```python
import torch

def _softmax(x, axis=-1):
    return torch.softmax(x, dim=axis)
def _gelu(x):
    return torch.nn.functional.gelu(x, approximate="tanh")
def _silu(x):
    return torch.nn.functional.silu(x)
def _sigmoid(x):
    return torch.sigmoid(x)
def _layernorm(x, axis=-1, eps=1e-5):
    m = x.mean(dim=axis, keepdim=True)
    v = x.var(dim=axis, keepdim=True, unbiased=False)
    return (x - m) / torch.sqrt(v + eps)
def _scatter_add(tgt, idx, src, axis=0):
    return tgt.clone().index_add_(axis, idx, src)
def _segment_sum(src, seg, n):
    out = torch.zeros((n,) + src.shape[1:], dtype=src.dtype)
    return out.index_add_(0, seg, src)
def _pad(x, pw):
    flat = tuple(v for pair in reversed(pw) for v in pair)
    return torch.nn.functional.pad(x, flat)

kernel_name = 'concat_heads__mha_block_cached__gqa_block_cached__near_ridge'

def setup_inputs():

    _w = (lambda a: (lambda t: t.to(torch.bfloat16) if t.is_floating_point() else t)(torch.as_tensor(a)))
    def _A_setup():
        B, Sq, D = 16, 96, 448
        H, Sk, Dh = 16, 96, 256
        return {
            "x": _w((lambda *s: torch.randn(*s, dtype=torch.bfloat16) * 0.8)(B, Sq, D)),
            "k_cache": _w((lambda *s: torch.randn(*s, dtype=torch.bfloat16) * 0.8)(B, H, Sk, Dh)),
            "v_cache": _w((lambda *s: torch.randn(*s, dtype=torch.bfloat16) * 0.05)(B, H, Sk, Dh)),
            "wq": _w((lambda *s: torch.randn(*s, dtype=torch.bfloat16) * 0.8)(D, H * Dh) * (D ** -0.5)),
            "wo": _w((lambda *s: torch.randn(*s, dtype=torch.bfloat16) * 0.05)(H * Dh, D) * ((H * Dh) ** -0.5)),
        }
    _A_in = _A_setup()

    def _B_setup():
        B, Sq, D = 16, 96, 448
        Hq, Hkv, Sk, Dh = 16, 16, 96, 256
        assert Hq % Hkv == 0, (Hq, Hkv)
        return {
            "x": _w((lambda *s: torch.randn(*s, dtype=torch.bfloat16) * 0.8)(B, Sq, D)),
            "k_cache": _w((lambda *s: torch.randn(*s, dtype=torch.bfloat16) * 0.8)(B, Hkv, Sk, Dh)),
            "v_cache": _w((lambda *s: torch.randn(*s, dtype=torch.bfloat16) * 0.05)(B, Hkv, Sk, Dh)),
            "wq": _w((lambda *s: torch.randn(*s, dtype=torch.bfloat16) * 0.8)(D, Hq * Dh) * (D ** -0.5)),
            "wo": _w((lambda *s: torch.randn(*s, dtype=torch.bfloat16) * 0.05)(Hq * Dh, D) * ((Hq * Dh) ** -0.5)),
        }
    _B_in = _B_setup()

    return {
        "A_x": _A_in["x"],
        "A_k_cache": _A_in["k_cache"],
        "A_v_cache": _A_in["v_cache"],
        "A_wq": _A_in["wq"],
        "A_wo": _A_in["wo"],
        "B_x": _B_in["x"],
        "B_k_cache": _B_in["k_cache"],
        "B_v_cache": _B_in["v_cache"],
        "B_wq": _B_in["wq"],
        "B_wo": _B_in["wo"],
    }

def reference(A_x, A_k_cache, A_v_cache, A_wq, A_wo, B_x, B_k_cache, B_v_cache, B_wq, B_wo):
    def _A_ref(x, k_cache, v_cache, wq, wo):
        B, Sq, D = x.shape
        H, Dh = 16, 256
        q = (lambda x, *d: x.permute(*d))((x @ wq).reshape(B, Sq, H, Dh), 0, 2, 1, 3)
        scores = torch.einsum("bhqd,bhkd->bhqk", q, k_cache) * (Dh ** -0.5)
        p = _softmax(scores, axis=-1)
        o = torch.einsum("bhqk,bhkd->bhqd", p, v_cache)
        return (lambda x, *d: x.permute(*d))(o, 0, 2, 1, 3).reshape(B, Sq, H * Dh) @ wo

    def _B_ref(x, k_cache, v_cache, wq, wo):
        B, Sq, D = x.shape
        Hq, Dh = 16, 256
        Hkv = k_cache.shape[1]
        rep = Hq // Hkv
        q = (lambda x, *d: x.permute(*d))((x @ wq).reshape(B, Sq, Hq, Dh), 0, 2, 1, 3)
        k = (lambda x, n, axis: torch.repeat_interleave(x, n, dim=axis))(k_cache, rep, axis=1)
        v = (lambda x, n, axis: torch.repeat_interleave(x, n, dim=axis))(v_cache, rep, axis=1)
        scores = torch.einsum("bhqd,bhkd->bhqk", q, k) * (Dh ** -0.5)
        p = _softmax(scores, axis=-1)
        o = torch.einsum("bhqk,bhkd->bhqd", p, v)
        return (lambda x, *d: x.permute(*d))(o, 0, 2, 1, 3).reshape(B, Sq, Hq * Dh) @ wo

    a = _A_ref(A_x, A_k_cache, A_v_cache, A_wq, A_wo)
    b = _B_ref(B_x, B_k_cache, B_v_cache, B_wq, B_wo)
    return torch.concatenate([a, b], axis=-1)
```

```asm
; @launch grid=(256,1,1) block=(512,1,1) lds=163840
.amdgcn_target "amdgcn-amd-amdhsa--gfx950"
.text
.globl concat_heads__mha_block_cached__gqa_block_cached__near_ridge_kernel
.p2align 12
.p2align 8
.type concat_heads__mha_block_cached__gqa_block_cached__near_ridge_kernel,@function
concat_heads__mha_block_cached__gqa_block_cached__near_ridge_kernel:
    s_and_b32 s7, s2, 4
    s_mul_i32 s7, s7, 10
    s_load_dwordx2 s[40:41], s[0:1], s7
    s_load_dwordx2 s[44:45], s[0:1], s7 offset:24
    v_cmp_gt_u32 vcc, 64, v0
    s_cbranch_vccz L_nocpf
    s_getpc_b64 s[4:5]
    s_and_b32 s6, s2, 56
    s_mulk_i32 s6, 672
    v_lshl_add_u32 v244, v0, 7, s6
    global_load_dword v246, v244, s[4:5]
L_nocpf:
    s_cmpk_ge_u32 s2, 0x100
    s_cbranch_scc1 L_exit0
    v_readfirstlane_b32 s67, v0
    v_and_b32 v255, 63, v0
    s_and_b32 s72, s2, 3
    s_lshr_b32 s73, s2, 7
    s_lshr_b32 s64, s2, 3
    s_and_b32 s64, s64, 15
    s_cmpk_lt_u32 s67, 0x100
    s_cbranch_scc1 L_compute
    s_lshr_b32 s88, s64, 1
    s_mul_i32 s74, s73, 3
    s_add_u32 s68, s88, s72
    s_add_u32 s68, s68, s74
    s_sub_u32 s74, s68, 7
    s_cselect_b32 s68, s68, s74
    v_lshrrev_b32 v210, 3, v255
    s_lshr_b32 s67, s67, 6
    v_mul_u32_u24 v202, 896, v210
    s_and_b32 s71, s67, 3
    v_lshlrev_b32 v209, 4, v255
    s_lshl2_add_u32 s74, s64, s71
    v_xor_b32 v210, v209, v0
    s_mulk_i32 s74, 336
    v_and_b32 v210, 0x70, v210
    s_and_b32 s3, s64, 1
    s_add_u32 s74, s74, s3
    s_lshl_b32 s74, s74, 6
    v_xad_u32 v202, v210, s74, v202
    s_add_u32 m0, s67, 7
    s_mulk_i32 m0, 3072
    s_lshl_b32 s80, s68, 7
    s_lshl_b32 s42, 21, 16
    s_mov_b32 s43, 0x00020000
    s_waitcnt lgkmcnt(0)
    buffer_load_dwordx4 v202, s[40:43], s80 offen lds
    v_xor_b32 v206, 64, v202
    s_addk_i32 m0, 1024
    s_add_u32 s74, s80, 7168
    buffer_load_dwordx4 v206, s[40:43], s74 offen lds
    s_addk_i32 m0, 1024
    s_addk_i32 s74, 7168
    buffer_load_dwordx4 v202, s[40:43], s74 offen lds
    s_lshl1_add_u32 s65, s72, s73
    s_lshl2_add_u32 s72, s3, s71
    s_lshl_b32 s72, s72, 6
    s_add_u32 s72, s72, s65
    s_lshl_b32 s72, s72, 10
    v_add_u32 v200, s72, v209
    s_lshr_b32 s74, s71, 1
    s_and_b32 s75, s71, 1
    s_lshl2_add_u32 s78, s74, s75
    s_mulk_i32 s78, 4224
    s_lshl_b32 s79, s68, 19
    s_lshl_b32 s46, 56, 16
    s_mov_b32 s47, s43
    s_add_u32 m0, s78, 130048
    s_add_u32 s72, s79, 0
    buffer_load_dwordx4 v200, s[44:47], s72 offen lds
    s_addk_i32 m0, 1056
    s_addk_i32 s72, 8192
    buffer_load_dwordx4 v200, s[44:47], s72 offen lds
    s_addk_i32 m0, 1056
    s_addk_i32 s72, 8192
    buffer_load_dwordx4 v200, s[44:47], s72 offen lds
    s_addk_i32 m0, 1056
    s_addk_i32 s72, 8192
    buffer_load_dwordx4 v200, s[44:47], s72 offen lds
    s_addk_i32 m0, 5280
    s_addk_i32 s72, 8192
    buffer_load_dwordx4 v200, s[44:47], s72 offen lds
    s_addk_i32 m0, 1056
    s_addk_i32 s72, 8192
    buffer_load_dwordx4 v200, s[44:47], s72 offen lds
    s_addk_i32 m0, 1056
    s_addk_i32 s72, 8192
    buffer_load_dwordx4 v200, s[44:47], s72 offen lds
    s_addk_i32 m0, 1056
    s_addk_i32 s72, 8192
    buffer_load_dwordx4 v200, s[44:47], s72 offen lds
    s_add_u32 s80, s80, 128
    s_cmp_ge_u32 s80, 896
    s_cselect_b32 s80, 0, s80
    s_mul_i32 s81, s71, 3072
    s_bfe_u32 s66, s2, 0x10002
    s_load_dwordx2 s[48:49], s[0:1], s7 offset:8
    s_load_dwordx2 s[52:53], s[0:1], s7 offset:16
    s_load_dwordx2 s[56:57], s[0:1], s7 offset:32
    s_load_dwordx4 s[36:39], s[0:1], 80
    s_load_dwordx2 s[14:15], s[0:1], 96
    v_xor_b32 v201, 0x40000, v200
    s_cmp_eq_u32 s88, 7
    s_cselect_b32 s88, 0, s88
    s_add_u32 s12, s65, 3
    s_and_b32 s12, s12, 7
    s_cmp_eq_u32 s12, 7
    s_cselect_b32 s13, 0, s12
    s_mov_b32 s50, 12582912
    s_mov_b32 s51, 0x00020000
    s_mov_b32 s54, 12582912
    s_mov_b32 s55, 0x00020000
    s_mov_b32 s58, 3670016
    s_mov_b32 s59, 0x00020000
    s_lshl_b32 s73, s64, 3
    s_add_u32 s73, s73, s65
    s_mul_i32 s73, s73, 98304
    s_mul_i32 s72, s74, 49152
    s_add_u32 s72, s72, s73
    s_lshl_b32 s82, s75, 13
    s_add_u32 s72, s72, s82
    v_and_b32 v210, 32, v255
    v_lshrrev_b32 v210, 1, v210
    v_xor_b32 v210, v210, v209
    v_add_u32 v203, s72, v210
    s_mul_i32 s82, s71, 8448
    s_mul_i32 s89, s71, 2112
    v_add_u32 v211, s89, v209
    s_add_u32 s72, s82, 96256
    v_add_u32 v212, s72, v209
    v_and_b32 v209, 0xf0, v209
    v_lshrrev_b32 v210, 4, v255
    v_lshl_add_u32 v209, v210, 12, v209
    s_lshl_b32 s72, s71, 10
    s_add_u32 s72, s72, s73
    s_lshl_b32 s73, s3, 8
    s_add_u32 s72, s72, s73
    v_add_u32 v204, s72, v209
    v_xor_b32 v205, 0x100, v204
    s_lshl_b32 s72, s65, 9
    s_lshl_b32 s73, s74, 8
    s_add_u32 s72, s72, s73
    s_lshl_b32 s73, s75, 6
    s_add_u32 s72, s72, s73
    s_mul_i32 s72, s72, 896
    v_and_b32 v209, 32, v255
    v_and_b32 v210, 8, v255
    v_lshl_add_u32 v209, v210, 1, v209
    v_and_b32 v210, 16, v255
    v_lshrrev_b32 v210, 1, v210
    v_add_u32 v209, v209, v210
    v_mul_u32_u24 v209, 896, v209
    v_and_b32 v210, 7, v255
    v_lshl_add_u32 v209, v210, 4, v209
    s_mul_i32 s73, s3, 114688
    s_add_u32 s74, s72, s73
    v_add_u32 v213, s74, v209
    s_sub_u32 s74, s72, s73
    s_add_u32 s74, s74, 114688
    v_add_u32 v214, s74, v209
    s_add_u32 s72, s88, s13
    s_sub_u32 s73, s72, 7
    s_cselect_b32 s72, s72, s73
    s_lshl_b32 s33, s72, 7
    s_waitcnt lgkmcnt(0)
    s_mov_b32 s60, s14
    s_mov_b32 s61, s15
    s_mov_b32 s62, 268435456
    s_mov_b32 s63, 0x00020000
    s_mov_b32 s92, s36
    s_mov_b32 s93, s37
    s_mov_b32 s94, 2752512
    s_mov_b32 s95, 0x00020000
    s_mov_b32 s96, s38
    s_mov_b32 s97, s39
    s_mov_b32 s98, 256
    s_mov_b32 s99, 0x00020000
    s_lshl_b32 s90, s66, 4
    s_add_u32 s90, s90, s64
    s_mul_i32 s91, s90, 4096
    s_add_u32 s91, s91, 25165824
    s_cmp_ge_u32 s68, 4
    s_cbranch_scc1 L_lv1
    v_bfrev_b32 v239, 1
    v_mov_b32 v224, -1
    v_mov_b32 v225, -1
    v_mov_b32 v226, -1
    v_mov_b32 v227, -1
    v_mov_b32 v160, 0
    v_mov_b32 v161, 0
    v_mov_b32 v162, 0
    v_mov_b32 v163, 0
    v_mov_b32 v164, 0
    v_mov_b32 v165, 0
    v_mov_b32 v166, 0
    v_mov_b32 v167, 0
    v_mov_b32 v168, 0
    v_mov_b32 v169, 0
    v_mov_b32 v170, 0
    v_mov_b32 v171, 0
    v_mov_b32 v172, 0
    v_mov_b32 v173, 0
    v_mov_b32 v174, 0
    v_mov_b32 v175, 0
    v_mov_b32 v176, 0
    v_mov_b32 v177, 0
    v_mov_b32 v178, 0
    v_mov_b32 v179, 0
    v_mov_b32 v180, 0
    v_mov_b32 v181, 0
    v_mov_b32 v182, 0
    v_mov_b32 v183, 0
    s_mul_i32 s72, s90, 602112
    s_add_u32 s72, s72, s81
    v_lshl_add_u32 v232, v255, 4, s72
    s_add_u32 s73, s81, 135168
    v_lshl_add_u32 v233, v255, 3, s73
    s_mul_i32 s74, s13, 86016
    s_add_u32 s72, s72, s74
    v_and_b32 v236, 15, v255
    v_and_b32 v237, 16, v255
    v_lshl_add_u32 v238, v237, 1, v236
    v_lshl_add_u32 v234, v238, 3, s73
    v_add_u32 v235, 0x80, v234
    v_lshl_add_u32 v228, v238, 4, s72
    v_and_b32 v238, 32, v255
    v_mul_u32_u24 v229, 384, v238
    v_add_u32 v228, v228, v229
    v_mul_u32_u24 v229, 1792, v236
    v_lshl_add_u32 v229, v237, 1, v229
    v_lshrrev_b32 v238, 1, v238
    s_and_b32 s72, s71, 1
    s_mul_i32 s72, s72, 85984
    s_lshl_b32 s73, s71, 5
    s_add_u32 s72, s72, s73
    s_mul_i32 s73, s64, 172032
    s_add_u32 s72, s72, s73
    s_mul_i32 s73, s66, 896
    s_add_u32 s72, s72, s73
    s_add_u32 s72, s72, s33
    s_cmp_eq_u32 s12, 7
    s_cselect_b32 s72, 0x80000000, s72
    v_add3_u32 v229, v229, v238, s72
    v_and_b32 v236, 1, v255
    v_lshlrev_b32 v236, 4, v236
    v_mov_b32 v237, 0x3f80
    v_lshlrev_b32 v237, v236, v237
    v_lshrrev_b32 v236, 1, v255
    v_lshrrev_b32 v238, 2, v255
    v_and_b32 v238, 4, v238
    v_xor_b32 v236, v236, v238
    v_and_b32 v236, 7, v236
    v_cmp_eq_u32 vcc, 0, v236
    v_cndmask_b32 v220, 0, v237, vcc
    v_cmp_eq_u32 vcc, 1, v236
    v_cndmask_b32 v221, 0, v237, vcc
    v_cmp_eq_u32 vcc, 2, v236
    v_cndmask_b32 v222, 0, v237, vcc
    v_cmp_eq_u32 vcc, 3, v236
    v_cndmask_b32 v223, 0, v237, vcc
    s_lshl_b32 s72, s71, 5
    v_lshl_add_u32 v231, v255, 7, s72
    v_cmp_le_u32 vcc, 4, v255
    v_cndmask_b32 v231, v231, v239, vcc
    v_lshlrev_b32 v230, 2, v255
    v_cmp_le_u32 vcc, 8, v255
    v_cndmask_b32 v230, v230, v239, vcc
    s_mul_i32 s73, s13, 512
    s_add_u32 s72, s72, s73
    s_add_u32 s32, s72, s91
    s_add_u32 m0, s78, 0
    s_add_u32 s72, s79, 0
    buffer_load_dwordx4 v201, s[44:47], s72 offen lds
    s_addk_i32 m0, 1056
    s_addk_i32 s72, 8192
    buffer_load_dwordx4 v201, s[44:47], s72 offen lds
    s_addk_i32 m0, 1056
    s_addk_i32 s72, 8192
    buffer_load_dwordx4 v201, s[44:47], s72 offen lds
    s_addk_i32 m0, 1056
    s_addk_i32 s72, 8192
    buffer_load_dwordx4 v201, s[44:47], s72 offen lds
    s_addk_i32 m0, 5280
    s_addk_i32 s72, 8192
    buffer_load_dwordx4 v201, s[44:47], s72 offen lds
    s_addk_i32 m0, 1056
    s_addk_i32 s72, 8192
    buffer_load_dwordx4 v201, s[44:47], s72 offen lds
    s_addk_i32 m0, 1056
    s_addk_i32 s72, 8192
    buffer_load_dwordx4 v201, s[44:47], s72 offen lds
    s_addk_i32 m0, 1056
    s_addk_i32 s72, 8192
    buffer_load_dwordx4 v201, s[44:47], s72 offen lds
    s_add_u32 s79, s79, 524288
    s_cmp_ge_u32 s79, 3670016
    s_cselect_b32 s79, 0, s79
    s_waitcnt vmcnt(8)
    s_barrier
    s_add_u32 m0, s81, 46080
    s_add_u32 s72, s80, 0
    buffer_load_dwordx4 v202, s[40:43], s72 offen lds
    s_addk_i32 m0, 1024
    s_addk_i32 s72, 7168
    buffer_load_dwordx4 v206, s[40:43], s72 offen lds
    s_addk_i32 m0, 1024
    s_addk_i32 s72, 7168
    buffer_load_dwordx4 v202, s[40:43], s72 offen lds
    s_add_u32 s80, s80, 128
    s_cmp_ge_u32 s80, 896
    s_cselect_b32 s80, 0, s80
    s_add_u32 m0, s78, 96256
    s_add_u32 s72, s79, 0
    buffer_load_dwordx4 v200, s[44:47], s72 offen lds
    s_addk_i32 m0, 1056
    s_addk_i32 s72, 8192
    buffer_load_dwordx4 v200, s[44:47], s72 offen lds
    s_addk_i32 m0, 1056
    s_addk_i32 s72, 8192
    buffer_load_dwordx4 v200, s[44:47], s72 offen lds
    s_addk_i32 m0, 1056
    s_addk_i32 s72, 8192
    buffer_load_dwordx4 v200, s[44:47], s72 offen lds
    s_addk_i32 m0, 5280
    s_addk_i32 s72, 8192
    buffer_load_dwordx4 v200, s[44:47], s72 offen lds
    s_addk_i32 m0, 1056
    s_addk_i32 s72, 8192
    buffer_load_dwordx4 v200, s[44:47], s72 offen lds
    s_addk_i32 m0, 1056
    s_addk_i32 s72, 8192
    buffer_load_dwordx4 v200, s[44:47], s72 offen lds
    s_addk_i32 m0, 1056
    s_addk_i32 s72, 8192
    buffer_load_dwordx4 v200, s[44:47], s72 offen lds
    s_waitcnt vmcnt(11)
    s_barrier
    s_add_u32 m0, s78, 130048
    s_add_u32 s72, s79, 0
    buffer_load_dwordx4 v201, s[44:47], s72 offen lds
    s_addk_i32 m0, 1056
    s_addk_i32 s72, 8192
    buffer_load_dwordx4 v201, s[44:47], s72 offen lds
    s_addk_i32 m0, 1056
    s_addk_i32 s72, 8192
    buffer_load_dwordx4 v201, s[44:47], s72 offen lds
    s_addk_i32 m0, 1056
    s_addk_i32 s72, 8192
    buffer_load_dwordx4 v201, s[44:47], s72 offen lds
    s_addk_i32 m0, 5280
    s_addk_i32 s72, 8192
    buffer_load_dwordx4 v201, s[44:47], s72 offen lds
    s_addk_i32 m0, 1056
    s_addk_i32 s72, 8192
    buffer_load_dwordx4 v201, s[44:47], s72 offen lds
    s_addk_i32 m0, 1056
    s_addk_i32 s72, 8192
    buffer_load_dwordx4 v201, s[44:47], s72 offen lds
    s_addk_i32 m0, 1056
    s_addk_i32 s72, 8192
    buffer_load_dwordx4 v201, s[44:47], s72 offen lds
    s_add_u32 s79, s79, 524288
    s_cmp_ge_u32 s79, 3670016
    s_cselect_b32 s79, 0, s79
    s_waitcnt vmcnt(8)
    s_barrier
    s_add_u32 m0, s81, 33792
    s_add_u32 s72, s80, 0
    buffer_load_dwordx4 v202, s[40:43], s72 offen lds
    s_addk_i32 m0, 1024
    s_addk_i32 s72, 7168
    buffer_load_dwordx4 v206, s[40:43], s72 offen lds
    s_addk_i32 m0, 1024
    s_addk_i32 s72, 7168
    buffer_load_dwordx4 v202, s[40:43], s72 offen lds
    s_add_u32 s80, s80, 128
    s_cmp_ge_u32 s80, 896
    s_cselect_b32 s80, 0, s80
    s_add_u32 m0, s82, 62464
    s_mov_b32 s72, 0
    buffer_load_dwordx4 v203, s[48:51], s72 offen nt lds
    s_addk_i32 m0, 1056
    s_addk_i32 s72, 1024
    buffer_load_dwordx4 v203, s[48:51], s72 offen nt lds
    s_addk_i32 m0, 1056
    s_addk_i32 s72, 1024
    buffer_load_dwordx4 v203, s[48:51], s72 offen nt lds
    s_addk_i32 m0, 1056
    s_addk_i32 s72, 1024
    buffer_load_dwordx4 v203, s[48:51], s72 offen nt lds
    s_addk_i32 m0, 1056
    s_addk_i32 s72, 1024
    buffer_load_dwordx4 v203, s[48:51], s72 offen nt lds
    s_addk_i32 m0, 1056
    s_addk_i32 s72, 1024
    buffer_load_dwordx4 v203, s[48:51], s72 offen nt lds
    s_addk_i32 m0, 1056
    s_addk_i32 s72, 1024
    buffer_load_dwordx4 v203, s[48:51], s72 offen nt lds
    s_addk_i32 m0, 1056
    s_addk_i32 s72, 1024
    buffer_load_dwordx4 v203, s[48:51], s72 offen nt lds
    s_waitcnt vmcnt(11)
    s_barrier
    s_add_u32 m0, s78, 0
    s_add_u32 s72, s79, 0
    buffer_load_dwordx4 v200, s[44:47], s72 offen lds
    s_addk_i32 m0, 1056
    s_addk_i32 s72, 8192
    buffer_load_dwordx4 v200, s[44:47], s72 offen lds
    s_addk_i32 m0, 1056
    s_addk_i32 s72, 8192
    buffer_load_dwordx4 v200, s[44:47], s72 offen lds
    s_addk_i32 m0, 1056
    s_addk_i32 s72, 8192
    buffer_load_dwordx4 v200, s[44:47], s72 offen lds
    s_addk_i32 m0, 5280
    s_addk_i32 s72, 8192
    buffer_load_dwordx4 v200, s[44:47], s72 offen lds
    s_addk_i32 m0, 1056
    s_addk_i32 s72, 8192
    buffer_load_dwordx4 v200, s[44:47], s72 offen lds
    s_addk_i32 m0, 1056
    s_addk_i32 s72, 8192
    buffer_load_dwordx4 v200, s[44:47], s72 offen lds
    s_addk_i32 m0, 1056
    s_addk_i32 s72, 8192
    buffer_load_dwordx4 v200, s[44:47], s72 offen lds
    s_add_u32 m0, s78, 96256
    s_add_u32 s72, s79, 0
    buffer_load_dwordx4 v201, s[44:47], s72 offen lds
    s_addk_i32 m0, 1056
    s_addk_i32 s72, 8192
    buffer_load_dwordx4 v201, s[44:47], s72 offen lds
    s_addk_i32 m0, 1056
    s_addk_i32 s72, 8192
    buffer_load_dwordx4 v201, s[44:47], s72 offen lds
    s_addk_i32 m0, 1056
    s_addk_i32 s72, 8192
    buffer_load_dwordx4 v201, s[44:47], s72 offen lds
    s_addk_i32 m0, 5280
    s_addk_i32 s72, 8192
    buffer_load_dwordx4 v201, s[44:47], s72 offen lds
    s_addk_i32 m0, 1056
    s_addk_i32 s72, 8192
    buffer_load_dwordx4 v201, s[44:47], s72 offen lds
    s_addk_i32 m0, 1056
    s_addk_i32 s72, 8192
    buffer_load_dwordx4 v201, s[44:47], s72 offen lds
    s_addk_i32 m0, 1056
    s_addk_i32 s72, 8192
    buffer_load_dwordx4 v201, s[44:47], s72 offen lds
    s_add_u32 s79, s79, 524288
    s_cmp_ge_u32 s79, 3670016
    s_cselect_b32 s79, 0, s79
    s_waitcnt vmcnt(8)
    s_barrier
    s_add_u32 m0, s78, 130048
    s_add_u32 s72, s79, 0
    buffer_load_dwordx4 v200, s[44:47], s72 offen lds
    s_addk_i32 m0, 1056
    s_addk_i32 s72, 8192
    buffer_load_dwordx4 v200, s[44:47], s72 offen lds
    s_addk_i32 m0, 1056
    s_addk_i32 s72, 8192
    buffer_load_dwordx4 v200, s[44:47], s72 offen lds
    s_addk_i32 m0, 1056
    s_addk_i32 s72, 8192
    buffer_load_dwordx4 v200, s[44:47], s72 offen lds
    s_addk_i32 m0, 5280
    s_addk_i32 s72, 8192
    buffer_load_dwordx4 v200, s[44:47], s72 offen lds
    s_addk_i32 m0, 1056
    s_addk_i32 s72, 8192
    buffer_load_dwordx4 v200, s[44:47], s72 offen lds
    s_addk_i32 m0, 1056
    s_addk_i32 s72, 8192
    buffer_load_dwordx4 v200, s[44:47], s72 offen lds
    s_addk_i32 m0, 1056
    s_addk_i32 s72, 8192
    buffer_load_dwordx4 v200, s[44:47], s72 offen lds
    s_add_u32 m0, s81, 46080
    s_add_u32 s72, s80, 0
    buffer_load_dwordx4 v202, s[40:43], s72 offen lds
    s_addk_i32 m0, 1024
    s_addk_i32 s72, 7168
    buffer_load_dwordx4 v206, s[40:43], s72 offen lds
    s_addk_i32 m0, 1024
    s_addk_i32 s72, 7168
    buffer_load_dwordx4 v202, s[40:43], s72 offen lds
    s_add_u32 s80, s80, 128
    s_cmp_ge_u32 s80, 896
    s_cselect_b32 s80, 0, s80
    s_waitcnt vmcnt(11)
    s_barrier
    s_mov_b32 s73, 16384
    buffer_load_dwordx4 v[0:3], v203, s[48:51], s73 offen offset:0 nt
    s_mov_b32 s73, 16384
    buffer_load_dwordx4 v[4:7], v203, s[48:51], s73 offen offset:1024 nt
    s_mov_b32 s73, 16384
    buffer_load_dwordx4 v[8:11], v203, s[48:51], s73 offen offset:2048 nt
    s_mov_b32 s73, 16384
    buffer_load_dwordx4 v[12:15], v203, s[48:51], s73 offen offset:3072 nt
    s_mov_b32 s73, 20480
    buffer_load_dwordx4 v[16:19], v203, s[48:51], s73 offen offset:0 nt
    s_mov_b32 s73, 20480
    buffer_load_dwordx4 v[20:23], v203, s[48:51], s73 offen offset:1024 nt
    s_mov_b32 s73, 20480
    buffer_load_dwordx4 v[24:27], v203, s[48:51], s73 offen offset:2048 nt
    s_mov_b32 s73, 20480
    buffer_load_dwordx4 v[28:31], v203, s[48:51], s73 offen offset:3072 nt
    s_waitcnt vmcnt(8)
    s_barrier
    s_add_u32 m0, s78, 0
    s_add_u32 s72, s79, 0
    buffer_load_dwordx4 v201, s[44:47], s72 offen lds
    s_addk_i32 m0, 1056
    s_addk_i32 s72, 8192
    buffer_load_dwordx4 v201, s[44:47], s72 offen lds
    s_addk_i32 m0, 1056
    s_addk_i32 s72, 8192
    buffer_load_dwordx4 v201, s[44:47], s72 offen lds
    s_addk_i32 m0, 1056
    s_addk_i32 s72, 8192
    buffer_load_dwordx4 v201, s[44:47], s72 offen lds
    s_addk_i32 m0, 5280
    s_addk_i32 s72, 8192
    buffer_load_dwordx4 v201, s[44:47], s72 offen lds
    s_addk_i32 m0, 1056
    s_addk_i32 s72, 8192
    buffer_load_dwordx4 v201, s[44:47], s72 offen lds
    s_addk_i32 m0, 1056
    s_addk_i32 s72, 8192
    buffer_load_dwordx4 v201, s[44:47], s72 offen lds
    s_addk_i32 m0, 1056
    s_addk_i32 s72, 8192
    buffer_load_dwordx4 v201, s[44:47], s72 offen lds
    s_add_u32 s79, s79, 524288
    s_cmp_ge_u32 s79, 3670016
    s_cselect_b32 s79, 0, s79
    s_add_u32 m0, s81, 33792
    s_add_u32 s72, s80, 0
    buffer_load_dwordx4 v202, s[40:43], s72 offen lds
    s_addk_i32 m0, 1024
    s_addk_i32 s72, 7168
    buffer_load_dwordx4 v206, s[40:43], s72 offen lds
    s_addk_i32 m0, 1024
    s_addk_i32 s72, 7168
    buffer_load_dwordx4 v202, s[40:43], s72 offen lds
    s_add_u32 s80, s80, 128
    s_cmp_ge_u32 s80, 896
    s_cselect_b32 s80, 0, s80
    s_add_u32 m0, s78, 96256
    s_add_u32 s72, s79, 0
    buffer_load_dwordx4 v200, s[44:47], s72 offen lds
    s_addk_i32 m0, 1056
    s_addk_i32 s72, 8192
    buffer_load_dwordx4 v200, s[44:47], s72 offen lds
    s_addk_i32 m0, 1056
    s_addk_i32 s72, 8192
    buffer_load_dwordx4 v200, s[44:47], s72 offen lds
    s_addk_i32 m0, 1056
    s_addk_i32 s72, 8192
    buffer_load_dwordx4 v200, s[44:47], s72 offen lds
    s_addk_i32 m0, 5280
    s_addk_i32 s72, 8192
    buffer_load_dwordx4 v200, s[44:47], s72 offen lds
    s_addk_i32 m0, 1056
    s_addk_i32 s72, 8192
    buffer_load_dwordx4 v200, s[44:47], s72 offen lds
    s_addk_i32 m0, 1056
    s_addk_i32 s72, 8192
    buffer_load_dwordx4 v200, s[44:47], s72 offen lds
    s_addk_i32 m0, 1056
    s_addk_i32 s72, 8192
    buffer_load_dwordx4 v200, s[44:47], s72 offen lds
    s_waitcnt vmcnt(11)
    s_barrier
    s_add_u32 m0, s78, 130048
    s_add_u32 s72, s79, 0
    buffer_load_dwordx4 v201, s[44:47], s72 offen lds
    s_addk_i32 m0, 1056
    s_addk_i32 s72, 8192
    buffer_load_dwordx4 v201, s[44:47], s72 offen lds
    s_addk_i32 m0, 1056
    s_addk_i32 s72, 8192
    buffer_load_dwordx4 v201, s[44:47], s72 offen lds
    s_addk_i32 m0, 1056
    s_addk_i32 s72, 8192
    buffer_load_dwordx4 v201, s[44:47], s72 offen lds
    s_addk_i32 m0, 5280
    s_addk_i32 s72, 8192
    buffer_load_dwordx4 v201, s[44:47], s72 offen lds
    s_addk_i32 m0, 1056
    s_addk_i32 s72, 8192
    buffer_load_dwordx4 v201, s[44:47], s72 offen lds
    s_addk_i32 m0, 1056
    s_addk_i32 s72, 8192
    buffer_load_dwordx4 v201, s[44:47], s72 offen lds
    s_addk_i32 m0, 1056
    s_addk_i32 s72, 8192
    buffer_load_dwordx4 v201, s[44:47], s72 offen lds
    s_add_u32 s79, s79, 524288
    s_cmp_ge_u32 s79, 3670016
    s_cselect_b32 s79, 0, s79
    s_waitcnt vmcnt(8)
    s_barrier
    s_add_u32 m0, s78, 0
    s_add_u32 s72, s79, 0
    buffer_load_dwordx4 v200, s[44:47], s72 offen lds
    s_addk_i32 m0, 1056
    s_addk_i32 s72, 8192
    buffer_load_dwordx4 v200, s[44:47], s72 offen lds
    s_addk_i32 m0, 1056
    s_addk_i32 s72, 8192
    buffer_load_dwordx4 v200, s[44:47], s72 offen lds
    s_addk_i32 m0, 1056
    s_addk_i32 s72, 8192
    buffer_load_dwordx4 v200, s[44:47], s72 offen lds
    s_addk_i32 m0, 5280
    s_addk_i32 s72, 8192
    buffer_load_dwordx4 v200, s[44:47], s72 offen lds
    s_addk_i32 m0, 1056
    s_addk_i32 s72, 8192
    buffer_load_dwordx4 v200, s[44:47], s72 offen lds
    s_addk_i32 m0, 1056
    s_addk_i32 s72, 8192
    buffer_load_dwordx4 v200, s[44:47], s72 offen lds
    s_addk_i32 m0, 1056
    s_addk_i32 s72, 8192
    buffer_load_dwordx4 v200, s[44:47], s72 offen lds
    s_add_u32 m0, s81, 46080
    s_add_u32 s72, s80, 0
    buffer_load_dwordx4 v202, s[40:43], s72 offen lds
    s_addk_i32 m0, 1024
    s_addk_i32 s72, 7168
    buffer_load_dwordx4 v206, s[40:43], s72 offen lds
    s_addk_i32 m0, 1024
    s_addk_i32 s72, 7168
    buffer_load_dwordx4 v202, s[40:43], s72 offen lds
    s_add_u32 s80, s80, 128
    s_cmp_ge_u32 s80, 896
    s_cselect_b32 s80, 0, s80
    s_waitcnt vmcnt(11)
    s_barrier
    s_mov_b32 s73, 32768
    buffer_load_dwordx4 v[32:35], v203, s[48:51], s73 offen offset:0 nt
    s_mov_b32 s73, 32768
    buffer_load_dwordx4 v[36:39], v203, s[48:51], s73 offen offset:1024 nt
    s_mov_b32 s73, 32768
    buffer_load_dwordx4 v[40:43], v203, s[48:51], s73 offen offset:2048 nt
    s_mov_b32 s73, 32768
    buffer_load_dwordx4 v[44:47], v203, s[48:51], s73 offen offset:3072 nt
    s_mov_b32 s73, 36864
    buffer_load_dwordx4 v[48:51], v203, s[48:51], s73 offen offset:0 nt
    s_mov_b32 s73, 36864
    buffer_load_dwordx4 v[52:55], v203, s[48:51], s73 offen offset:1024 nt
    s_mov_b32 s73, 36864
    buffer_load_dwordx4 v[56:59], v203, s[48:51], s73 offen offset:2048 nt
    s_mov_b32 s73, 36864
    buffer_load_dwordx4 v[60:63], v203, s[48:51], s73 offen offset:3072 nt
    s_waitcnt vmcnt(8)
    s_barrier
    s_add_u32 m0, s78, 96256
    s_add_u32 s72, s79, 0
    buffer_load_dwordx4 v201, s[44:47], s72 offen lds
    s_addk_i32 m0, 1056
    s_addk_i32 s72, 8192
    buffer_load_dwordx4 v201, s[44:47], s72 offen lds
    s_addk_i32 m0, 1056
    s_addk_i32 s72, 8192
    buffer_load_dwordx4 v201, s[44:47], s72 offen lds
    s_addk_i32 m0, 1056
    s_addk_i32 s72, 8192
    buffer_load_dwordx4 v201, s[44:47], s72 offen lds
    s_addk_i32 m0, 5280
    s_addk_i32 s72, 8192
    buffer_load_dwordx4 v201, s[44:47], s72 offen lds
    s_addk_i32 m0, 1056
    s_addk_i32 s72, 8192
    buffer_load_dwordx4 v201, s[44:47], s72 offen lds
    s_addk_i32 m0, 1056
    s_addk_i32 s72, 8192
    buffer_load_dwordx4 v201, s[44:47], s72 offen lds
    s_addk_i32 m0, 1056
    s_addk_i32 s72, 8192
    buffer_load_dwordx4 v201, s[44:47], s72 offen lds
    s_add_u32 s79, s79, 524288
    s_cmp_ge_u32 s79, 3670016
    s_cselect_b32 s79, 0, s79
    s_add_u32 m0, s81, 33792
    s_add_u32 s72, s80, 0
    buffer_load_dwordx4 v202, s[40:43], s72 offen lds
    s_addk_i32 m0, 1024
    s_addk_i32 s72, 7168
    buffer_load_dwordx4 v206, s[40:43], s72 offen lds
    s_addk_i32 m0, 1024
    s_addk_i32 s72, 7168
    buffer_load_dwordx4 v202, s[40:43], s72 offen lds
    s_add_u32 s80, s80, 128
    s_cmp_ge_u32 s80, 896
    s_cselect_b32 s80, 0, s80
    s_add_u32 m0, s78, 130048
    s_add_u32 s72, s79, 0
    buffer_load_dwordx4 v200, s[44:47], s72 offen lds
    s_addk_i32 m0, 1056
    s_addk_i32 s72, 8192
    buffer_load_dwordx4 v200, s[44:47], s72 offen lds
    s_addk_i32 m0, 1056
    s_addk_i32 s72, 8192
    buffer_load_dwordx4 v200, s[44:47], s72 offen lds
    s_addk_i32 m0, 1056
    s_addk_i32 s72, 8192
    buffer_load_dwordx4 v200, s[44:47], s72 offen lds
    s_addk_i32 m0, 5280
    s_addk_i32 s72, 8192
    buffer_load_dwordx4 v200, s[44:47], s72 offen lds
    s_addk_i32 m0, 1056
    s_addk_i32 s72, 8192
    buffer_load_dwordx4 v200, s[44:47], s72 offen lds
    s_addk_i32 m0, 1056
    s_addk_i32 s72, 8192
    buffer_load_dwordx4 v200, s[44:47], s72 offen lds
    s_addk_i32 m0, 1056
    s_addk_i32 s72, 8192
    buffer_load_dwordx4 v200, s[44:47], s72 offen lds
    s_waitcnt vmcnt(11)
    s_barrier
    s_add_u32 m0, s78, 0
    s_add_u32 s72, s79, 0
    buffer_load_dwordx4 v201, s[44:47], s72 offen lds
    s_addk_i32 m0, 1056
    s_addk_i32 s72, 8192
    buffer_load_dwordx4 v201, s[44:47], s72 offen lds
    s_addk_i32 m0, 1056
    s_addk_i32 s72, 8192
    buffer_load_dwordx4 v201, s[44:47], s72 offen lds
    s_addk_i32 m0, 1056
    s_addk_i32 s72, 8192
    buffer_load_dwordx4 v201, s[44:47], s72 offen lds
    s_addk_i32 m0, 5280
    s_addk_i32 s72, 8192
    buffer_load_dwordx4 v201, s[44:47], s72 offen lds
    s_addk_i32 m0, 1056
    s_addk_i32 s72, 8192
    buffer_load_dwordx4 v201, s[44:47], s72 offen lds
    s_addk_i32 m0, 1056
    s_addk_i32 s72, 8192
    buffer_load_dwordx4 v201, s[44:47], s72 offen lds
    s_addk_i32 m0, 1056
    s_addk_i32 s72, 8192
    buffer_load_dwordx4 v201, s[44:47], s72 offen lds
    s_add_u32 s79, s79, 524288
    s_cmp_ge_u32 s79, 3670016
    s_cselect_b32 s79, 0, s79
    s_waitcnt vmcnt(8)
    s_branch L_merge
L_lv1:
    v_bfrev_b32 v239, 1
    v_mov_b32 v224, -1
    v_mov_b32 v225, -1
    v_mov_b32 v226, -1
    v_mov_b32 v227, -1
    v_mov_b32 v160, 0
    v_mov_b32 v161, 0
    v_mov_b32 v162, 0
    v_mov_b32 v163, 0
    v_mov_b32 v164, 0
    v_mov_b32 v165, 0
    v_mov_b32 v166, 0
    v_mov_b32 v167, 0
    v_mov_b32 v168, 0
    v_mov_b32 v169, 0
    v_mov_b32 v170, 0
    v_mov_b32 v171, 0
    v_mov_b32 v172, 0
    v_mov_b32 v173, 0
    v_mov_b32 v174, 0
    v_mov_b32 v175, 0
    v_mov_b32 v176, 0
    v_mov_b32 v177, 0
    v_mov_b32 v178, 0
    v_mov_b32 v179, 0
    v_mov_b32 v180, 0
    v_mov_b32 v181, 0
    v_mov_b32 v182, 0
    v_mov_b32 v183, 0
    s_mul_i32 s72, s90, 602112
    s_add_u32 s72, s72, s81
    v_lshl_add_u32 v232, v255, 4, s72
    s_add_u32 s73, s81, 135168
    v_lshl_add_u32 v233, v255, 3, s73
    s_mul_i32 s74, s13, 86016
    s_add_u32 s72, s72, s74
    v_and_b32 v236, 15, v255
    v_and_b32 v237, 16, v255
    v_lshl_add_u32 v238, v237, 1, v236
    v_lshl_add_u32 v234, v238, 3, s73
    v_add_u32 v235, 0x80, v234
    v_lshl_add_u32 v228, v238, 4, s72
    v_and_b32 v238, 32, v255
    v_mul_u32_u24 v229, 384, v238
    v_add_u32 v228, v228, v229
    v_mul_u32_u24 v229, 1792, v236
    v_lshl_add_u32 v229, v237, 1, v229
    v_lshrrev_b32 v238, 1, v238
    s_and_b32 s72, s71, 1
    s_mul_i32 s72, s72, 85984
    s_lshl_b32 s73, s71, 5
    s_add_u32 s72, s72, s73
    s_mul_i32 s73, s64, 172032
    s_add_u32 s72, s72, s73
    s_mul_i32 s73, s66, 896
    s_add_u32 s72, s72, s73
    s_add_u32 s72, s72, s33
    s_cmp_eq_u32 s12, 7
    s_cselect_b32 s72, 0x80000000, s72
    v_add3_u32 v229, v229, v238, s72
    v_and_b32 v236, 1, v255
    v_lshlrev_b32 v236, 4, v236
    v_mov_b32 v237, 0x3f80
    v_lshlrev_b32 v237, v236, v237
    v_lshrrev_b32 v236, 1, v255
    v_lshrrev_b32 v238, 2, v255
    v_and_b32 v238, 4, v238
    v_xor_b32 v236, v236, v238
    v_and_b32 v236, 7, v236
    v_cmp_eq_u32 vcc, 0, v236
    v_cndmask_b32 v220, 0, v237, vcc
    v_cmp_eq_u32 vcc, 1, v236
    v_cndmask_b32 v221, 0, v237, vcc
    v_cmp_eq_u32 vcc, 2, v236
    v_cndmask_b32 v222, 0, v237, vcc
    v_cmp_eq_u32 vcc, 3, v236
    v_cndmask_b32 v223, 0, v237, vcc
    s_lshl_b32 s72, s71, 5
    v_lshl_add_u32 v231, v255, 7, s72
    v_cmp_le_u32 vcc, 4, v255
    v_cndmask_b32 v231, v231, v239, vcc
    v_lshlrev_b32 v230, 2, v255
    v_cmp_le_u32 vcc, 8, v255
    v_cndmask_b32 v230, v230, v239, vcc
    s_mul_i32 s73, s13, 512
    s_add_u32 s72, s72, s73
    s_add_u32 s32, s72, s91
    s_add_u32 m0, s78, 0
    s_add_u32 s72, s79, 0
    buffer_load_dwordx4 v201, s[44:47], s72 offen lds
    s_addk_i32 m0, 1056
    s_addk_i32 s72, 8192
    buffer_load_dwordx4 v201, s[44:47], s72 offen lds
    s_addk_i32 m0, 1056
    s_addk_i32 s72, 8192
    buffer_load_dwordx4 v201, s[44:47], s72 offen lds
    s_addk_i32 m0, 1056
    s_addk_i32 s72, 8192
    buffer_load_dwordx4 v201, s[44:47], s72 offen lds
    s_addk_i32 m0, 5280
    s_addk_i32 s72, 8192
    buffer_load_dwordx4 v201, s[44:47], s72 offen lds
    s_addk_i32 m0, 1056
    s_addk_i32 s72, 8192
    buffer_load_dwordx4 v201, s[44:47], s72 offen lds
    s_addk_i32 m0, 1056
    s_addk_i32 s72, 8192
    buffer_load_dwordx4 v201, s[44:47], s72 offen lds
    s_addk_i32 m0, 1056
    s_addk_i32 s72, 8192
    buffer_load_dwordx4 v201, s[44:47], s72 offen lds
    s_add_u32 s79, s79, 524288
    s_cmp_ge_u32 s79, 3670016
    s_cselect_b32 s79, 0, s79
    s_waitcnt vmcnt(8)
    s_barrier
    s_add_u32 m0, s81, 46080
    s_add_u32 s72, s80, 0
    buffer_load_dwordx4 v202, s[40:43], s72 offen lds
    s_addk_i32 m0, 1024
    s_addk_i32 s72, 7168
    buffer_load_dwordx4 v206, s[40:43], s72 offen lds
    s_addk_i32 m0, 1024
    s_addk_i32 s72, 7168
    buffer_load_dwordx4 v202, s[40:43], s72 offen lds
    s_add_u32 s80, s80, 128
    s_cmp_ge_u32 s80, 896
    s_cselect_b32 s80, 0, s80
    s_add_u32 m0, s78, 96256
    s_add_u32 s72, s79, 0
    buffer_load_dwordx4 v200, s[44:47], s72 offen lds
    s_addk_i32 m0, 1056
    s_addk_i32 s72, 8192
    buffer_load_dwordx4 v200, s[44:47], s72 offen lds
    s_addk_i32 m0, 1056
    s_addk_i32 s72, 8192
    buffer_load_dwordx4 v200, s[44:47], s72 offen lds
    s_addk_i32 m0, 1056
    s_addk_i32 s72, 8192
    buffer_load_dwordx4 v200, s[44:47], s72 offen lds
    s_addk_i32 m0, 5280
    s_addk_i32 s72, 8192
    buffer_load_dwordx4 v200, s[44:47], s72 offen lds
    s_addk_i32 m0, 1056
    s_addk_i32 s72, 8192
    buffer_load_dwordx4 v200, s[44:47], s72 offen lds
    s_addk_i32 m0, 1056
    s_addk_i32 s72, 8192
    buffer_load_dwordx4 v200, s[44:47], s72 offen lds
    s_addk_i32 m0, 1056
    s_addk_i32 s72, 8192
    buffer_load_dwordx4 v200, s[44:47], s72 offen lds
    s_waitcnt vmcnt(11)
    s_barrier
    s_add_u32 m0, s78, 130048
    s_add_u32 s72, s79, 0
    buffer_load_dwordx4 v201, s[44:47], s72 offen lds
    s_addk_i32 m0, 1056
    s_addk_i32 s72, 8192
    buffer_load_dwordx4 v201, s[44:47], s72 offen lds
    s_addk_i32 m0, 1056
    s_addk_i32 s72, 8192
    buffer_load_dwordx4 v201, s[44:47], s72 offen lds
    s_addk_i32 m0, 1056
    s_addk_i32 s72, 8192
    buffer_load_dwordx4 v201, s[44:47], s72 offen lds
    s_addk_i32 m0, 5280
    s_addk_i32 s72, 8192
    buffer_load_dwordx4 v201, s[44:47], s72 offen lds
    s_addk_i32 m0, 1056
    s_addk_i32 s72, 8192
    buffer_load_dwordx4 v201, s[44:47], s72 offen lds
    s_addk_i32 m0, 1056
    s_addk_i32 s72, 8192
    buffer_load_dwordx4 v201, s[44:47], s72 offen lds
    s_addk_i32 m0, 1056
    s_addk_i32 s72, 8192
    buffer_load_dwordx4 v201, s[44:47], s72 offen lds
    s_add_u32 s79, s79, 524288
    s_cmp_ge_u32 s79, 3670016
    s_cselect_b32 s79, 0, s79
    s_waitcnt vmcnt(8)
    s_barrier
    s_add_u32 m0, s81, 33792
    s_add_u32 s72, s80, 0
    buffer_load_dwordx4 v202, s[40:43], s72 offen lds
    s_addk_i32 m0, 1024
    s_addk_i32 s72, 7168
    buffer_load_dwordx4 v206, s[40:43], s72 offen lds
    s_addk_i32 m0, 1024
    s_addk_i32 s72, 7168
    buffer_load_dwordx4 v202, s[40:43], s72 offen lds
    s_add_u32 s80, s80, 128
    s_cmp_ge_u32 s80, 896
    s_cselect_b32 s80, 0, s80
    s_add_u32 m0, s78, 0
    s_add_u32 s72, s79, 0
    buffer_load_dwordx4 v200, s[44:47], s72 offen lds
    s_addk_i32 m0, 1056
    s_addk_i32 s72, 8192
    buffer_load_dwordx4 v200, s[44:47], s72 offen lds
    s_addk_i32 m0, 1056
    s_addk_i32 s72, 8192
    buffer_load_dwordx4 v200, s[44:47], s72 offen lds
    s_addk_i32 m0, 1056
    s_addk_i32 s72, 8192
    buffer_load_dwordx4 v200, s[44:47], s72 offen lds
    s_addk_i32 m0, 5280
    s_addk_i32 s72, 8192
    buffer_load_dwordx4 v200, s[44:47], s72 offen lds
    s_addk_i32 m0, 1056
    s_addk_i32 s72, 8192
    buffer_load_dwordx4 v200, s[44:47], s72 offen lds
    s_addk_i32 m0, 1056
    s_addk_i32 s72, 8192
    buffer_load_dwordx4 v200, s[44:47], s72 offen lds
    s_addk_i32 m0, 1056
    s_addk_i32 s72, 8192
    buffer_load_dwordx4 v200, s[44:47], s72 offen lds
    s_waitcnt vmcnt(11)
    s_barrier
    s_add_u32 m0, s78, 96256
    s_add_u32 s72, s79, 0
    buffer_load_dwordx4 v201, s[44:47], s72 offen lds
    s_addk_i32 m0, 1056
    s_addk_i32 s72, 8192
    buffer_load_dwordx4 v201, s[44:47], s72 offen lds
    s_addk_i32 m0, 1056
    s_addk_i32 s72, 8192
    buffer_load_dwordx4 v201, s[44:47], s72 offen lds
    s_addk_i32 m0, 1056
    s_addk_i32 s72, 8192
    buffer_load_dwordx4 v201, s[44:47], s72 offen lds
    s_addk_i32 m0, 5280
    s_addk_i32 s72, 8192
    buffer_load_dwordx4 v201, s[44:47], s72 offen lds
    s_addk_i32 m0, 1056
    s_addk_i32 s72, 8192
    buffer_load_dwordx4 v201, s[44:47], s72 offen lds
    s_addk_i32 m0, 1056
    s_addk_i32 s72, 8192
    buffer_load_dwordx4 v201, s[44:47], s72 offen lds
    s_addk_i32 m0, 1056
    s_addk_i32 s72, 8192
    buffer_load_dwordx4 v201, s[44:47], s72 offen lds
    s_add_u32 s79, s79, 524288
    s_cmp_ge_u32 s79, 3670016
    s_cselect_b32 s79, 0, s79
    s_waitcnt vmcnt(8)
    s_barrier
    s_add_u32 m0, s81, 46080
    s_add_u32 s72, s80, 0
    buffer_load_dwordx4 v202, s[40:43], s72 offen lds
    s_addk_i32 m0, 1024
    s_addk_i32 s72, 7168
    buffer_load_dwordx4 v206, s[40:43], s72 offen lds
    s_addk_i32 m0, 1024
    s_addk_i32 s72, 7168
    buffer_load_dwordx4 v202, s[40:43], s72 offen lds
    s_add_u32 s80, s80, 128
    s_cmp_ge_u32 s80, 896
    s_cselect_b32 s80, 0, s80
    s_add_u32 m0, s82, 62464
    s_mov_b32 s72, 0
    buffer_load_dwordx4 v203, s[48:51], s72 offen nt lds
    s_addk_i32 m0, 1056
    s_addk_i32 s72, 1024
    buffer_load_dwordx4 v203, s[48:51], s72 offen nt lds
    s_addk_i32 m0, 1056
    s_addk_i32 s72, 1024
    buffer_load_dwordx4 v203, s[48:51], s72 offen nt lds
    s_addk_i32 m0, 1056
    s_addk_i32 s72, 1024
    buffer_load_dwordx4 v203, s[48:51], s72 offen nt lds
    s_addk_i32 m0, 1056
    s_addk_i32 s72, 1024
    buffer_load_dwordx4 v203, s[48:51], s72 offen nt lds
    s_addk_i32 m0, 1056
    s_addk_i32 s72, 1024
    buffer_load_dwordx4 v203, s[48:51], s72 offen nt lds
    s_addk_i32 m0, 1056
    s_addk_i32 s72, 1024
    buffer_load_dwordx4 v203, s[48:51], s72 offen nt lds
    s_addk_i32 m0, 1056
    s_addk_i32 s72, 1024
    buffer_load_dwordx4 v203, s[48:51], s72 offen nt lds
    s_waitcnt vmcnt(11)
    s_barrier
    s_add_u32 m0, s78, 130048
    s_add_u32 s72, s79, 0
    buffer_load_dwordx4 v200, s[44:47], s72 offen lds
    s_addk_i32 m0, 1056
    s_addk_i32 s72, 8192
    buffer_load_dwordx4 v200, s[44:47], s72 offen lds
    s_addk_i32 m0, 1056
    s_addk_i32 s72, 8192
    buffer_load_dwordx4 v200, s[44:47], s72 offen lds
    s_addk_i32 m0, 1056
    s_addk_i32 s72, 8192
    buffer_load_dwordx4 v200, s[44:47], s72 offen lds
    s_addk_i32 m0, 5280
    s_addk_i32 s72, 8192
    buffer_load_dwordx4 v200, s[44:47], s72 offen lds
    s_addk_i32 m0, 1056
    s_addk_i32 s72, 8192
    buffer_load_dwordx4 v200, s[44:47], s72 offen lds
    s_addk_i32 m0, 1056
    s_addk_i32 s72, 8192
    buffer_load_dwordx4 v200, s[44:47], s72 offen lds
    s_addk_i32 m0, 1056
    s_addk_i32 s72, 8192
    buffer_load_dwordx4 v200, s[44:47], s72 offen lds
    s_add_u32 m0, s78, 0
    s_add_u32 s72, s79, 0
    buffer_load_dwordx4 v201, s[44:47], s72 offen lds
    s_addk_i32 m0, 1056
    s_addk_i32 s72, 8192
    buffer_load_dwordx4 v201, s[44:47], s72 offen lds
    s_addk_i32 m0, 1056
    s_addk_i32 s72, 8192
    buffer_load_dwordx4 v201, s[44:47], s72 offen lds
    s_addk_i32 m0, 1056
    s_addk_i32 s72, 8192
    buffer_load_dwordx4 v201, s[44:47], s72 offen lds
    s_addk_i32 m0, 5280
    s_addk_i32 s72, 8192
    buffer_load_dwordx4 v201, s[44:47], s72 offen lds
    s_addk_i32 m0, 1056
    s_addk_i32 s72, 8192
    buffer_load_dwordx4 v201, s[44:47], s72 offen lds
    s_addk_i32 m0, 1056
    s_addk_i32 s72, 8192
    buffer_load_dwordx4 v201, s[44:47], s72 offen lds
    s_addk_i32 m0, 1056
    s_addk_i32 s72, 8192
    buffer_load_dwordx4 v201, s[44:47], s72 offen lds
    s_add_u32 s79, s79, 524288
    s_cmp_ge_u32 s79, 3670016
    s_cselect_b32 s79, 0, s79
    s_waitcnt vmcnt(8)
    s_barrier
    s_add_u32 m0, s78, 96256
    s_add_u32 s72, s79, 0
    buffer_load_dwordx4 v200, s[44:47], s72 offen lds
    s_addk_i32 m0, 1056
    s_addk_i32 s72, 8192
    buffer_load_dwordx4 v200, s[44:47], s72 offen lds
    s_addk_i32 m0, 1056
    s_addk_i32 s72, 8192
    buffer_load_dwordx4 v200, s[44:47], s72 offen lds
    s_addk_i32 m0, 1056
    s_addk_i32 s72, 8192
    buffer_load_dwordx4 v200, s[44:47], s72 offen lds
    s_addk_i32 m0, 5280
    s_addk_i32 s72, 8192
    buffer_load_dwordx4 v200, s[44:47], s72 offen lds
    s_addk_i32 m0, 1056
    s_addk_i32 s72, 8192
    buffer_load_dwordx4 v200, s[44:47], s72 offen lds
    s_addk_i32 m0, 1056
    s_addk_i32 s72, 8192
    buffer_load_dwordx4 v200, s[44:47], s72 offen lds
    s_addk_i32 m0, 1056
    s_addk_i32 s72, 8192
    buffer_load_dwordx4 v200, s[44:47], s72 offen lds
    s_add_u32 m0, s81, 33792
    s_add_u32 s72, s80, 0
    buffer_load_dwordx4 v202, s[40:43], s72 offen lds
    s_addk_i32 m0, 1024
    s_addk_i32 s72, 7168
    buffer_load_dwordx4 v206, s[40:43], s72 offen lds
    s_addk_i32 m0, 1024
    s_addk_i32 s72, 7168
    buffer_load_dwordx4 v202, s[40:43], s72 offen lds
    s_add_u32 s80, s80, 128
    s_cmp_ge_u32 s80, 896
    s_cselect_b32 s80, 0, s80
    s_waitcnt vmcnt(11)
    s_barrier
    s_mov_b32 s73, 16384
    buffer_load_dwordx4 v[0:3], v203, s[48:51], s73 offen offset:0 nt
    s_mov_b32 s73, 16384
    buffer_load_dwordx4 v[4:7], v203, s[48:51], s73 offen offset:1024 nt
    s_mov_b32 s73, 16384
    buffer_load_dwordx4 v[8:11], v203, s[48:51], s73 offen offset:2048 nt
    s_mov_b32 s73, 16384
    buffer_load_dwordx4 v[12:15], v203, s[48:51], s73 offen offset:3072 nt
    s_mov_b32 s73, 20480
    buffer_load_dwordx4 v[16:19], v203, s[48:51], s73 offen offset:0 nt
    s_mov_b32 s73, 20480
    buffer_load_dwordx4 v[20:23], v203, s[48:51], s73 offen offset:1024 nt
    s_mov_b32 s73, 20480
    buffer_load_dwordx4 v[24:27], v203, s[48:51], s73 offen offset:2048 nt
    s_mov_b32 s73, 20480
    buffer_load_dwordx4 v[28:31], v203, s[48:51], s73 offen offset:3072 nt
    s_waitcnt vmcnt(8)
    s_barrier
    s_add_u32 m0, s78, 130048
    s_add_u32 s72, s79, 0
    buffer_load_dwordx4 v201, s[44:47], s72 offen lds
    s_addk_i32 m0, 1056
    s_addk_i32 s72, 8192
    buffer_load_dwordx4 v201, s[44:47], s72 offen lds
    s_addk_i32 m0, 1056
    s_addk_i32 s72, 8192
    buffer_load_dwordx4 v201, s[44:47], s72 offen lds
    s_addk_i32 m0, 1056
    s_addk_i32 s72, 8192
    buffer_load_dwordx4 v201, s[44:47], s72 offen lds
    s_addk_i32 m0, 5280
    s_addk_i32 s72, 8192
    buffer_load_dwordx4 v201, s[44:47], s72 offen lds
    s_addk_i32 m0, 1056
    s_addk_i32 s72, 8192
    buffer_load_dwordx4 v201, s[44:47], s72 offen lds
    s_addk_i32 m0, 1056
    s_addk_i32 s72, 8192
    buffer_load_dwordx4 v201, s[44:47], s72 offen lds
    s_addk_i32 m0, 1056
    s_addk_i32 s72, 8192
    buffer_load_dwordx4 v201, s[44:47], s72 offen lds
    s_add_u32 s79, s79, 524288
    s_cmp_ge_u32 s79, 3670016
    s_cselect_b32 s79, 0, s79
    s_add_u32 m0, s81, 46080
    s_add_u32 s72, s80, 0
    buffer_load_dwordx4 v202, s[40:43], s72 offen lds
    s_addk_i32 m0, 1024
    s_addk_i32 s72, 7168
    buffer_load_dwordx4 v206, s[40:43], s72 offen lds
    s_addk_i32 m0, 1024
    s_addk_i32 s72, 7168
    buffer_load_dwordx4 v202, s[40:43], s72 offen lds
    s_add_u32 s80, s80, 128
    s_cmp_ge_u32 s80, 896
    s_cselect_b32 s80, 0, s80
    s_add_u32 m0, s78, 0
    s_add_u32 s72, s79, 0
    buffer_load_dwordx4 v200, s[44:47], s72 offen lds
    s_addk_i32 m0, 1056
    s_addk_i32 s72, 8192
    buffer_load_dwordx4 v200, s[44:47], s72 offen lds
    s_addk_i32 m0, 1056
    s_addk_i32 s72, 8192
    buffer_load_dwordx4 v200, s[44:47], s72 offen lds
    s_addk_i32 m0, 1056
    s_addk_i32 s72, 8192
    buffer_load_dwordx4 v200, s[44:47], s72 offen lds
    s_addk_i32 m0, 5280
    s_addk_i32 s72, 8192
    buffer_load_dwordx4 v200, s[44:47], s72 offen lds
    s_addk_i32 m0, 1056
    s_addk_i32 s72, 8192
    buffer_load_dwordx4 v200, s[44:47], s72 offen lds
    s_addk_i32 m0, 1056
    s_addk_i32 s72, 8192
    buffer_load_dwordx4 v200, s[44:47], s72 offen lds
    s_addk_i32 m0, 1056
    s_addk_i32 s72, 8192
    buffer_load_dwordx4 v200, s[44:47], s72 offen lds
    s_waitcnt vmcnt(11)
    s_barrier
    s_add_u32 m0, s78, 96256
    s_add_u32 s72, s79, 0
    buffer_load_dwordx4 v201, s[44:47], s72 offen lds
    s_addk_i32 m0, 1056
    s_addk_i32 s72, 8192
    buffer_load_dwordx4 v201, s[44:47], s72 offen lds
    s_addk_i32 m0, 1056
    s_addk_i32 s72, 8192
    buffer_load_dwordx4 v201, s[44:47], s72 offen lds
    s_addk_i32 m0, 1056
    s_addk_i32 s72, 8192
    buffer_load_dwordx4 v201, s[44:47], s72 offen lds
    s_addk_i32 m0, 5280
    s_addk_i32 s72, 8192
    buffer_load_dwordx4 v201, s[44:47], s72 offen lds
    s_addk_i32 m0, 1056
    s_addk_i32 s72, 8192
    buffer_load_dwordx4 v201, s[44:47], s72 offen lds
    s_addk_i32 m0, 1056
    s_addk_i32 s72, 8192
    buffer_load_dwordx4 v201, s[44:47], s72 offen lds
    s_addk_i32 m0, 1056
    s_addk_i32 s72, 8192
    buffer_load_dwordx4 v201, s[44:47], s72 offen lds
    s_add_u32 s79, s79, 524288
    s_cmp_ge_u32 s79, 3670016
    s_cselect_b32 s79, 0, s79
    s_waitcnt vmcnt(8)
    s_barrier
    s_add_u32 m0, s81, 33792
    s_add_u32 s72, s80, 0
    buffer_load_dwordx4 v202, s[40:43], s72 offen lds
    s_addk_i32 m0, 1024
    s_addk_i32 s72, 7168
    buffer_load_dwordx4 v206, s[40:43], s72 offen lds
    s_addk_i32 m0, 1024
    s_addk_i32 s72, 7168
    buffer_load_dwordx4 v202, s[40:43], s72 offen lds
    s_add_u32 s80, s80, 128
    s_cmp_ge_u32 s80, 896
    s_cselect_b32 s80, 0, s80
    s_mov_b32 s73, 32768
    buffer_load_dwordx4 v[32:35], v203, s[48:51], s73 offen offset:0 nt
    s_mov_b32 s73, 32768
    buffer_load_dwordx4 v[36:39], v203, s[48:51], s73 offen offset:1024 nt
    s_mov_b32 s73, 32768
    buffer_load_dwordx4 v[40:43], v203, s[48:51], s73 offen offset:2048 nt
    s_mov_b32 s73, 32768
    buffer_load_dwordx4 v[44:47], v203, s[48:51], s73 offen offset:3072 nt
    s_mov_b32 s73, 36864
    buffer_load_dwordx4 v[48:51], v203, s[48:51], s73 offen offset:0 nt
    s_mov_b32 s73, 36864
    buffer_load_dwordx4 v[52:55], v203, s[48:51], s73 offen offset:1024 nt
    s_mov_b32 s73, 36864
    buffer_load_dwordx4 v[56:59], v203, s[48:51], s73 offen offset:2048 nt
    s_mov_b32 s73, 36864
    buffer_load_dwordx4 v[60:63], v203, s[48:51], s73 offen offset:3072 nt
    s_waitcnt vmcnt(11)
    s_barrier
    s_add_u32 m0, s78, 130048
    s_add_u32 s72, s79, 0
    buffer_load_dwordx4 v200, s[44:47], s72 offen lds
    s_addk_i32 m0, 1056
    s_addk_i32 s72, 8192
    buffer_load_dwordx4 v200, s[44:47], s72 offen lds
    s_addk_i32 m0, 1056
    s_addk_i32 s72, 8192
    buffer_load_dwordx4 v200, s[44:47], s72 offen lds
    s_addk_i32 m0, 1056
    s_addk_i32 s72, 8192
    buffer_load_dwordx4 v200, s[44:47], s72 offen lds
    s_addk_i32 m0, 5280
    s_addk_i32 s72, 8192
    buffer_load_dwordx4 v200, s[44:47], s72 offen lds
    s_addk_i32 m0, 1056
    s_addk_i32 s72, 8192
    buffer_load_dwordx4 v200, s[44:47], s72 offen lds
    s_addk_i32 m0, 1056
    s_addk_i32 s72, 8192
    buffer_load_dwordx4 v200, s[44:47], s72 offen lds
    s_addk_i32 m0, 1056
    s_addk_i32 s72, 8192
    buffer_load_dwordx4 v200, s[44:47], s72 offen lds
    s_add_u32 m0, s78, 0
    s_add_u32 s72, s79, 0
    buffer_load_dwordx4 v201, s[44:47], s72 offen lds
    s_addk_i32 m0, 1056
    s_addk_i32 s72, 8192
    buffer_load_dwordx4 v201, s[44:47], s72 offen lds
    s_addk_i32 m0, 1056
    s_addk_i32 s72, 8192
    buffer_load_dwordx4 v201, s[44:47], s72 offen lds
    s_addk_i32 m0, 1056
    s_addk_i32 s72, 8192
    buffer_load_dwordx4 v201, s[44:47], s72 offen lds
    s_addk_i32 m0, 5280
    s_addk_i32 s72, 8192
    buffer_load_dwordx4 v201, s[44:47], s72 offen lds
    s_addk_i32 m0, 1056
    s_addk_i32 s72, 8192
    buffer_load_dwordx4 v201, s[44:47], s72 offen lds
    s_addk_i32 m0, 1056
    s_addk_i32 s72, 8192
    buffer_load_dwordx4 v201, s[44:47], s72 offen lds
    s_addk_i32 m0, 1056
    s_addk_i32 s72, 8192
    buffer_load_dwordx4 v201, s[44:47], s72 offen lds
    s_add_u32 s79, s79, 524288
    s_cmp_ge_u32 s79, 3670016
    s_cselect_b32 s79, 0, s79
    s_waitcnt vmcnt(8)
L_merge:
    s_barrier
    s_mov_b32 s73, 0
    buffer_load_dwordx4 v[64:67], v204, s[52:55], s73 offen offset:0 nt
    s_mov_b32 s73, 0
    buffer_load_dwordx4 v[68:71], v204, s[52:55], s73 offen offset:512 nt
    s_mov_b32 s73, 16384
    buffer_load_dwordx4 v[72:75], v204, s[52:55], s73 offen offset:0 nt
    s_mov_b32 s73, 16384
    buffer_load_dwordx4 v[76:79], v204, s[52:55], s73 offen offset:512 nt
    s_mov_b32 s73, 32768
    buffer_load_dwordx4 v[80:83], v204, s[52:55], s73 offen offset:0 nt
    s_mov_b32 s73, 32768
    buffer_load_dwordx4 v[84:87], v204, s[52:55], s73 offen offset:512 nt
    s_mov_b32 s73, 49152
    buffer_load_dwordx4 v[88:91], v204, s[52:55], s73 offen offset:0 nt
    s_mov_b32 s73, 49152
    buffer_load_dwordx4 v[92:95], v204, s[52:55], s73 offen offset:512 nt
    ds_write_b128 v212, v[0:3] offset:0
    ds_write_b128 v212, v[4:7] offset:1056
    ds_write_b128 v212, v[8:11] offset:2112
    s_waitcnt vmcnt(8)
    s_barrier
    s_mov_b32 s73, 65536
    buffer_load_dwordx4 v[96:99], v204, s[52:55], s73 offen offset:0 nt
    s_mov_b32 s73, 65536
    buffer_load_dwordx4 v[100:103], v204, s[52:55], s73 offen offset:512 nt
    ds_write_b128 v212, v[12:15] offset:3168
    ds_write_b128 v212, v[16:19] offset:4224
    ds_write_b128 v212, v[20:23] offset:5280
    ds_write_b128 v212, v[24:27] offset:6336
    ds_write_b128 v212, v[28:31] offset:7392
    s_barrier
    s_mov_b32 s73, 81920
    buffer_load_dwordx4 v[104:107], v204, s[52:55], s73 offen offset:0 nt
    s_mov_b32 s73, 81920
    buffer_load_dwordx4 v[108:111], v204, s[52:55], s73 offen offset:512 nt
    s_add_u32 m0, s89, 50688
    s_mov_b32 s72, 0
    buffer_load_dwordx4 v205, s[52:55], s72 offen nt lds
    s_addk_i32 m0, 1056
    s_addk_i32 s72, 512
    buffer_load_dwordx4 v205, s[52:55], s72 offen nt lds
    ds_write_b128 v212, v[32:35] offset:33792
    ds_write_b128 v212, v[36:39] offset:34848
    ds_write_b128 v212, v[40:43] offset:35904
    ds_write_b128 v212, v[44:47] offset:36960
    ds_write_b128 v212, v[48:51] offset:38016
    s_waitcnt lgkmcnt(0)
    s_barrier
    s_add_u32 m0, s89, 59136
    s_mov_b32 s72, 16384
    buffer_load_dwordx4 v205, s[52:55], s72 offen nt lds
    s_addk_i32 m0, 1056
    s_addk_i32 s72, 512
    buffer_load_dwordx4 v205, s[52:55], s72 offen nt lds
    s_addk_i32 m0, 7392
    s_addk_i32 s72, 15872
    buffer_load_dwordx4 v205, s[52:55], s72 offen nt lds
    s_addk_i32 m0, 1056
    s_addk_i32 s72, 512
    buffer_load_dwordx4 v205, s[52:55], s72 offen nt lds
    s_addk_i32 m0, 7392
    s_addk_i32 s72, 15872
    buffer_load_dwordx4 v205, s[52:55], s72 offen nt lds
    s_addk_i32 m0, 1056
    s_addk_i32 s72, 512
    buffer_load_dwordx4 v205, s[52:55], s72 offen nt lds
    ds_write_b128 v212, v[52:55] offset:39072
    ds_write_b128 v212, v[56:59] offset:40128
    ds_write_b128 v212, v[60:63] offset:41184
    s_waitcnt lgkmcnt(0)
    s_barrier
    s_waitcnt vmcnt(19)
    ds_write_b128 v211, v[64:67] offset:0
    s_waitcnt vmcnt(18)
    ds_write_b128 v211, v[68:71] offset:1056
    s_waitcnt vmcnt(17)
    ds_write_b128 v211, v[72:75] offset:8448
    s_waitcnt vmcnt(16)
    ds_write_b128 v211, v[76:79] offset:9504
    s_waitcnt vmcnt(15)
    ds_write_b128 v211, v[80:83] offset:16896
    s_add_u32 m0, s89, 84480
    s_mov_b32 s72, 65536
    buffer_load_dwordx4 v205, s[52:55], s72 offen nt lds
    s_addk_i32 m0, 1056
    s_addk_i32 s72, 512
    buffer_load_dwordx4 v205, s[52:55], s72 offen nt lds
    s_addk_i32 m0, 7392
    s_addk_i32 s72, 15872
    buffer_load_dwordx4 v205, s[52:55], s72 offen nt lds
    s_addk_i32 m0, 1056
    s_addk_i32 s72, 512
    buffer_load_dwordx4 v205, s[52:55], s72 offen nt lds
    s_barrier
    s_waitcnt vmcnt(18)
    ds_write_b128 v211, v[84:87] offset:17952
    s_waitcnt vmcnt(17)
    ds_write_b128 v211, v[88:91] offset:25344
    s_waitcnt vmcnt(16)
    ds_write_b128 v211, v[92:95] offset:26400
    s_waitcnt vmcnt(15)
    ds_write_b128 v211, v[96:99] offset:33792
    s_waitcnt vmcnt(14)
    ds_write_b128 v211, v[100:103] offset:34848
    s_waitcnt vmcnt(13)
    ds_write_b128 v211, v[104:107] offset:42240
    s_waitcnt vmcnt(12)
    ds_write_b128 v211, v[108:111] offset:43296
    s_add_u32 s83, s33, 128
    s_sub_u32 s72, s83, 896
    s_cselect_b32 s83, s83, s72
    s_add_u32 m0, s82, 101376
    s_add_u32 s72, s83, 0
    buffer_load_dwordx4 v213, s[56:59], s72 offen lds
    s_addk_i32 m0, 1056
    s_addk_i32 s72, 896
    buffer_load_dwordx4 v213, s[56:59], s72 offen lds
    s_addk_i32 m0, 1056
    s_addk_i32 s72, 896
    buffer_load_dwordx4 v213, s[56:59], s72 offen lds
    s_addk_i32 m0, 1056
    s_addk_i32 s72, 896
    buffer_load_dwordx4 v213, s[56:59], s72 offen lds
    s_addk_i32 m0, 1056
    s_addk_i32 s72, 896
    buffer_load_dwordx4 v213, s[56:59], s72 offen lds
    s_addk_i32 m0, 1056
    s_addk_i32 s72, 896
    buffer_load_dwordx4 v213, s[56:59], s72 offen lds
    s_addk_i32 m0, 1056
    s_addk_i32 s72, 896
    buffer_load_dwordx4 v213, s[56:59], s72 offen lds
    s_addk_i32 m0, 1056
    s_addk_i32 s72, 896
    buffer_load_dwordx4 v213, s[56:59], s72 offen lds
    s_waitcnt lgkmcnt(0)
    s_barrier
    s_barrier
    s_waitcnt vmcnt(8)
    s_barrier
    s_add_u32 s73, s13, 5
    s_sub_u32 s74, s73, 7
    s_cselect_b32 s73, s73, s74
    s_cmp_eq_u32 s12, 7
    s_cselect_b32 s74, 3, 5
    s_mul_i32 s73, s73, 7
    s_add_u32 s73, s73, s74
    s_mul_i32 s73, s73, 12288
    buffer_store_dwordx4 v[224:227], v232, s[60:63], s73 offen offset:0 sc1
    buffer_store_dwordx4 v[224:227], v232, s[60:63], s73 offen offset:1024 sc1
    buffer_store_dwordx4 v[224:227], v232, s[60:63], s73 offen offset:2048 sc1
    s_barrier
    s_add_u32 s83, s33, 128
    s_sub_u32 s72, s83, 896
    s_cselect_b32 s83, s83, s72
    s_add_u32 m0, s82, 0
    s_add_u32 s72, s83, 0
    buffer_load_dwordx4 v214, s[56:59], s72 offen lds
    s_addk_i32 m0, 1056
    s_addk_i32 s72, 896
    buffer_load_dwordx4 v214, s[56:59], s72 offen lds
    s_addk_i32 m0, 1056
    s_addk_i32 s72, 896
    buffer_load_dwordx4 v214, s[56:59], s72 offen lds
    s_addk_i32 m0, 1056
    s_addk_i32 s72, 896
    buffer_load_dwordx4 v214, s[56:59], s72 offen lds
    s_addk_i32 m0, 1056
    s_addk_i32 s72, 896
    buffer_load_dwordx4 v214, s[56:59], s72 offen lds
    s_addk_i32 m0, 1056
    s_addk_i32 s72, 896
    buffer_load_dwordx4 v214, s[56:59], s72 offen lds
    s_addk_i32 m0, 1056
    s_addk_i32 s72, 896
    buffer_load_dwordx4 v214, s[56:59], s72 offen lds
    s_addk_i32 m0, 1056
    s_addk_i32 s72, 896
    buffer_load_dwordx4 v214, s[56:59], s72 offen lds
    s_barrier
    s_add_u32 s73, s13, 6
    s_sub_u32 s74, s73, 7
    s_cselect_b32 s73, s73, s74
    s_cmp_eq_u32 s12, 7
    s_cselect_b32 s74, 3, 6
    s_mul_i32 s73, s73, 7
    s_add_u32 s73, s73, s74
    s_mul_i32 s73, s73, 12288
    buffer_store_dwordx4 v[224:227], v232, s[60:63], s73 offen offset:0 sc1
    buffer_store_dwordx4 v[224:227], v232, s[60:63], s73 offen offset:1024 sc1
    buffer_store_dwordx4 v[224:227], v232, s[60:63], s73 offen offset:2048 sc1
    s_add_u32 s83, s33, 768
    s_sub_u32 s72, s83, 896
    s_cselect_b32 s83, s83, s72
    s_add_u32 s72, s83, 3584
    buffer_load_dwordx4 v[0:3], v214, s[56:59], s72 offen
    s_add_u32 s72, s83, 4480
    buffer_load_dwordx4 v[4:7], v214, s[56:59], s72 offen
    s_add_u32 s72, s83, 5376
    buffer_load_dwordx4 v[8:11], v214, s[56:59], s72 offen
    s_add_u32 s72, s83, 6272
    buffer_load_dwordx4 v[12:15], v214, s[56:59], s72 offen
    s_barrier
    s_add_u32 s73, s13, 7
    s_sub_u32 s74, s73, 7
    s_cselect_b32 s73, s73, s74
    s_cmp_eq_u32 s12, 7
    s_cselect_b32 s74, 3, 7
    s_mul_i32 s73, s73, 7
    s_add_u32 s73, s73, s74
    s_mul_i32 s73, s73, 12288
    s_cmp_eq_u32 s12, 7
    s_cselect_b64 exec, -1, 0
    buffer_store_dwordx4 v[224:227], v232, s[60:63], s73 offen offset:0 sc1
    buffer_store_dwordx4 v[224:227], v232, s[60:63], s73 offen offset:1024 sc1
    buffer_store_dwordx4 v[224:227], v232, s[60:63], s73 offen offset:2048 sc1
    s_mov_b64 exec, -1
    s_add_u32 s83, s33, 896
    s_sub_u32 s72, s83, 896
    s_cselect_b32 s83, s83, s72
    s_add_u32 s72, s83, 896
    buffer_load_dwordx4 v[16:19], v214, s[56:59], s72 offen
    s_add_u32 s72, s83, 1792
    buffer_load_dwordx4 v[20:23], v214, s[56:59], s72 offen
    s_add_u32 s72, s83, 2688
    buffer_load_dwordx4 v[24:27], v214, s[56:59], s72 offen
    s_add_u32 s72, s83, 3584
    buffer_load_dwordx4 v[28:31], v214, s[56:59], s72 offen
    s_lshl_b32 s73, s90, 2
    buffer_load_dword v216, off, s[96:99], s73 offset:128 sc1
    s_waitcnt vmcnt(26)
    s_barrier
    s_add_u32 s83, s33, 896
    s_sub_u32 s72, s83, 896
    s_cselect_b32 s83, s83, s72
    s_add_u32 s72, s83, 4480
    buffer_load_dwordx4 v[32:35], v214, s[56:59], s72 offen
    s_add_u32 s72, s83, 5376
    buffer_load_dwordx4 v[36:39], v214, s[56:59], s72 offen
    s_add_u32 s72, s83, 6272
    buffer_load_dwordx4 v[40:43], v214, s[56:59], s72 offen
    s_barrier
    s_waitcnt vmcnt(3)
    v_cmp_gt_u32 vcc, 8, v216
    s_cbranch_vccz L_ok0
    s_mov_b32 s100, 200000
L_sp0:
    s_lshl_b32 s73, s90, 2
    buffer_load_dword v216, off, s[96:99], s73 offset:128 sc1
    s_waitcnt vmcnt(0)
    v_cmp_gt_u32 vcc, 8, v216
    s_sub_u32 s100, s100, 1
    s_cbranch_scc1 L_ok0
    s_cbranch_vccnz L_sp0
L_ok0:
    s_add_u32 s83, s33, 256
    s_sub_u32 s72, s83, 896
    s_cselect_b32 s83, s83, s72
    s_add_u32 m0, s82, 33792
    s_add_u32 s72, s83, 0
    buffer_load_dwordx4 v213, s[56:59], s72 offen lds
    s_addk_i32 m0, 1056
    s_addk_i32 s72, 896
    buffer_load_dwordx4 v213, s[56:59], s72 offen lds
    s_addk_i32 m0, 1056
    s_addk_i32 s72, 896
    buffer_load_dwordx4 v213, s[56:59], s72 offen lds
    s_addk_i32 m0, 1056
    s_addk_i32 s72, 896
    buffer_load_dwordx4 v213, s[56:59], s72 offen lds
    s_addk_i32 m0, 1056
    s_addk_i32 s72, 896
    buffer_load_dwordx4 v213, s[56:59], s72 offen lds
    s_addk_i32 m0, 1056
    s_addk_i32 s72, 896
    buffer_load_dwordx4 v213, s[56:59], s72 offen lds
    s_addk_i32 m0, 1056
    s_addk_i32 s72, 896
    buffer_load_dwordx4 v213, s[56:59], s72 offen lds
    s_addk_i32 m0, 1056
    s_addk_i32 s72, 896
    buffer_load_dwordx4 v213, s[56:59], s72 offen lds
    s_barrier
    s_add_u32 s83, s33, 256
    s_sub_u32 s72, s83, 896
    s_cselect_b32 s83, s83, s72
    s_add_u32 m0, s82, 67584
    s_add_u32 s72, s83, 0
    buffer_load_dwordx4 v214, s[56:59], s72 offen lds
    s_addk_i32 m0, 1056
    s_addk_i32 s72, 896
    buffer_load_dwordx4 v214, s[56:59], s72 offen lds
    s_addk_i32 m0, 1056
    s_addk_i32 s72, 896
    buffer_load_dwordx4 v214, s[56:59], s72 offen lds
    s_addk_i32 m0, 1056
    s_addk_i32 s72, 896
    buffer_load_dwordx4 v214, s[56:59], s72 offen lds
    s_addk_i32 m0, 1056
    s_addk_i32 s72, 896
    buffer_load_dwordx4 v214, s[56:59], s72 offen lds
    s_addk_i32 m0, 1056
    s_addk_i32 s72, 896
    buffer_load_dwordx4 v214, s[56:59], s72 offen lds
    s_addk_i32 m0, 1056
    s_addk_i32 s72, 896
    buffer_load_dwordx4 v214, s[56:59], s72 offen lds
    s_addk_i32 m0, 1056
    s_addk_i32 s72, 896
    buffer_load_dwordx4 v214, s[56:59], s72 offen lds
    s_add_u32 s83, s33, 384
    s_sub_u32 s72, s83, 896
    s_cselect_b32 s83, s83, s72
    s_add_u32 m0, s82, 101376
    s_add_u32 s72, s83, 0
    buffer_load_dwordx4 v213, s[56:59], s72 offen lds
    s_addk_i32 m0, 1056
    s_addk_i32 s72, 896
    buffer_load_dwordx4 v213, s[56:59], s72 offen lds
    s_addk_i32 m0, 1056
    s_addk_i32 s72, 896
    buffer_load_dwordx4 v213, s[56:59], s72 offen lds
    s_addk_i32 m0, 1056
    s_addk_i32 s72, 896
    buffer_load_dwordx4 v213, s[56:59], s72 offen lds
    s_addk_i32 m0, 1056
    s_addk_i32 s72, 896
    buffer_load_dwordx4 v213, s[56:59], s72 offen lds
    s_addk_i32 m0, 1056
    s_addk_i32 s72, 896
    buffer_load_dwordx4 v213, s[56:59], s72 offen lds
    s_addk_i32 m0, 1056
    s_addk_i32 s72, 896
    buffer_load_dwordx4 v213, s[56:59], s72 offen lds
    s_addk_i32 m0, 1056
    s_addk_i32 s72, 896
    buffer_load_dwordx4 v213, s[56:59], s72 offen lds
    s_waitcnt vmcnt(16)
    s_barrier
    s_add_u32 s83, s33, 384
    s_sub_u32 s72, s83, 896
    s_cselect_b32 s83, s83, s72
    s_add_u32 m0, s82, 0
    s_add_u32 s72, s83, 0
    buffer_load_dwordx4 v214, s[56:59], s72 offen lds
    s_addk_i32 m0, 1056
    s_addk_i32 s72, 896
    buffer_load_dwordx4 v214, s[56:59], s72 offen lds
    s_addk_i32 m0, 1056
    s_addk_i32 s72, 896
    buffer_load_dwordx4 v214, s[56:59], s72 offen lds
    s_addk_i32 m0, 1056
    s_addk_i32 s72, 896
    buffer_load_dwordx4 v214, s[56:59], s72 offen lds
    s_addk_i32 m0, 1056
    s_addk_i32 s72, 896
    buffer_load_dwordx4 v214, s[56:59], s72 offen lds
    s_addk_i32 m0, 1056
    s_addk_i32 s72, 896
    buffer_load_dwordx4 v214, s[56:59], s72 offen lds
    s_addk_i32 m0, 1056
    s_addk_i32 s72, 896
    buffer_load_dwordx4 v214, s[56:59], s72 offen lds
    s_addk_i32 m0, 1056
    s_addk_i32 s72, 896
    buffer_load_dwordx4 v214, s[56:59], s72 offen lds
    s_waitcnt vmcnt(16)
    s_barrier
    s_add_u32 s83, s33, 512
    s_sub_u32 s72, s83, 896
    s_cselect_b32 s83, s83, s72
    s_add_u32 m0, s82, 33792
    s_add_u32 s72, s83, 0
    buffer_load_dwordx4 v213, s[56:59], s72 offen lds
    s_addk_i32 m0, 1056
    s_addk_i32 s72, 896
    buffer_load_dwordx4 v213, s[56:59], s72 offen lds
    s_addk_i32 m0, 1056
    s_addk_i32 s72, 896
    buffer_load_dwordx4 v213, s[56:59], s72 offen lds
    s_addk_i32 m0, 1056
    s_addk_i32 s72, 896
    buffer_load_dwordx4 v213, s[56:59], s72 offen lds
    s_addk_i32 m0, 1056
    s_addk_i32 s72, 896
    buffer_load_dwordx4 v213, s[56:59], s72 offen lds
    s_addk_i32 m0, 1056
    s_addk_i32 s72, 896
    buffer_load_dwordx4 v213, s[56:59], s72 offen lds
    s_addk_i32 m0, 1056
    s_addk_i32 s72, 896
    buffer_load_dwordx4 v213, s[56:59], s72 offen lds
    s_addk_i32 m0, 1056
    s_addk_i32 s72, 896
    buffer_load_dwordx4 v213, s[56:59], s72 offen lds
    s_waitcnt vmcnt(16)
    s_barrier
    s_add_u32 s83, s33, 512
    s_sub_u32 s72, s83, 896
    s_cselect_b32 s83, s83, s72
    s_add_u32 m0, s82, 67584
    s_add_u32 s72, s83, 0
    buffer_load_dwordx4 v214, s[56:59], s72 offen lds
    s_addk_i32 m0, 1056
    s_addk_i32 s72, 896
    buffer_load_dwordx4 v214, s[56:59], s72 offen lds
    s_addk_i32 m0, 1056
    s_addk_i32 s72, 896
    buffer_load_dwordx4 v214, s[56:59], s72 offen lds
    s_addk_i32 m0, 1056
    s_addk_i32 s72, 896
    buffer_load_dwordx4 v214, s[56:59], s72 offen lds
    s_addk_i32 m0, 1056
    s_addk_i32 s72, 896
    buffer_load_dwordx4 v214, s[56:59], s72 offen lds
    s_addk_i32 m0, 1056
    s_addk_i32 s72, 896
    buffer_load_dwordx4 v214, s[56:59], s72 offen lds
    s_addk_i32 m0, 1056
    s_addk_i32 s72, 896
    buffer_load_dwordx4 v214, s[56:59], s72 offen lds
    s_addk_i32 m0, 1056
    s_addk_i32 s72, 896
    buffer_load_dwordx4 v214, s[56:59], s72 offen lds
    s_waitcnt vmcnt(16)
    s_barrier
    s_add_u32 s83, s33, 640
    s_sub_u32 s72, s83, 896
    s_cselect_b32 s83, s83, s72
    s_add_u32 m0, s82, 101376
    s_add_u32 s72, s83, 0
    buffer_load_dwordx4 v213, s[56:59], s72 offen lds
    s_addk_i32 m0, 1056
    s_addk_i32 s72, 896
    buffer_load_dwordx4 v213, s[56:59], s72 offen lds
    s_addk_i32 m0, 1056
    s_addk_i32 s72, 896
    buffer_load_dwordx4 v213, s[56:59], s72 offen lds
    s_addk_i32 m0, 1056
    s_addk_i32 s72, 896
    buffer_load_dwordx4 v213, s[56:59], s72 offen lds
    s_addk_i32 m0, 1056
    s_addk_i32 s72, 896
    buffer_load_dwordx4 v213, s[56:59], s72 offen lds
    s_addk_i32 m0, 1056
    s_addk_i32 s72, 896
    buffer_load_dwordx4 v213, s[56:59], s72 offen lds
    s_addk_i32 m0, 1056
    s_addk_i32 s72, 896
    buffer_load_dwordx4 v213, s[56:59], s72 offen lds
    s_addk_i32 m0, 1056
    s_addk_i32 s72, 896
    buffer_load_dwordx4 v213, s[56:59], s72 offen lds
    s_waitcnt vmcnt(16)
    s_barrier
    s_add_u32 s83, s33, 640
    s_sub_u32 s72, s83, 896
    s_cselect_b32 s83, s83, s72
    s_add_u32 m0, s82, 0
    s_add_u32 s72, s83, 0
    buffer_load_dwordx4 v214, s[56:59], s72 offen lds
    s_addk_i32 m0, 1056
    s_addk_i32 s72, 896
    buffer_load_dwordx4 v214, s[56:59], s72 offen lds
    s_addk_i32 m0, 1056
    s_addk_i32 s72, 896
    buffer_load_dwordx4 v214, s[56:59], s72 offen lds
    s_addk_i32 m0, 1056
    s_addk_i32 s72, 896
    buffer_load_dwordx4 v214, s[56:59], s72 offen lds
    s_addk_i32 m0, 1056
    s_addk_i32 s72, 896
    buffer_load_dwordx4 v214, s[56:59], s72 offen lds
    s_addk_i32 m0, 1056
    s_addk_i32 s72, 896
    buffer_load_dwordx4 v214, s[56:59], s72 offen lds
    s_addk_i32 m0, 1056
    s_addk_i32 s72, 896
    buffer_load_dwordx4 v214, s[56:59], s72 offen lds
    s_addk_i32 m0, 1056
    s_addk_i32 s72, 896
    buffer_load_dwordx4 v214, s[56:59], s72 offen lds
    s_waitcnt vmcnt(16)
    s_barrier
    s_add_u32 s83, s33, 768
    s_sub_u32 s72, s83, 896
    s_cselect_b32 s83, s83, s72
    s_add_u32 m0, s82, 33792
    s_add_u32 s72, s83, 0
    buffer_load_dwordx4 v213, s[56:59], s72 offen lds
    s_addk_i32 m0, 1056
    s_addk_i32 s72, 896
    buffer_load_dwordx4 v213, s[56:59], s72 offen lds
    s_addk_i32 m0, 1056
    s_addk_i32 s72, 896
    buffer_load_dwordx4 v213, s[56:59], s72 offen lds
    s_addk_i32 m0, 1056
    s_addk_i32 s72, 896
    buffer_load_dwordx4 v213, s[56:59], s72 offen lds
    s_addk_i32 m0, 1056
    s_addk_i32 s72, 896
    buffer_load_dwordx4 v213, s[56:59], s72 offen lds
    s_addk_i32 m0, 1056
    s_addk_i32 s72, 896
    buffer_load_dwordx4 v213, s[56:59], s72 offen lds
    s_addk_i32 m0, 1056
    s_addk_i32 s72, 896
    buffer_load_dwordx4 v213, s[56:59], s72 offen lds
    s_addk_i32 m0, 1056
    s_addk_i32 s72, 896
    buffer_load_dwordx4 v213, s[56:59], s72 offen lds
    s_load_dwordx8 s[16:23], s[14:15], s32 offset:0 glc
    s_waitcnt vmcnt(16)
    s_barrier
    s_add_u32 s83, s33, 768
    s_sub_u32 s72, s83, 896
    s_cselect_b32 s83, s83, s72
    s_add_u32 m0, s82, 67584
    s_add_u32 s72, s83, 0
    buffer_load_dwordx4 v214, s[56:59], s72 offen lds
    s_addk_i32 m0, 1056
    s_addk_i32 s72, 896
    buffer_load_dwordx4 v214, s[56:59], s72 offen lds
    s_addk_i32 m0, 1056
    s_addk_i32 s72, 896
    buffer_load_dwordx4 v214, s[56:59], s72 offen lds
    s_addk_i32 m0, 1056
    s_addk_i32 s72, 896
    buffer_load_dwordx4 v214, s[56:59], s72 offen lds
    s_cmp_lg_u32 s12, 7
    s_cselect_b64 s[40:41], -1, 0
    s_mov_b64 s[42:43], s[40:41]
    s_mov_b64 s[44:45], s[40:41]
    s_mov_b32 s46, s40
    s_mov_b32 s47, 0
    s_lshr_b32 s72, 0x61, s12
    s_bitcmp1_b32 s72, 0
    s_cselect_b32 s51, -1, 0
    s_mov_b32 s50, 0
    s_mov_b32 s53, s40
    s_mov_b32 s52, 0
    s_mov_b64 s[54:55], s[46:47]
    s_mov_b32 s36, 31
    s_waitcnt lgkmcnt(0)
    s_and_b64 exec, s[16:17], s[40:41]
    s_andn2_b64 s[40:41], s[40:41], s[16:17]
    s_mov_b32 s73, 0
    buffer_load_dwordx4 v[64:67], v228, s[60:63], s73 offen offset:0 sc1
    buffer_load_dwordx4 v[68:71], v228, s[60:63], s73 offen offset:256 sc1
    buffer_load_dwordx4 v[72:75], v228, s[60:63], s73 offen offset:1024 sc1
    buffer_load_dwordx4 v[76:79], v228, s[60:63], s73 offen offset:1280 sc1
    buffer_load_dwordx4 v[80:83], v228, s[60:63], s73 offen offset:2048 sc1
    buffer_load_dwordx4 v[84:87], v228, s[60:63], s73 offen offset:2304 sc1
    s_mov_b64 exec, -1
    s_waitcnt vmcnt(18)
    s_barrier
    v_subrev_u32 v212, 28672, v212
    ds_write_b128 v212, v[0:3] offset:4224
    ds_write_b128 v212, v[4:7] offset:5280
    ds_write_b128 v212, v[8:11] offset:6336
    ds_write_b128 v212, v[12:15] offset:7392
    s_waitcnt lgkmcnt(0)
    s_add_u32 s83, s33, 896
    s_sub_u32 s72, s83, 896
    s_cselect_b32 s83, s83, s72
    s_add_u32 m0, s82, 101376
    s_add_u32 s72, s83, 0
    buffer_load_dwordx4 v213, s[56:59], s72 offen lds
    s_addk_i32 m0, 1056
    s_addk_i32 s72, 896
    buffer_load_dwordx4 v213, s[56:59], s72 offen lds
    s_addk_i32 m0, 1056
    s_addk_i32 s72, 896
    buffer_load_dwordx4 v213, s[56:59], s72 offen lds
    s_addk_i32 m0, 1056
    s_addk_i32 s72, 896
    buffer_load_dwordx4 v213, s[56:59], s72 offen lds
    s_addk_i32 m0, 1056
    s_addk_i32 s72, 896
    buffer_load_dwordx4 v213, s[56:59], s72 offen lds
    s_load_dwordx8 s[16:23], s[14:15], s32 offset:128 glc
    s_waitcnt vmcnt(15)
    s_barrier
    s_add_u32 s83, s33, 896
    s_sub_u32 s72, s83, 896
    s_cselect_b32 s83, s83, s72
    s_add_u32 m0, s82, 106656
    s_add_u32 s72, s83, 4480
    buffer_load_dwordx4 v213, s[56:59], s72 offen lds
    s_addk_i32 m0, 1056
    s_addk_i32 s72, 896
    buffer_load_dwordx4 v213, s[56:59], s72 offen lds
    s_addk_i32 m0, 1056
    s_addk_i32 s72, 896
    buffer_load_dwordx4 v213, s[56:59], s72 offen lds
    s_add_u32 s83, s33, 896
    s_sub_u32 s72, s83, 896
    s_cselect_b32 s83, s83, s72
    s_add_u32 m0, s82, 0
    s_add_u32 s72, s83, 0
    buffer_load_dwordx4 v214, s[56:59], s72 offen lds
    s_waitcnt lgkmcnt(0)
    s_and_b64 exec, s[16:17], s[40:41]
    s_cbranch_scc0 L_sk1
    s_andn2_b64 s[40:41], s[40:41], s[16:17]
    s_mov_b32 s73, 0
    buffer_load_dwordx4 v[64:67], v228, s[60:63], s73 offen offset:0 sc1
    buffer_load_dwordx4 v[68:71], v228, s[60:63], s73 offen offset:256 sc1
    buffer_load_dwordx4 v[72:75], v228, s[60:63], s73 offen offset:1024 sc1
    buffer_load_dwordx4 v[76:79], v228, s[60:63], s73 offen offset:1280 sc1
    buffer_load_dwordx4 v[80:83], v228, s[60:63], s73 offen offset:2048 sc1
    buffer_load_dwordx4 v[84:87], v228, s[60:63], s73 offen offset:2304 sc1
L_sk1:
    s_and_b64 exec, s[18:19], s[42:43]
    s_andn2_b64 s[42:43], s[42:43], s[18:19]
    s_mov_b32 s73, 24576
    buffer_load_dwordx4 v[88:91], v228, s[60:63], s73 offen offset:0 sc1
    buffer_load_dwordx4 v[92:95], v228, s[60:63], s73 offen offset:256 sc1
    buffer_load_dwordx4 v[96:99], v228, s[60:63], s73 offen offset:1024 sc1
    buffer_load_dwordx4 v[100:103], v228, s[60:63], s73 offen offset:1280 sc1
    buffer_load_dwordx4 v[104:107], v228, s[60:63], s73 offen offset:2048 sc1
    buffer_load_dwordx4 v[108:111], v228, s[60:63], s73 offen offset:2304 sc1
    s_mov_b64 exec, -1
    v_subrev_u32 v212, 67584, v212
    ds_write_b128 v212, v[16:19] offset:1056
    ds_write_b128 v212, v[20:23] offset:2112
    s_waitcnt vmcnt(21)
    s_barrier
    s_add_u32 s73, s13, 6
    s_sub_u32 s74, s73, 7
    s_cselect_b32 s73, s73, s74
    s_cmp_eq_u32 s12, 7
    s_cselect_b32 s74, 3, 6
    s_mul_i32 s73, s73, 512
    s_lshl_b32 s74, s74, 2
    s_add_u32 s73, s73, s74
    s_add_u32 s73, s73, s91
    buffer_store_dword v224, v231, s[60:63], s73 offen sc1
    s_load_dwordx8 s[16:23], s[14:15], s32 offset:256 glc
    ds_write_b128 v212, v[24:27] offset:3168
    ds_write_b128 v212, v[28:31] offset:4224
    ds_write_b128 v212, v[32:35] offset:5280
    ds_write_b128 v212, v[36:39] offset:6336
    ds_write_b128 v212, v[40:43] offset:7392
    s_waitcnt lgkmcnt(0)
    s_waitcnt vmcnt(7)
    s_barrier
    s_waitcnt lgkmcnt(0)
    s_load_dwordx8 s[4:11], s[14:15], s32 offset:384 glc
    s_and_b64 exec, s[16:17], s[40:41]
    s_cbranch_scc0 L_sk2
    s_andn2_b64 s[40:41], s[40:41], s[16:17]
    s_mov_b32 s73, 0
    buffer_load_dwordx4 v[64:67], v228, s[60:63], s73 offen offset:0 sc1
    buffer_load_dwordx4 v[68:71], v228, s[60:63], s73 offen offset:256 sc1
    buffer_load_dwordx4 v[72:75], v228, s[60:63], s73 offen offset:1024 sc1
    buffer_load_dwordx4 v[76:79], v228, s[60:63], s73 offen offset:1280 sc1
    buffer_load_dwordx4 v[80:83], v228, s[60:63], s73 offen offset:2048 sc1
    buffer_load_dwordx4 v[84:87], v228, s[60:63], s73 offen offset:2304 sc1
L_sk2:
    s_and_b64 exec, s[18:19], s[42:43]
    s_cbranch_scc0 L_sk3
    s_andn2_b64 s[42:43], s[42:43], s[18:19]
    s_mov_b32 s73, 24576
    buffer_load_dwordx4 v[88:91], v228, s[60:63], s73 offen offset:0 sc1
    buffer_load_dwordx4 v[92:95], v228, s[60:63], s73 offen offset:256 sc1
    buffer_load_dwordx4 v[96:99], v228, s[60:63], s73 offen offset:1024 sc1
    buffer_load_dwordx4 v[100:103], v228, s[60:63], s73 offen offset:1280 sc1
    buffer_load_dwordx4 v[104:107], v228, s[60:63], s73 offen offset:2048 sc1
    buffer_load_dwordx4 v[108:111], v228, s[60:63], s73 offen offset:2304 sc1
L_sk3:
    s_and_b64 exec, s[20:21], s[44:45]
    s_andn2_b64 s[44:45], s[44:45], s[20:21]
    s_mov_b32 s73, 49152
    buffer_load_dwordx4 v[112:115], v228, s[60:63], s73 offen offset:0 sc1
    buffer_load_dwordx4 v[116:119], v228, s[60:63], s73 offen offset:256 sc1
    buffer_load_dwordx4 v[120:123], v228, s[60:63], s73 offen offset:1024 sc1
    buffer_load_dwordx4 v[124:127], v228, s[60:63], s73 offen offset:1280 sc1
    buffer_load_dwordx4 v[128:131], v228, s[60:63], s73 offen offset:2048 sc1
    buffer_load_dwordx4 v[132:135], v228, s[60:63], s73 offen offset:2304 sc1
    s_and_b64 exec, s[22:23], s[46:47]
    s_andn2_b64 s[46:47], s[46:47], s[22:23]
    s_mov_b32 s73, 73728
    buffer_load_dwordx4 v[136:139], v228, s[60:63], s73 offen offset:0 sc1
    buffer_load_dwordx4 v[140:143], v228, s[60:63], s73 offen offset:256 sc1
    buffer_load_dwordx4 v[144:147], v228, s[60:63], s73 offen offset:1024 sc1
    buffer_load_dwordx4 v[148:151], v228, s[60:63], s73 offen offset:1280 sc1
    buffer_load_dwordx4 v[152:155], v228, s[60:63], s73 offen offset:2048 sc1
    buffer_load_dwordx4 v[156:159], v228, s[60:63], s73 offen offset:2304 sc1
    s_mov_b64 exec, -1
    s_mov_b32 s100, 200000
    s_waitcnt vmcnt(12)
    s_cmp_eq_u64 s[40:41], 0
    s_cselect_b32 s72, s36, 0
    s_bitcmp1_b32 s72, 0
    s_cbranch_scc0 L_ck4
    s_bitset0_b32 s36, 0
    v_mfma_f32_16x16x32_bf16 v[160:163], v[220:223], v[64:67], v[160:163]
    v_mfma_f32_16x16x32_bf16 v[164:167], v[220:223], v[68:71], v[164:167]
    v_mfma_f32_16x16x32_bf16 v[168:171], v[220:223], v[72:75], v[168:171]
    v_mfma_f32_16x16x32_bf16 v[172:175], v[220:223], v[76:79], v[172:175]
    v_mfma_f32_16x16x32_bf16 v[176:179], v[220:223], v[80:83], v[176:179]
    v_mfma_f32_16x16x32_bf16 v[180:183], v[220:223], v[84:87], v[180:183]
L_ck4:
    s_cmp_eq_u64 s[42:43], 0
    s_cselect_b32 s72, s36, 0
    s_bitcmp1_b32 s72, 1
    s_cbranch_scc0 L_ck5
    v_max_u32 v236, v88, v89
    v_max_u32 v237, v96, v97
    v_max_u32 v238, v104, v105
    v_max3_u32 v236, v236, v90, v91
    v_max3_u32 v237, v237, v98, v99
    v_max3_u32 v238, v238, v106, v107
    v_max3_u32 v236, v236, v92, v93
    v_max3_u32 v237, v237, v100, v101
    v_max3_u32 v238, v238, v108, v109
    v_max3_u32 v236, v236, v94, v95
    v_max3_u32 v237, v237, v102, v103
    v_max3_u32 v238, v238, v110, v111
    v_max3_u32 v236, v236, v237, v238
    v_cmp_eq_u32 s[42:43], -1, v236
    s_nop 1
    s_and_b64 s[42:43], s[42:43], s[50:51]
    s_cbranch_scc1 L_ck5
    s_bitset0_b32 s36, 1
    v_mfma_f32_16x16x32_bf16 v[160:163], v[220:223], v[88:91], v[160:163]
    v_mfma_f32_16x16x32_bf16 v[164:167], v[220:223], v[92:95], v[164:167]
    v_mfma_f32_16x16x32_bf16 v[168:171], v[220:223], v[96:99], v[168:171]
    v_mfma_f32_16x16x32_bf16 v[172:175], v[220:223], v[100:103], v[172:175]
    v_mfma_f32_16x16x32_bf16 v[176:179], v[220:223], v[104:107], v[176:179]
    v_mfma_f32_16x16x32_bf16 v[180:183], v[220:223], v[108:111], v[180:183]
L_ck5:
    s_waitcnt lgkmcnt(0)
    s_or_b64 vcc, s[46:47], 0
    s_or_b64 vcc, s[44:45], vcc
    s_or_b64 vcc, s[42:43], vcc
    s_or_b64 vcc, s[40:41], vcc
    s_cbranch_scc1 L_g1
    s_waitcnt vmcnt(6)
    s_cmp_eq_u64 s[44:45], 0
    s_cselect_b32 s72, s36, 0
    s_bitcmp1_b32 s72, 2
    s_cbranch_scc0 L_ck6
    v_max_u32 v236, v112, v113
    v_max_u32 v237, v120, v121
    v_max_u32 v238, v128, v129
    v_max3_u32 v236, v236, v114, v115
    v_max3_u32 v237, v237, v122, v123
    v_max3_u32 v238, v238, v130, v131
    v_max3_u32 v236, v236, v116, v117
    v_max3_u32 v237, v237, v124, v125
    v_max3_u32 v238, v238, v132, v133
    v_max3_u32 v236, v236, v118, v119
    v_max3_u32 v237, v237, v126, v127
    v_max3_u32 v238, v238, v134, v135
    v_max3_u32 v236, v236, v237, v238
    v_cmp_eq_u32 s[44:45], -1, v236
    s_nop 1
    s_and_b64 s[44:45], s[44:45], s[52:53]
    s_cbranch_scc1 L_ck6
    s_bitset0_b32 s36, 2
    v_mfma_f32_16x16x32_bf16 v[160:163], v[220:223], v[112:115], v[160:163]
    v_mfma_f32_16x16x32_bf16 v[164:167], v[220:223], v[116:119], v[164:167]
    v_mfma_f32_16x16x32_bf16 v[168:171], v[220:223], v[120:123], v[168:171]
    v_mfma_f32_16x16x32_bf16 v[172:175], v[220:223], v[124:127], v[172:175]
    v_mfma_f32_16x16x32_bf16 v[176:179], v[220:223], v[128:131], v[176:179]
    v_mfma_f32_16x16x32_bf16 v[180:183], v[220:223], v[132:135], v[180:183]
L_ck6:
    s_waitcnt vmcnt(0)
    s_cmp_eq_u64 s[46:47], 0
    s_cselect_b32 s72, s36, 0
    s_bitcmp1_b32 s72, 3
    s_cbranch_scc0 L_ck7
    v_max_u32 v236, v136, v137
    v_max_u32 v237, v144, v145
    v_max_u32 v238, v152, v153
    v_max3_u32 v236, v236, v138, v139
    v_max3_u32 v237, v237, v146, v147
    v_max3_u32 v238, v238, v154, v155
    v_max3_u32 v236, v236, v140, v141
    v_max3_u32 v237, v237, v148, v149
    v_max3_u32 v238, v238, v156, v157
    v_max3_u32 v236, v236, v142, v143
    v_max3_u32 v237, v237, v150, v151
    v_max3_u32 v238, v238, v158, v159
    v_max3_u32 v236, v236, v237, v238
    v_cmp_eq_u32 s[46:47], -1, v236
    s_nop 1
    s_and_b64 s[46:47], s[46:47], s[54:55]
    s_cbranch_scc1 L_ck7
    s_bitset0_b32 s36, 3
L_ck7:
    s_and_b32 s72, s36, 15
    s_cbranch_scc1 L_more
L_fin:
    s_bitcmp1_b32 s36, 4
    s_cbranch_scc0 L_fin1
    s_barrier
    s_mov_b32 exec_lo, 0
    ds_read2st64_b64 v[136:139], v234 offset0:24 offset1:25
    ds_read2st64_b64 v[140:143], v235 offset0:24 offset1:25
    ds_read2st64_b64 v[144:147], v234 offset0:26 offset1:27
    ds_read2st64_b64 v[148:151], v235 offset0:26 offset1:27
    ds_read2st64_b64 v[152:155], v234 offset0:28 offset1:29
    ds_read2st64_b64 v[156:159], v235 offset0:28 offset1:29
    s_mov_b64 exec, -1
L_fin1:
    s_waitcnt lgkmcnt(5)
    v_mfma_f32_16x16x32_bf16 v[160:163], v[220:223], v[136:139], v[160:163]
    s_waitcnt lgkmcnt(4)
    v_mfma_f32_16x16x32_bf16 v[164:167], v[220:223], v[140:143], v[164:167]
    s_waitcnt lgkmcnt(3)
    v_mfma_f32_16x16x32_bf16 v[168:171], v[220:223], v[144:147], v[168:171]
    s_waitcnt lgkmcnt(2)
    v_mfma_f32_16x16x32_bf16 v[172:175], v[220:223], v[148:151], v[172:175]
    s_waitcnt lgkmcnt(1)
    v_mfma_f32_16x16x32_bf16 v[176:179], v[220:223], v[152:155], v[176:179]
    s_waitcnt lgkmcnt(0)
    v_mfma_f32_16x16x32_bf16 v[180:183], v[220:223], v[156:159], v[180:183]
    v_cvt_pk_bf16_f32 v160, v160, v161
    v_cvt_pk_bf16_f32 v161, v162, v163
    v_cvt_pk_bf16_f32 v162, v164, v165
    v_cvt_pk_bf16_f32 v163, v166, v167
    s_mov_b32 s73, 0
    buffer_store_dwordx4 v[160:163], v229, s[92:95], s73 offen sc1
    v_cvt_pk_bf16_f32 v168, v168, v169
    v_cvt_pk_bf16_f32 v169, v170, v171
    v_cvt_pk_bf16_f32 v170, v172, v173
    v_cvt_pk_bf16_f32 v171, v174, v175
    s_mov_b32 s73, 28672
    buffer_store_dwordx4 v[168:171], v229, s[92:95], s73 offen sc1
    v_cvt_pk_bf16_f32 v176, v176, v177
    v_cvt_pk_bf16_f32 v177, v178, v179
    v_cvt_pk_bf16_f32 v178, v180, v181
    v_cvt_pk_bf16_f32 v179, v182, v183
    s_mov_b32 s73, 57344
    buffer_store_dwordx4 v[176:179], v229, s[92:95], s73 offen sc1
    s_branch L_lend
L_g1:
    s_mov_b64 s[16:17], s[4:5]
    s_mov_b64 s[18:19], s[6:7]
    s_mov_b64 s[20:21], s[8:9]
    s_mov_b64 s[22:23], s[10:11]
L_regate:
    s_and_b64 exec, s[22:23], s[46:47]
    s_cbranch_scc0 L_sk8
    s_andn2_b64 s[46:47], s[46:47], s[22:23]
    s_mov_b32 s73, 73728
    buffer_load_dwordx4 v[136:139], v228, s[60:63], s73 offen offset:0 sc1
    buffer_load_dwordx4 v[140:143], v228, s[60:63], s73 offen offset:256 sc1
    buffer_load_dwordx4 v[144:147], v228, s[60:63], s73 offen offset:1024 sc1
    buffer_load_dwordx4 v[148:151], v228, s[60:63], s73 offen offset:1280 sc1
    buffer_load_dwordx4 v[152:155], v228, s[60:63], s73 offen offset:2048 sc1
    buffer_load_dwordx4 v[156:159], v228, s[60:63], s73 offen offset:2304 sc1
L_sk8:
    s_and_b64 exec, s[20:21], s[44:45]
    s_cbranch_scc0 L_sk9
    s_andn2_b64 s[44:45], s[44:45], s[20:21]
    s_mov_b32 s73, 49152
    buffer_load_dwordx4 v[112:115], v228, s[60:63], s73 offen offset:0 sc1
    buffer_load_dwordx4 v[116:119], v228, s[60:63], s73 offen offset:256 sc1
    buffer_load_dwordx4 v[120:123], v228, s[60:63], s73 offen offset:1024 sc1
    buffer_load_dwordx4 v[124:127], v228, s[60:63], s73 offen offset:1280 sc1
    buffer_load_dwordx4 v[128:131], v228, s[60:63], s73 offen offset:2048 sc1
    buffer_load_dwordx4 v[132:135], v228, s[60:63], s73 offen offset:2304 sc1
L_sk9:
    s_and_b64 exec, s[18:19], s[42:43]
    s_cbranch_scc0 L_sk10
    s_andn2_b64 s[42:43], s[42:43], s[18:19]
    s_mov_b32 s73, 24576
    buffer_load_dwordx4 v[88:91], v228, s[60:63], s73 offen offset:0 sc1
    buffer_load_dwordx4 v[92:95], v228, s[60:63], s73 offen offset:256 sc1
    buffer_load_dwordx4 v[96:99], v228, s[60:63], s73 offen offset:1024 sc1
    buffer_load_dwordx4 v[100:103], v228, s[60:63], s73 offen offset:1280 sc1
    buffer_load_dwordx4 v[104:107], v228, s[60:63], s73 offen offset:2048 sc1
    buffer_load_dwordx4 v[108:111], v228, s[60:63], s73 offen offset:2304 sc1
L_sk10:
    s_and_b64 exec, s[16:17], s[40:41]
    s_cbranch_scc0 L_sk11
    s_andn2_b64 s[40:41], s[40:41], s[16:17]
    s_mov_b32 s73, 0
    buffer_load_dwordx4 v[64:67], v228, s[60:63], s73 offen offset:0 sc1
    buffer_load_dwordx4 v[68:71], v228, s[60:63], s73 offen offset:256 sc1
    buffer_load_dwordx4 v[72:75], v228, s[60:63], s73 offen offset:1024 sc1
    buffer_load_dwordx4 v[76:79], v228, s[60:63], s73 offen offset:1280 sc1
    buffer_load_dwordx4 v[80:83], v228, s[60:63], s73 offen offset:2048 sc1
    buffer_load_dwordx4 v[84:87], v228, s[60:63], s73 offen offset:2304 sc1
L_sk11:
    s_mov_b64 exec, -1
L_top:
    s_sub_u32 s100, s100, 1
    s_cbranch_scc1 L_fin
    s_or_b64 vcc, s[46:47], 0
    s_or_b64 vcc, s[44:45], vcc
    s_or_b64 vcc, s[42:43], vcc
    s_or_b64 vcc, s[40:41], vcc
    s_cbranch_scc1 L_poll
    s_bitcmp1_b32 s36, 4
    s_cbranch_scc0 L_m3
    s_bitset0_b32 s36, 4
    s_barrier
    s_mov_b32 exec_lo, 0
    ds_read2st64_b64 v[136:139], v234 offset0:24 offset1:25
    ds_read2st64_b64 v[140:143], v235 offset0:24 offset1:25
    ds_read2st64_b64 v[144:147], v234 offset0:26 offset1:27
    ds_read2st64_b64 v[148:151], v235 offset0:26 offset1:27
    ds_read2st64_b64 v[152:155], v234 offset0:28 offset1:29
    ds_read2st64_b64 v[156:159], v235 offset0:28 offset1:29
    s_mov_b64 exec, -1
L_m3:
    s_waitcnt vmcnt(0)
    s_branch L_gate
L_poll:
    buffer_load_dword v216, v230, s[60:63], s32 offen sc1
    s_waitcnt vmcnt(0)
    v_readlane_b32 s16, v216, 0
    v_readlane_b32 s17, v216, 1
    v_readlane_b32 s18, v216, 2
    v_readlane_b32 s19, v216, 3
    v_readlane_b32 s20, v216, 4
    v_readlane_b32 s21, v216, 5
    v_readlane_b32 s22, v216, 6
L_gate:
    s_mov_b64 s[24:25], s[40:41]
    s_mov_b64 s[26:27], s[42:43]
    s_mov_b64 s[28:29], s[44:45]
    s_mov_b64 s[30:31], s[46:47]
    s_and_b64 exec, s[22:23], s[46:47]
    s_cbranch_scc0 L_sk12
    s_andn2_b64 s[46:47], s[46:47], s[22:23]
    s_mov_b32 s73, 73728
    buffer_load_dwordx4 v[136:139], v228, s[60:63], s73 offen offset:0 sc1
    buffer_load_dwordx4 v[140:143], v228, s[60:63], s73 offen offset:256 sc1
    buffer_load_dwordx4 v[144:147], v228, s[60:63], s73 offen offset:1024 sc1
    buffer_load_dwordx4 v[148:151], v228, s[60:63], s73 offen offset:1280 sc1
    buffer_load_dwordx4 v[152:155], v228, s[60:63], s73 offen offset:2048 sc1
    buffer_load_dwordx4 v[156:159], v228, s[60:63], s73 offen offset:2304 sc1
L_sk12:
    s_and_b64 exec, s[20:21], s[44:45]
    s_cbranch_scc0 L_sk13
    s_andn2_b64 s[44:45], s[44:45], s[20:21]
    s_mov_b32 s73, 49152
    buffer_load_dwordx4 v[112:115], v228, s[60:63], s73 offen offset:0 sc1
    buffer_load_dwordx4 v[116:119], v228, s[60:63], s73 offen offset:256 sc1
    buffer_load_dwordx4 v[120:123], v228, s[60:63], s73 offen offset:1024 sc1
    buffer_load_dwordx4 v[124:127], v228, s[60:63], s73 offen offset:1280 sc1
    buffer_load_dwordx4 v[128:131], v228, s[60:63], s73 offen offset:2048 sc1
    buffer_load_dwordx4 v[132:135], v228, s[60:63], s73 offen offset:2304 sc1
L_sk13:
    s_and_b64 exec, s[18:19], s[42:43]
    s_cbranch_scc0 L_sk14
    s_andn2_b64 s[42:43], s[42:43], s[18:19]
    s_mov_b32 s73, 24576
    buffer_load_dwordx4 v[88:91], v228, s[60:63], s73 offen offset:0 sc1
    buffer_load_dwordx4 v[92:95], v228, s[60:63], s73 offen offset:256 sc1
    buffer_load_dwordx4 v[96:99], v228, s[60:63], s73 offen offset:1024 sc1
    buffer_load_dwordx4 v[100:103], v228, s[60:63], s73 offen offset:1280 sc1
    buffer_load_dwordx4 v[104:107], v228, s[60:63], s73 offen offset:2048 sc1
    buffer_load_dwordx4 v[108:111], v228, s[60:63], s73 offen offset:2304 sc1
L_sk14:
    s_and_b64 exec, s[16:17], s[40:41]
    s_cbranch_scc0 L_sk15
    s_andn2_b64 s[40:41], s[40:41], s[16:17]
    s_mov_b32 s73, 0
    buffer_load_dwordx4 v[64:67], v228, s[60:63], s73 offen offset:0 sc1
    buffer_load_dwordx4 v[68:71], v228, s[60:63], s73 offen offset:256 sc1
    buffer_load_dwordx4 v[72:75], v228, s[60:63], s73 offen offset:1024 sc1
    buffer_load_dwordx4 v[76:79], v228, s[60:63], s73 offen offset:1280 sc1
    buffer_load_dwordx4 v[80:83], v228, s[60:63], s73 offen offset:2048 sc1
    buffer_load_dwordx4 v[84:87], v228, s[60:63], s73 offen offset:2304 sc1
L_sk15:
    s_mov_b64 exec, -1
    s_cmp_eq_u64 s[30:31], 0
    s_cselect_b32 s72, s36, 0
    s_bitcmp1_b32 s72, 3
    s_cbranch_scc0 L_ck16
    v_max_u32 v236, v136, v137
    v_max_u32 v237, v144, v145
    v_max_u32 v238, v152, v153
    v_max3_u32 v236, v236, v138, v139
    v_max3_u32 v237, v237, v146, v147
    v_max3_u32 v238, v238, v154, v155
    v_max3_u32 v236, v236, v140, v141
    v_max3_u32 v237, v237, v148, v149
    v_max3_u32 v238, v238, v156, v157
    v_max3_u32 v236, v236, v142, v143
    v_max3_u32 v237, v237, v150, v151
    v_max3_u32 v238, v238, v158, v159
    v_max3_u32 v236, v236, v237, v238
    v_cmp_eq_u32 s[46:47], -1, v236
    s_nop 1
    s_and_b64 s[46:47], s[46:47], s[54:55]
    s_cbranch_scc1 L_ck16
    s_bitset0_b32 s36, 3
L_ck16:
    s_cmp_eq_u64 s[28:29], 0
    s_cselect_b32 s72, s36, 0
    s_bitcmp1_b32 s72, 2
    s_cbranch_scc0 L_ck17
    v_max_u32 v236, v112, v113
    v_max_u32 v237, v120, v121
    v_max_u32 v238, v128, v129
    v_max3_u32 v236, v236, v114, v115
    v_max3_u32 v237, v237, v122, v123
    v_max3_u32 v238, v238, v130, v131
    v_max3_u32 v236, v236, v116, v117
    v_max3_u32 v237, v237, v124, v125
    v_max3_u32 v238, v238, v132, v133
    v_max3_u32 v236, v236, v118, v119
    v_max3_u32 v237, v237, v126, v127
    v_max3_u32 v238, v238, v134, v135
    v_max3_u32 v236, v236, v237, v238
    v_cmp_eq_u32 s[44:45], -1, v236
    s_nop 1
    s_and_b64 s[44:45], s[44:45], s[52:53]
    s_cbranch_scc1 L_ck17
    s_bitset0_b32 s36, 2
    v_mfma_f32_16x16x32_bf16 v[160:163], v[220:223], v[112:115], v[160:163]
    v_mfma_f32_16x16x32_bf16 v[164:167], v[220:223], v[116:119], v[164:167]
    v_mfma_f32_16x16x32_bf16 v[168:171], v[220:223], v[120:123], v[168:171]
    v_mfma_f32_16x16x32_bf16 v[172:175], v[220:223], v[124:127], v[172:175]
    v_mfma_f32_16x16x32_bf16 v[176:179], v[220:223], v[128:131], v[176:179]
    v_mfma_f32_16x16x32_bf16 v[180:183], v[220:223], v[132:135], v[180:183]
L_ck17:
    s_cmp_eq_u64 s[26:27], 0
    s_cselect_b32 s72, s36, 0
    s_bitcmp1_b32 s72, 1
    s_cbranch_scc0 L_ck18
    v_max_u32 v236, v88, v89
    v_max_u32 v237, v96, v97
    v_max_u32 v238, v104, v105
    v_max3_u32 v236, v236, v90, v91
    v_max3_u32 v237, v237, v98, v99
    v_max3_u32 v238, v238, v106, v107
    v_max3_u32 v236, v236, v92, v93
    v_max3_u32 v237, v237, v100, v101
    v_max3_u32 v238, v238, v108, v109
    v_max3_u32 v236, v236, v94, v95
    v_max3_u32 v237, v237, v102, v103
    v_max3_u32 v238, v238, v110, v111
    v_max3_u32 v236, v236, v237, v238
    v_cmp_eq_u32 s[42:43], -1, v236
    s_nop 1
    s_and_b64 s[42:43], s[42:43], s[50:51]
    s_cbranch_scc1 L_ck18
    s_bitset0_b32 s36, 1
    v_mfma_f32_16x16x32_bf16 v[160:163], v[220:223], v[88:91], v[160:163]
    v_mfma_f32_16x16x32_bf16 v[164:167], v[220:223], v[92:95], v[164:167]
    v_mfma_f32_16x16x32_bf16 v[168:171], v[220:223], v[96:99], v[168:171]
    v_mfma_f32_16x16x32_bf16 v[172:175], v[220:223], v[100:103], v[172:175]
    v_mfma_f32_16x16x32_bf16 v[176:179], v[220:223], v[104:107], v[176:179]
    v_mfma_f32_16x16x32_bf16 v[180:183], v[220:223], v[108:111], v[180:183]
L_ck18:
    s_cmp_eq_u64 s[24:25], 0
    s_cselect_b32 s72, s36, 0
    s_bitcmp1_b32 s72, 0
    s_cbranch_scc0 L_ck19
    s_bitset0_b32 s36, 0
    v_mfma_f32_16x16x32_bf16 v[160:163], v[220:223], v[64:67], v[160:163]
    v_mfma_f32_16x16x32_bf16 v[164:167], v[220:223], v[68:71], v[164:167]
    v_mfma_f32_16x16x32_bf16 v[168:171], v[220:223], v[72:75], v[168:171]
    v_mfma_f32_16x16x32_bf16 v[172:175], v[220:223], v[76:79], v[172:175]
    v_mfma_f32_16x16x32_bf16 v[176:179], v[220:223], v[80:83], v[176:179]
    v_mfma_f32_16x16x32_bf16 v[180:183], v[220:223], v[84:87], v[180:183]
L_ck19:
    s_and_b32 s72, s36, 15
    s_cbranch_scc0 L_fin
L_more:
    s_and_b64 vcc, s[16:17], s[40:41]
    s_and_b64 s[34:35], s[18:19], s[42:43]
    s_or_b64 vcc, vcc, s[34:35]
    s_and_b64 s[34:35], s[20:21], s[44:45]
    s_or_b64 vcc, vcc, s[34:35]
    s_and_b64 s[34:35], s[22:23], s[46:47]
    s_or_b64 vcc, vcc, s[34:35]
    s_cbranch_scc0 L_m2
    s_and_b64 exec, s[22:23], s[46:47]
    s_cbranch_scc0 L_sk20
    s_andn2_b64 s[46:47], s[46:47], s[22:23]
    s_mov_b32 s73, 73728
    buffer_load_dwordx4 v[136:139], v228, s[60:63], s73 offen offset:0 sc1
    buffer_load_dwordx4 v[140:143], v228, s[60:63], s73 offen offset:256 sc1
    buffer_load_dwordx4 v[144:147], v228, s[60:63], s73 offen offset:1024 sc1
    buffer_load_dwordx4 v[148:151], v228, s[60:63], s73 offen offset:1280 sc1
    buffer_load_dwordx4 v[152:155], v228, s[60:63], s73 offen offset:2048 sc1
    buffer_load_dwordx4 v[156:159], v228, s[60:63], s73 offen offset:2304 sc1
L_sk20:
    s_and_b64 exec, s[20:21], s[44:45]
    s_cbranch_scc0 L_sk21
    s_andn2_b64 s[44:45], s[44:45], s[20:21]
    s_mov_b32 s73, 49152
    buffer_load_dwordx4 v[112:115], v228, s[60:63], s73 offen offset:0 sc1
    buffer_load_dwordx4 v[116:119], v228, s[60:63], s73 offen offset:256 sc1
    buffer_load_dwordx4 v[120:123], v228, s[60:63], s73 offen offset:1024 sc1
    buffer_load_dwordx4 v[124:127], v228, s[60:63], s73 offen offset:1280 sc1
    buffer_load_dwordx4 v[128:131], v228, s[60:63], s73 offen offset:2048 sc1
    buffer_load_dwordx4 v[132:135], v228, s[60:63], s73 offen offset:2304 sc1
L_sk21:
    s_and_b64 exec, s[18:19], s[42:43]
    s_cbranch_scc0 L_sk22
    s_andn2_b64 s[42:43], s[42:43], s[18:19]
    s_mov_b32 s73, 24576
    buffer_load_dwordx4 v[88:91], v228, s[60:63], s73 offen offset:0 sc1
    buffer_load_dwordx4 v[92:95], v228, s[60:63], s73 offen offset:256 sc1
    buffer_load_dwordx4 v[96:99], v228, s[60:63], s73 offen offset:1024 sc1
    buffer_load_dwordx4 v[100:103], v228, s[60:63], s73 offen offset:1280 sc1
    buffer_load_dwordx4 v[104:107], v228, s[60:63], s73 offen offset:2048 sc1
    buffer_load_dwordx4 v[108:111], v228, s[60:63], s73 offen offset:2304 sc1
L_sk22:
    s_and_b64 exec, s[16:17], s[40:41]
    s_cbranch_scc0 L_sk23
    s_andn2_b64 s[40:41], s[40:41], s[16:17]
    s_mov_b32 s73, 0
    buffer_load_dwordx4 v[64:67], v228, s[60:63], s73 offen offset:0 sc1
    buffer_load_dwordx4 v[68:71], v228, s[60:63], s73 offen offset:256 sc1
    buffer_load_dwordx4 v[72:75], v228, s[60:63], s73 offen offset:1024 sc1
    buffer_load_dwordx4 v[76:79], v228, s[60:63], s73 offen offset:1280 sc1
    buffer_load_dwordx4 v[80:83], v228, s[60:63], s73 offen offset:2048 sc1
    buffer_load_dwordx4 v[84:87], v228, s[60:63], s73 offen offset:2304 sc1
L_sk23:
    s_mov_b64 exec, -1
L_m2:
    s_mov_b32 s73, 0
    s_cmp_eq_u64 s[40:41], 0
    s_cselect_b32 s72, 1, 0
    s_or_b32 s73, s73, s72
    s_cmp_eq_u64 s[42:43], 0
    s_cselect_b32 s72, 2, 0
    s_or_b32 s73, s73, s72
    s_cmp_eq_u64 s[44:45], 0
    s_cselect_b32 s72, 4, 0
    s_or_b32 s73, s73, s72
    s_cmp_eq_u64 s[46:47], 0
    s_cselect_b32 s72, 8, 0
    s_or_b32 s73, s73, s72
    s_and_b32 s73, s73, s36
    s_cbranch_scc1 L_top
L_spin:
    buffer_load_dword v216, v230, s[60:63], s32 offen sc1
    s_waitcnt vmcnt(1)
    v_readlane_b32 s16, v216, 0
    v_readlane_b32 s17, v216, 1
    v_readlane_b32 s18, v216, 2
    v_readlane_b32 s19, v216, 3
    v_readlane_b32 s20, v216, 4
    v_readlane_b32 s21, v216, 5
    v_readlane_b32 s22, v216, 6
    s_sub_u32 s100, s100, 1
    s_cbranch_scc1 L_fin
    s_and_b64 vcc, s[16:17], s[40:41]
    s_and_b64 s[34:35], s[18:19], s[42:43]
    s_or_b64 vcc, vcc, s[34:35]
    s_and_b64 s[34:35], s[20:21], s[44:45]
    s_or_b64 vcc, vcc, s[34:35]
    s_and_b64 s[34:35], s[22:23], s[46:47]
    s_or_b64 vcc, vcc, s[34:35]
    s_cbranch_scc0 L_spin
    s_branch L_regate
L_lend:
L_exit:
    s_endpgm
L_exit0:
    s_waitcnt vmcnt(0) lgkmcnt(0)
    s_endpgm
L_compute:
    s_load_dwordx4 s[36:39], s[0:1], 80
    s_load_dwordx2 s[14:15], s[0:1], 96
    s_bfe_u32 s66, s2, 0x10002
    v_lshrrev_b32 v1, 6, v0
    s_and_b32 s72, s2, 3
    s_lshr_b32 s73, s2, 3
    s_and_b32 s64, s73, 15
    s_lshr_b32 s73, s73, 4
    s_lshl_b32 s65, s72, 1
    s_add_u32 s65, s65, s73
    v_readfirstlane_b32 s67, v1
    s_lshr_b32 s88, s64, 1
    s_cmp_eq_u32 s88, 7
    s_cselect_b32 s88, 0, s88
    s_mul_i32 s73, s73, 3
    s_add_u32 s73, s73, s72
    s_add_u32 s68, s88, s73
    s_sub_u32 s72, s68, 7
    s_cselect_b32 s68, s68, s72
    s_and_b32 s3, s64, 1
    s_add_u32 s12, s65, 3
    s_and_b32 s12, s12, 7
    s_cmp_eq_u32 s12, 7
    s_cselect_b32 s13, 0, s12
    s_lshr_b32 s69, s67, 1
    s_and_b32 s70, s67, 1
    s_mov_b32 s76, 0x3db8aa3b
    s_mov_b32 s77, 0x3db8aa3b
    s_waitcnt lgkmcnt(0)
    s_mov_b32 s60, s14
    s_mov_b32 s61, s15
    s_mov_b32 s62, 268435456
    s_mov_b32 s63, 0x00020000
    s_mov_b32 s92, s36
    s_mov_b32 s93, s37
    s_mov_b32 s94, 2752512
    s_mov_b32 s95, 0x00020000
    s_mov_b32 s96, s38
    s_mov_b32 s97, s39
    s_mov_b32 s98, 256
    s_mov_b32 s99, 0x00020000
    s_lshl_b32 s90, s66, 4
    s_add_u32 s90, s90, s64
    s_mul_i32 s91, s90, 4096
    s_add_u32 s91, s91, 25165824
    s_cmp_lg_u32 s67, 0
    s_cbranch_scc1 L_noclr
    s_lshl_b32 s72, s65, 9
    s_add_u32 s72, s72, s91
    v_mov_b32 v8, 0
    v_mov_b32 v9, 0
    v_mov_b32 v10, 0
    v_mov_b32 v11, 0
    v_lshlrev_b32 v12, 4, v255
    s_mov_b32 exec_hi, 0
    buffer_store_dwordx4 v[8:11], v12, s[60:63], s72 offen sc1
    s_mov_b64 exec, -1
L_noclr:
    v_and_b32 v1, 15, v255
    v_lshrrev_b32 v2, 4, v255
    v_lshrrev_b32 v3, 2, v1
    v_and_b32 v4, 3, v1
    v_and_b32 v6, 1, v2
    v_lshlrev_b32 v6, 2, v6
    v_add_u32 v6, v6, v3
    v_mul_u32_u24 v5, 1056, v6
    v_lshlrev_b32 v6, 3, v4
    v_add_u32 v5, v5, v6
    v_lshrrev_b32 v7, 1, v2
    v_mul_u32_u24 v6, 16896, v7
    v_add_u32 v6, v6, v5
    s_lshl_b32 s72, s69, 9
    s_add_u32 s73, s72, 130048
    v_add_u32 v248, s73, v6
    s_add_u32 s73, s72, 0
    v_add_u32 v249, s73, v6
    s_add_u32 s73, s72, 96256
    v_add_u32 v250, s73, v6
    s_mul_i32 s72, s70, 6144
    v_lshrrev_b32 v6, 1, v1
    v_xor_b32 v6, v6, v2
    v_lshlrev_b32 v6, 4, v6
    v_lshl_add_u32 v6, v1, 7, v6
    v_add_u32 v251, s72, v6
    v_xor_b32 v252, 64, v251
    s_mul_i32 s72, s69, 16896
    s_add_u32 s72, s72, 62464
    v_and_b32 v6, 1, v1
    v_mul_u32_u24 v6, 528, v6
    v_lshlrev_b32 v253, 3, v2
    v_xor_b32 v253, v253, v6
    v_lshrrev_b32 v6, 1, v1
    v_mul_u32_u24 v6, 1056, v6
    v_add3_u32 v253, v253, v6, s72
    s_mul_i32 s72, s69, 25344
    v_lshlrev_b32 v6, 8, v7
    v_add_u32 v6, v6, v5
    v_add_u32 v254, s72, v6
    s_mul_i32 s73, s67, 3072
    s_add_u32 s72, s73, 135168
    s_mov_b32 s22, s72
    s_xor_b32 s74, s67, 2
    s_mul_i32 s74, s74, 3072
    s_add_u32 s74, s74, 135168
    s_mov_b32 s23, s74
    s_mul_i32 s78, s90, 602112
    s_add_u32 s78, s78, s73
    s_lshl_b32 s72, s72, 1
    s_sub_u32 s78, s78, s72
    s_mul_i32 s79, s69, 8384
    s_sub_u32 s79, 16896, s79
    s_mul_i32 s80, s69, 42176
    s_sub_u32 s80, 33792, s80
    s_mul_i32 s16, s90, 602112
    s_mul_i32 s74, s67, 3040
    s_add_u32 s16, s16, s74
    s_sub_u32 s16, s91, s16
    s_add_u32 s89, s13, 1
    s_sub_u32 s74, s89, 7
    s_cselect_b32 s89, s89, s74
    s_cmp_eq_u32 s12, 7
    s_cselect_b32 s74, 3, 0
    s_lshl_b32 s17, s89, 7
    s_add_u32 s17, s17, s74
    s_lshl2_add_u32 s17, s17, s16
    s_mul_i32 s89, s89, 7
    s_add_u32 s89, s89, s74
    s_mul_i32 s89, s89, 12288
    s_add_u32 s81, s13, 7
    s_sub_u32 s74, s81, 7
    s_cselect_b32 s81, s81, s74
    s_cmp_eq_u32 s12, 7
    s_cselect_b32 s74, 3, 7
    s_lshl_b32 s19, s81, 7
    s_add_u32 s19, s19, s74
    s_lshl2_add_u32 s19, s19, s16
    s_mul_i32 s81, s81, 7
    s_add_u32 s81, s81, s74
    s_mul_i32 s81, s81, 12288
    s_cmp_eq_u32 s12, 7
    s_cselect_b64 s[20:21], 0x01010101, 0
    s_waitcnt vmcnt(0)
    s_barrier
    ds_read_b128 v[192:195], v251 offset:33792
    ds_read_b128 v[196:199], v251 offset:35840
    ds_read_b128 v[200:203], v251 offset:37888
    ds_read_b64_tr_b16 v[216:217], v248 offset:0
    ds_read_b64_tr_b16 v[218:219], v248 offset:8448
    s_waitcnt lgkmcnt(0)
    v_mfma_f32_16x16x32_bf16 v[0:3], v[216:219], v[192:195], 0
    ds_read_b64_tr_b16 v[220:221], v248 offset:32
    ds_read_b64_tr_b16 v[222:223], v248 offset:8480
    v_mfma_f32_16x16x32_bf16 v[4:7], v[216:219], v[196:199], 0
    ds_read_b64_tr_b16 v[224:225], v248 offset:64
    ds_read_b64_tr_b16 v[226:227], v248 offset:8512
    v_mfma_f32_16x16x32_bf16 v[8:11], v[216:219], v[200:203], 0
    ds_read_b64_tr_b16 v[228:229], v248 offset:96
    ds_read_b64_tr_b16 v[230:231], v248 offset:8544
    s_waitcnt lgkmcnt(4)
    v_mfma_f32_16x16x32_bf16 v[12:15], v[220:223], v[192:195], 0
    ds_read_b64_tr_b16 v[232:233], v248 offset:128
    ds_read_b64_tr_b16 v[234:235], v248 offset:8576
    v_mfma_f32_16x16x32_bf16 v[16:19], v[220:223], v[196:199], 0
    ds_read_b64_tr_b16 v[236:237], v248 offset:160
    ds_read_b64_tr_b16 v[238:239], v248 offset:8608
    v_mfma_f32_16x16x32_bf16 v[20:23], v[220:223], v[200:203], 0
    ds_read_b64_tr_b16 v[240:241], v248 offset:192
    ds_read_b64_tr_b16 v[242:243], v248 offset:8640
    s_waitcnt lgkmcnt(8)
    v_mfma_f32_16x16x32_bf16 v[24:27], v[224:227], v[192:195], 0
    ds_read_b64_tr_b16 v[244:245], v248 offset:224
    ds_read_b64_tr_b16 v[246:247], v248 offset:8672
    v_mfma_f32_16x16x32_bf16 v[28:31], v[224:227], v[196:199], 0
    ds_read_b64_tr_b16 v[216:217], v248 offset:256
    ds_read_b64_tr_b16 v[218:219], v248 offset:8704
    v_mfma_f32_16x16x32_bf16 v[32:35], v[224:227], v[200:203], 0
    ds_read_b64_tr_b16 v[220:221], v248 offset:288
    s_cmp_lg_u32 s67, 0
    s_cbranch_scc1 L_noarr
    s_lshl_b32 s72, s90, 2
    s_mov_b64 exec, 2
    buffer_atomic_add v255, off, s[96:99], s72 offset:128 sc1
    s_mov_b64 exec, -1
L_noarr:
    s_waitcnt lgkmcnt(11)
    v_mfma_f32_16x16x32_bf16 v[36:39], v[228:231], v[192:195], 0
    ds_read_b64_tr_b16 v[222:223], v248 offset:8736
    v_mfma_f32_16x16x32_bf16 v[40:43], v[228:231], v[196:199], 0
    ds_read_b64_tr_b16 v[224:225], v248 offset:320
    v_mfma_f32_16x16x32_bf16 v[44:47], v[228:231], v[200:203], 0
    ds_read_b64_tr_b16 v[226:227], v248 offset:8768
    s_waitcnt lgkmcnt(12)
    v_mfma_f32_16x16x32_bf16 v[48:51], v[232:235], v[192:195], 0
    ds_read_b64_tr_b16 v[228:229], v248 offset:352
    v_mfma_f32_16x16x32_bf16 v[52:55], v[232:235], v[196:199], 0
    ds_read_b64_tr_b16 v[230:231], v248 offset:8800
    v_mfma_f32_16x16x32_bf16 v[56:59], v[232:235], v[200:203], 0
    s_waitcnt lgkmcnt(12)
    v_mfma_f32_16x16x32_bf16 v[60:63], v[236:239], v[192:195], 0
    ds_read_b64_tr_b16 v[232:233], v248 offset:384
    v_mfma_f32_16x16x32_bf16 v[64:67], v[236:239], v[196:199], 0
    ds_read_b64_tr_b16 v[234:235], v248 offset:8832
    v_mfma_f32_16x16x32_bf16 v[68:71], v[236:239], v[200:203], 0
    s_waitcnt lgkmcnt(12)
    v_mfma_f32_16x16x32_bf16 v[72:75], v[240:243], v[192:195], 0
    ds_read_b64_tr_b16 v[236:237], v248 offset:416
    v_mfma_f32_16x16x32_bf16 v[76:79], v[240:243], v[196:199], 0
    ds_read_b64_tr_b16 v[238:239], v248 offset:8864
    v_mfma_f32_16x16x32_bf16 v[80:83], v[240:243], v[200:203], 0
    s_waitcnt lgkmcnt(12)
    v_mfma_f32_16x16x32_bf16 v[84:87], v[244:247], v[192:195], 0
    ds_read_b64_tr_b16 v[240:241], v248 offset:448
    v_mfma_f32_16x16x32_bf16 v[88:91], v[244:247], v[196:199], 0
    ds_read_b64_tr_b16 v[242:243], v248 offset:8896
    v_mfma_f32_16x16x32_bf16 v[92:95], v[244:247], v[200:203], 0
    s_waitcnt lgkmcnt(12)
    v_mfma_f32_16x16x32_bf16 v[96:99], v[216:219], v[192:195], 0
    ds_read_b64_tr_b16 v[244:245], v248 offset:480
    v_mfma_f32_16x16x32_bf16 v[100:103], v[216:219], v[196:199], 0
    ds_read_b64_tr_b16 v[246:247], v248 offset:8928
    v_mfma_f32_16x16x32_bf16 v[104:107], v[216:219], v[200:203], 0
    s_waitcnt lgkmcnt(12)
    v_mfma_f32_16x16x32_bf16 v[108:111], v[220:223], v[192:195], 0
    v_mfma_f32_16x16x32_bf16 v[112:115], v[220:223], v[196:199], 0
    v_mfma_f32_16x16x32_bf16 v[116:119], v[220:223], v[200:203], 0
    s_waitcnt lgkmcnt(0)
    s_barrier
    v_mfma_f32_16x16x32_bf16 v[120:123], v[224:227], v[192:195], 0
    ds_read_b128 v[204:207], v252 offset:33792
    ds_read_b128 v[208:211], v252 offset:35840
    v_mfma_f32_16x16x32_bf16 v[124:127], v[224:227], v[196:199], 0
    ds_read_b128 v[212:215], v252 offset:37888
    ds_read_b64_tr_b16 v[216:217], v249 offset:0
    v_mfma_f32_16x16x32_bf16 v[128:131], v[224:227], v[200:203], 0
    ds_read_b64_tr_b16 v[218:219], v249 offset:8448
    v_mfma_f32_16x16x32_bf16 v[132:135], v[228:231], v[192:195], 0
    ds_read_b64_tr_b16 v[220:221], v249 offset:32
    ds_read_b64_tr_b16 v[222:223], v249 offset:8480
    v_mfma_f32_16x16x32_bf16 v[136:139], v[228:231], v[196:199], 0
    ds_read_b64_tr_b16 v[224:225], v249 offset:64
    v_mfma_f32_16x16x32_bf16 v[140:143], v[228:231], v[200:203], 0
    ds_read_b64_tr_b16 v[226:227], v249 offset:8512
    v_mfma_f32_16x16x32_bf16 v[144:147], v[232:235], v[192:195], 0
    ds_read_b64_tr_b16 v[228:229], v249 offset:96
    v_mfma_f32_16x16x32_bf16 v[148:151], v[232:235], v[196:199], 0
    ds_read_b64_tr_b16 v[230:231], v249 offset:8544
    v_mfma_f32_16x16x32_bf16 v[152:155], v[232:235], v[200:203], 0
    v_mfma_f32_16x16x32_bf16 v[156:159], v[236:239], v[192:195], 0
    ds_read_b64_tr_b16 v[232:233], v249 offset:128
    v_mfma_f32_16x16x32_bf16 v[160:163], v[236:239], v[196:199], 0
    ds_read_b64_tr_b16 v[234:235], v249 offset:8576
    v_mfma_f32_16x16x32_bf16 v[164:167], v[236:239], v[200:203], 0
    v_mfma_f32_16x16x32_bf16 v[168:171], v[240:243], v[192:195], 0
    ds_read_b64_tr_b16 v[236:237], v249 offset:160
    v_mfma_f32_16x16x32_bf16 v[172:175], v[240:243], v[196:199], 0
    ds_read_b64_tr_b16 v[238:239], v249 offset:8608
    v_mfma_f32_16x16x32_bf16 v[176:179], v[240:243], v[200:203], 0
    v_mfma_f32_16x16x32_bf16 v[180:183], v[244:247], v[192:195], 0
    ds_read_b64_tr_b16 v[240:241], v249 offset:192
    v_mfma_f32_16x16x32_bf16 v[184:187], v[244:247], v[196:199], 0
    ds_read_b64_tr_b16 v[242:243], v249 offset:8640
    v_mfma_f32_16x16x32_bf16 v[188:191], v[244:247], v[200:203], 0
    s_waitcnt lgkmcnt(12)
    v_mfma_f32_16x16x32_bf16 v[0:3], v[216:219], v[204:207], v[0:3]
    ds_read_b64_tr_b16 v[244:245], v249 offset:224
    v_mfma_f32_16x16x32_bf16 v[4:7], v[216:219], v[208:211], v[4:7]
    ds_read_b64_tr_b16 v[246:247], v249 offset:8672
    v_mfma_f32_16x16x32_bf16 v[8:11], v[216:219], v[212:215], v[8:11]
    s_waitcnt lgkmcnt(12)
    v_mfma_f32_16x16x32_bf16 v[12:15], v[220:223], v[204:207], v[12:15]
    ds_read_b64_tr_b16 v[216:217], v249 offset:256
    v_mfma_f32_16x16x32_bf16 v[16:19], v[220:223], v[208:211], v[16:19]
    ds_read_b64_tr_b16 v[218:219], v249 offset:8704
    v_mfma_f32_16x16x32_bf16 v[20:23], v[220:223], v[212:215], v[20:23]
    s_waitcnt lgkmcnt(12)
    v_mfma_f32_16x16x32_bf16 v[24:27], v[224:227], v[204:207], v[24:27]
    ds_read_b64_tr_b16 v[220:221], v249 offset:288
    v_mfma_f32_16x16x32_bf16 v[28:31], v[224:227], v[208:211], v[28:31]
    ds_read_b64_tr_b16 v[222:223], v249 offset:8736
    v_mfma_f32_16x16x32_bf16 v[32:35], v[224:227], v[212:215], v[32:35]
    s_waitcnt lgkmcnt(12)
    v_mfma_f32_16x16x32_bf16 v[36:39], v[228:231], v[204:207], v[36:39]
    ds_read_b64_tr_b16 v[224:225], v249 offset:320
    v_mfma_f32_16x16x32_bf16 v[40:43], v[228:231], v[208:211], v[40:43]
    ds_read_b64_tr_b16 v[226:227], v249 offset:8768
    v_mfma_f32_16x16x32_bf16 v[44:47], v[228:231], v[212:215], v[44:47]
    s_waitcnt lgkmcnt(12)
    v_mfma_f32_16x16x32_bf16 v[48:51], v[232:235], v[204:207], v[48:51]
    ds_read_b64_tr_b16 v[228:229], v249 offset:352
    v_mfma_f32_16x16x32_bf16 v[52:55], v[232:235], v[208:211], v[52:55]
    ds_read_b64_tr_b16 v[230:231], v249 offset:8800
    v_mfma_f32_16x16x32_bf16 v[56:59], v[232:235], v[212:215], v[56:59]
    s_waitcnt lgkmcnt(12)
    v_mfma_f32_16x16x32_bf16 v[60:63], v[236:239], v[204:207], v[60:63]
    ds_read_b64_tr_b16 v[232:233], v249 offset:384
    v_mfma_f32_16x16x32_bf16 v[64:67], v[236:239], v[208:211], v[64:67]
    ds_read_b64_tr_b16 v[234:235], v249 offset:8832
    v_mfma_f32_16x16x32_bf16 v[68:71], v[236:239], v[212:215], v[68:71]
    s_waitcnt lgkmcnt(12)
    v_mfma_f32_16x16x32_bf16 v[72:75], v[240:243], v[204:207], v[72:75]
    ds_read_b64_tr_b16 v[236:237], v249 offset:416
    v_mfma_f32_16x16x32_bf16 v[76:79], v[240:243], v[208:211], v[76:79]
    ds_read_b64_tr_b16 v[238:239], v249 offset:8864
    v_mfma_f32_16x16x32_bf16 v[80:83], v[240:243], v[212:215], v[80:83]
    s_waitcnt lgkmcnt(12)
    v_mfma_f32_16x16x32_bf16 v[84:87], v[244:247], v[204:207], v[84:87]
    ds_read_b64_tr_b16 v[240:241], v249 offset:448
    v_mfma_f32_16x16x32_bf16 v[88:91], v[244:247], v[208:211], v[88:91]
    ds_read_b64_tr_b16 v[242:243], v249 offset:8896
    v_mfma_f32_16x16x32_bf16 v[92:95], v[244:247], v[212:215], v[92:95]
    s_waitcnt lgkmcnt(12)
    v_mfma_f32_16x16x32_bf16 v[96:99], v[216:219], v[204:207], v[96:99]
    ds_read_b64_tr_b16 v[244:245], v249 offset:480
    v_mfma_f32_16x16x32_bf16 v[100:103], v[216:219], v[208:211], v[100:103]
    ds_read_b64_tr_b16 v[246:247], v249 offset:8928
    v_mfma_f32_16x16x32_bf16 v[104:107], v[216:219], v[212:215], v[104:107]
    s_waitcnt lgkmcnt(12)
    v_mfma_f32_16x16x32_bf16 v[108:111], v[220:223], v[204:207], v[108:111]
    v_mfma_f32_16x16x32_bf16 v[112:115], v[220:223], v[208:211], v[112:115]
    v_mfma_f32_16x16x32_bf16 v[116:119], v[220:223], v[212:215], v[116:119]
    s_waitcnt lgkmcnt(0)
    s_barrier
    v_mfma_f32_16x16x32_bf16 v[120:123], v[224:227], v[204:207], v[120:123]
    ds_read_b128 v[192:195], v251 offset:46080
    ds_read_b128 v[196:199], v251 offset:48128
    v_mfma_f32_16x16x32_bf16 v[124:127], v[224:227], v[208:211], v[124:127]
    ds_read_b128 v[200:203], v251 offset:50176
    ds_read_b64_tr_b16 v[216:217], v250 offset:0
    v_mfma_f32_16x16x32_bf16 v[128:131], v[224:227], v[212:215], v[128:131]
    ds_read_b64_tr_b16 v[218:219], v250 offset:8448
    v_mfma_f32_16x16x32_bf16 v[132:135], v[228:231], v[204:207], v[132:135]
    ds_read_b64_tr_b16 v[220:221], v250 offset:32
    ds_read_b64_tr_b16 v[222:223], v250 offset:8480
    v_mfma_f32_16x16x32_bf16 v[136:139], v[228:231], v[208:211], v[136:139]
    ds_read_b64_tr_b16 v[224:225], v250 offset:64
    v_mfma_f32_16x16x32_bf16 v[140:143], v[228:231], v[212:215], v[140:143]
    ds_read_b64_tr_b16 v[226:227], v250 offset:8512
    v_mfma_f32_16x16x32_bf16 v[144:147], v[232:235], v[204:207], v[144:147]
    ds_read_b64_tr_b16 v[228:229], v250 offset:96
    v_mfma_f32_16x16x32_bf16 v[148:151], v[232:235], v[208:211], v[148:151]
    ds_read_b64_tr_b16 v[230:231], v250 offset:8544
    v_mfma_f32_16x16x32_bf16 v[152:155], v[232:235], v[212:215], v[152:155]
    v_mfma_f32_16x16x32_bf16 v[156:159], v[236:239], v[204:207], v[156:159]
    ds_read_b64_tr_b16 v[232:233], v250 offset:128
    v_mfma_f32_16x16x32_bf16 v[160:163], v[236:239], v[208:211], v[160:163]
    ds_read_b64_tr_b16 v[234:235], v250 offset:8576
    v_mfma_f32_16x16x32_bf16 v[164:167], v[236:239], v[212:215], v[164:167]
    v_mfma_f32_16x16x32_bf16 v[168:171], v[240:243], v[204:207], v[168:171]
    ds_read_b64_tr_b16 v[236:237], v250 offset:160
    v_mfma_f32_16x16x32_bf16 v[172:175], v[240:243], v[208:211], v[172:175]
    ds_read_b64_tr_b16 v[238:239], v250 offset:8608
    v_mfma_f32_16x16x32_bf16 v[176:179], v[240:243], v[212:215], v[176:179]
    v_mfma_f32_16x16x32_bf16 v[180:183], v[244:247], v[204:207], v[180:183]
    ds_read_b64_tr_b16 v[240:241], v250 offset:192
    v_mfma_f32_16x16x32_bf16 v[184:187], v[244:247], v[208:211], v[184:187]
    ds_read_b64_tr_b16 v[242:243], v250 offset:8640
    v_mfma_f32_16x16x32_bf16 v[188:191], v[244:247], v[212:215], v[188:191]
    s_waitcnt lgkmcnt(12)
    v_mfma_f32_16x16x32_bf16 v[0:3], v[216:219], v[192:195], v[0:3]
    ds_read_b64_tr_b16 v[244:245], v250 offset:224
    v_mfma_f32_16x16x32_bf16 v[4:7], v[216:219], v[196:199], v[4:7]
    ds_read_b64_tr_b16 v[246:247], v250 offset:8672
    v_mfma_f32_16x16x32_bf16 v[8:11], v[216:219], v[200:203], v[8:11]
    s_waitcnt lgkmcnt(12)
    v_mfma_f32_16x16x32_bf16 v[12:15], v[220:223], v[192:195], v[12:15]
    ds_read_b64_tr_b16 v[216:217], v250 offset:256
    v_mfma_f32_16x16x32_bf16 v[16:19], v[220:223], v[196:199], v[16:19]
    ds_read_b64_tr_b16 v[218:219], v250 offset:8704
    v_mfma_f32_16x16x32_bf16 v[20:23], v[220:223], v[200:203], v[20:23]
    s_waitcnt lgkmcnt(12)
    v_mfma_f32_16x16x32_bf16 v[24:27], v[224:227], v[192:195], v[24:27]
    ds_read_b64_tr_b16 v[220:221], v250 offset:288
    v_mfma_f32_16x16x32_bf16 v[28:31], v[224:227], v[196:199], v[28:31]
    ds_read_b64_tr_b16 v[222:223], v250 offset:8736
    v_mfma_f32_16x16x32_bf16 v[32:35], v[224:227], v[200:203], v[32:35]
    s_waitcnt lgkmcnt(12)
    v_mfma_f32_16x16x32_bf16 v[36:39], v[228:231], v[192:195], v[36:39]
    ds_read_b64_tr_b16 v[224:225], v250 offset:320
    v_mfma_f32_16x16x32_bf16 v[40:43], v[228:231], v[196:199], v[40:43]
    ds_read_b64_tr_b16 v[226:227], v250 offset:8768
    v_mfma_f32_16x16x32_bf16 v[44:47], v[228:231], v[200:203], v[44:47]
    s_waitcnt lgkmcnt(12)
    v_mfma_f32_16x16x32_bf16 v[48:51], v[232:235], v[192:195], v[48:51]
    ds_read_b64_tr_b16 v[228:229], v250 offset:352
    v_mfma_f32_16x16x32_bf16 v[52:55], v[232:235], v[196:199], v[52:55]
    ds_read_b64_tr_b16 v[230:231], v250 offset:8800
    v_mfma_f32_16x16x32_bf16 v[56:59], v[232:235], v[200:203], v[56:59]
    s_waitcnt lgkmcnt(12)
    v_mfma_f32_16x16x32_bf16 v[60:63], v[236:239], v[192:195], v[60:63]
    ds_read_b64_tr_b16 v[232:233], v250 offset:384
    v_mfma_f32_16x16x32_bf16 v[64:67], v[236:239], v[196:199], v[64:67]
    ds_read_b64_tr_b16 v[234:235], v250 offset:8832
    v_mfma_f32_16x16x32_bf16 v[68:71], v[236:239], v[200:203], v[68:71]
    s_waitcnt lgkmcnt(12)
    v_mfma_f32_16x16x32_bf16 v[72:75], v[240:243], v[192:195], v[72:75]
    ds_read_b64_tr_b16 v[236:237], v250 offset:416
    v_mfma_f32_16x16x32_bf16 v[76:79], v[240:243], v[196:199], v[76:79]
    ds_read_b64_tr_b16 v[238:239], v250 offset:8864
    v_mfma_f32_16x16x32_bf16 v[80:83], v[240:243], v[200:203], v[80:83]
    s_waitcnt lgkmcnt(12)
    v_mfma_f32_16x16x32_bf16 v[84:87], v[244:247], v[192:195], v[84:87]
    ds_read_b64_tr_b16 v[240:241], v250 offset:448
    v_mfma_f32_16x16x32_bf16 v[88:91], v[244:247], v[196:199], v[88:91]
    ds_read_b64_tr_b16 v[242:243], v250 offset:8896
    v_mfma_f32_16x16x32_bf16 v[92:95], v[244:247], v[200:203], v[92:95]
    s_waitcnt lgkmcnt(12)
    v_mfma_f32_16x16x32_bf16 v[96:99], v[216:219], v[192:195], v[96:99]
    ds_read_b64_tr_b16 v[244:245], v250 offset:480
    v_mfma_f32_16x16x32_bf16 v[100:103], v[216:219], v[196:199], v[100:103]
    ds_read_b64_tr_b16 v[246:247], v250 offset:8928
    v_mfma_f32_16x16x32_bf16 v[104:107], v[216:219], v[200:203], v[104:107]
    s_waitcnt lgkmcnt(12)
    v_mfma_f32_16x16x32_bf16 v[108:111], v[220:223], v[192:195], v[108:111]
    v_mfma_f32_16x16x32_bf16 v[112:115], v[220:223], v[196:199], v[112:115]
    v_mfma_f32_16x16x32_bf16 v[116:119], v[220:223], v[200:203], v[116:119]
    s_waitcnt lgkmcnt(0)
    s_barrier
    v_mfma_f32_16x16x32_bf16 v[120:123], v[224:227], v[192:195], v[120:123]
    ds_read_b128 v[204:207], v252 offset:46080
    ds_read_b128 v[208:211], v252 offset:48128
    v_mfma_f32_16x16x32_bf16 v[124:127], v[224:227], v[196:199], v[124:127]
    ds_read_b128 v[212:215], v252 offset:50176
    ds_read_b64_tr_b16 v[216:217], v248 offset:0
    v_mfma_f32_16x16x32_bf16 v[128:131], v[224:227], v[200:203], v[128:131]
    ds_read_b64_tr_b16 v[218:219], v248 offset:8448
    v_mfma_f32_16x16x32_bf16 v[132:135], v[228:231], v[192:195], v[132:135]
    ds_read_b64_tr_b16 v[220:221], v248 offset:32
    ds_read_b64_tr_b16 v[222:223], v248 offset:8480
    v_mfma_f32_16x16x32_bf16 v[136:139], v[228:231], v[196:199], v[136:139]
    ds_read_b64_tr_b16 v[224:225], v248 offset:64
    v_mfma_f32_16x16x32_bf16 v[140:143], v[228:231], v[200:203], v[140:143]
    ds_read_b64_tr_b16 v[226:227], v248 offset:8512
    v_mfma_f32_16x16x32_bf16 v[144:147], v[232:235], v[192:195], v[144:147]
    ds_read_b64_tr_b16 v[228:229], v248 offset:96
    v_mfma_f32_16x16x32_bf16 v[148:151], v[232:235], v[196:199], v[148:151]
    ds_read_b64_tr_b16 v[230:231], v248 offset:8544
    v_mfma_f32_16x16x32_bf16 v[152:155], v[232:235], v[200:203], v[152:155]
    v_mfma_f32_16x16x32_bf16 v[156:159], v[236:239], v[192:195], v[156:159]
    ds_read_b64_tr_b16 v[232:233], v248 offset:128
    v_mfma_f32_16x16x32_bf16 v[160:163], v[236:239], v[196:199], v[160:163]
    ds_read_b64_tr_b16 v[234:235], v248 offset:8576
    v_mfma_f32_16x16x32_bf16 v[164:167], v[236:239], v[200:203], v[164:167]
    v_mfma_f32_16x16x32_bf16 v[168:171], v[240:243], v[192:195], v[168:171]
    ds_read_b64_tr_b16 v[236:237], v248 offset:160
    v_mfma_f32_16x16x32_bf16 v[172:175], v[240:243], v[196:199], v[172:175]
    ds_read_b64_tr_b16 v[238:239], v248 offset:8608
    v_mfma_f32_16x16x32_bf16 v[176:179], v[240:243], v[200:203], v[176:179]
    v_mfma_f32_16x16x32_bf16 v[180:183], v[244:247], v[192:195], v[180:183]
    ds_read_b64_tr_b16 v[240:241], v248 offset:192
    v_mfma_f32_16x16x32_bf16 v[184:187], v[244:247], v[196:199], v[184:187]
    ds_read_b64_tr_b16 v[242:243], v248 offset:8640
    v_mfma_f32_16x16x32_bf16 v[188:191], v[244:247], v[200:203], v[188:191]
    s_waitcnt lgkmcnt(12)
    v_mfma_f32_16x16x32_bf16 v[0:3], v[216:219], v[204:207], v[0:3]
    ds_read_b64_tr_b16 v[244:245], v248 offset:224
    v_mfma_f32_16x16x32_bf16 v[4:7], v[216:219], v[208:211], v[4:7]
    ds_read_b64_tr_b16 v[246:247], v248 offset:8672
    v_mfma_f32_16x16x32_bf16 v[8:11], v[216:219], v[212:215], v[8:11]
    s_waitcnt lgkmcnt(12)
    v_mfma_f32_16x16x32_bf16 v[12:15], v[220:223], v[204:207], v[12:15]
    ds_read_b64_tr_b16 v[216:217], v248 offset:256
    v_mfma_f32_16x16x32_bf16 v[16:19], v[220:223], v[208:211], v[16:19]
    ds_read_b64_tr_b16 v[218:219], v248 offset:8704
    v_mfma_f32_16x16x32_bf16 v[20:23], v[220:223], v[212:215], v[20:23]
    s_waitcnt lgkmcnt(12)
    v_mfma_f32_16x16x32_bf16 v[24:27], v[224:227], v[204:207], v[24:27]
    ds_read_b64_tr_b16 v[220:221], v248 offset:288
    v_mfma_f32_16x16x32_bf16 v[28:31], v[224:227], v[208:211], v[28:31]
    ds_read_b64_tr_b16 v[222:223], v248 offset:8736
    v_mfma_f32_16x16x32_bf16 v[32:35], v[224:227], v[212:215], v[32:35]
    s_waitcnt lgkmcnt(12)
    v_mfma_f32_16x16x32_bf16 v[36:39], v[228:231], v[204:207], v[36:39]
    ds_read_b64_tr_b16 v[224:225], v248 offset:320
    v_mfma_f32_16x16x32_bf16 v[40:43], v[228:231], v[208:211], v[40:43]
    ds_read_b64_tr_b16 v[226:227], v248 offset:8768
    v_mfma_f32_16x16x32_bf16 v[44:47], v[228:231], v[212:215], v[44:47]
    s_waitcnt lgkmcnt(12)
    v_mfma_f32_16x16x32_bf16 v[48:51], v[232:235], v[204:207], v[48:51]
    ds_read_b64_tr_b16 v[228:229], v248 offset:352
    v_mfma_f32_16x16x32_bf16 v[52:55], v[232:235], v[208:211], v[52:55]
    ds_read_b64_tr_b16 v[230:231], v248 offset:8800
    v_mfma_f32_16x16x32_bf16 v[56:59], v[232:235], v[212:215], v[56:59]
    s_waitcnt lgkmcnt(12)
    v_mfma_f32_16x16x32_bf16 v[60:63], v[236:239], v[204:207], v[60:63]
    ds_read_b64_tr_b16 v[232:233], v248 offset:384
    v_mfma_f32_16x16x32_bf16 v[64:67], v[236:239], v[208:211], v[64:67]
    ds_read_b64_tr_b16 v[234:235], v248 offset:8832
    v_mfma_f32_16x16x32_bf16 v[68:71], v[236:239], v[212:215], v[68:71]
    s_waitcnt lgkmcnt(12)
    v_mfma_f32_16x16x32_bf16 v[72:75], v[240:243], v[204:207], v[72:75]
    ds_read_b64_tr_b16 v[236:237], v248 offset:416
    v_mfma_f32_16x16x32_bf16 v[76:79], v[240:243], v[208:211], v[76:79]
    ds_read_b64_tr_b16 v[238:239], v248 offset:8864
    v_mfma_f32_16x16x32_bf16 v[80:83], v[240:243], v[212:215], v[80:83]
    s_waitcnt lgkmcnt(12)
    v_mfma_f32_16x16x32_bf16 v[84:87], v[244:247], v[204:207], v[84:87]
    ds_read_b64_tr_b16 v[240:241], v248 offset:448
    v_mfma_f32_16x16x32_bf16 v[88:91], v[244:247], v[208:211], v[88:91]
    ds_read_b64_tr_b16 v[242:243], v248 offset:8896
    v_mfma_f32_16x16x32_bf16 v[92:95], v[244:247], v[212:215], v[92:95]
    s_waitcnt lgkmcnt(12)
    v_mfma_f32_16x16x32_bf16 v[96:99], v[216:219], v[204:207], v[96:99]
    ds_read_b64_tr_b16 v[244:245], v248 offset:480
    v_mfma_f32_16x16x32_bf16 v[100:103], v[216:219], v[208:211], v[100:103]
    ds_read_b64_tr_b16 v[246:247], v248 offset:8928
    v_mfma_f32_16x16x32_bf16 v[104:107], v[216:219], v[212:215], v[104:107]
    s_waitcnt lgkmcnt(12)
    v_mfma_f32_16x16x32_bf16 v[108:111], v[220:223], v[204:207], v[108:111]
    v_mfma_f32_16x16x32_bf16 v[112:115], v[220:223], v[208:211], v[112:115]
    v_mfma_f32_16x16x32_bf16 v[116:119], v[220:223], v[212:215], v[116:119]
    s_waitcnt lgkmcnt(0)
    s_barrier
    v_mfma_f32_16x16x32_bf16 v[120:123], v[224:227], v[204:207], v[120:123]
    ds_read_b128 v[192:195], v251 offset:33792
    ds_read_b128 v[196:199], v251 offset:35840
    v_mfma_f32_16x16x32_bf16 v[124:127], v[224:227], v[208:211], v[124:127]
    ds_read_b128 v[200:203], v251 offset:37888
    ds_read_b64_tr_b16 v[216:217], v249 offset:0
    v_mfma_f32_16x16x32_bf16 v[128:131], v[224:227], v[212:215], v[128:131]
    ds_read_b64_tr_b16 v[218:219], v249 offset:8448
    v_mfma_f32_16x16x32_bf16 v[132:135], v[228:231], v[204:207], v[132:135]
    ds_read_b64_tr_b16 v[220:221], v249 offset:32
    ds_read_b64_tr_b16 v[222:223], v249 offset:8480
    v_mfma_f32_16x16x32_bf16 v[136:139], v[228:231], v[208:211], v[136:139]
    ds_read_b64_tr_b16 v[224:225], v249 offset:64
    v_mfma_f32_16x16x32_bf16 v[140:143], v[228:231], v[212:215], v[140:143]
    ds_read_b64_tr_b16 v[226:227], v249 offset:8512
    v_mfma_f32_16x16x32_bf16 v[144:147], v[232:235], v[204:207], v[144:147]
    ds_read_b64_tr_b16 v[228:229], v249 offset:96
    v_mfma_f32_16x16x32_bf16 v[148:151], v[232:235], v[208:211], v[148:151]
    ds_read_b64_tr_b16 v[230:231], v249 offset:8544
    v_mfma_f32_16x16x32_bf16 v[152:155], v[232:235], v[212:215], v[152:155]
    v_mfma_f32_16x16x32_bf16 v[156:159], v[236:239], v[204:207], v[156:159]
    ds_read_b64_tr_b16 v[232:233], v249 offset:128
    v_mfma_f32_16x16x32_bf16 v[160:163], v[236:239], v[208:211], v[160:163]
    ds_read_b64_tr_b16 v[234:235], v249 offset:8576
    v_mfma_f32_16x16x32_bf16 v[164:167], v[236:239], v[212:215], v[164:167]
    v_mfma_f32_16x16x32_bf16 v[168:171], v[240:243], v[204:207], v[168:171]
    ds_read_b64_tr_b16 v[236:237], v249 offset:160
    v_mfma_f32_16x16x32_bf16 v[172:175], v[240:243], v[208:211], v[172:175]
    ds_read_b64_tr_b16 v[238:239], v249 offset:8608
    v_mfma_f32_16x16x32_bf16 v[176:179], v[240:243], v[212:215], v[176:179]
    v_mfma_f32_16x16x32_bf16 v[180:183], v[244:247], v[204:207], v[180:183]
    ds_read_b64_tr_b16 v[240:241], v249 offset:192
    v_mfma_f32_16x16x32_bf16 v[184:187], v[244:247], v[208:211], v[184:187]
    ds_read_b64_tr_b16 v[242:243], v249 offset:8640
    v_mfma_f32_16x16x32_bf16 v[188:191], v[244:247], v[212:215], v[188:191]
    s_waitcnt lgkmcnt(12)
    v_mfma_f32_16x16x32_bf16 v[0:3], v[216:219], v[192:195], v[0:3]
    ds_read_b64_tr_b16 v[244:245], v249 offset:224
    v_mfma_f32_16x16x32_bf16 v[4:7], v[216:219], v[196:199], v[4:7]
    ds_read_b64_tr_b16 v[246:247], v249 offset:8672
    v_mfma_f32_16x16x32_bf16 v[8:11], v[216:219], v[200:203], v[8:11]
    s_waitcnt lgkmcnt(12)
    v_mfma_f32_16x16x32_bf16 v[12:15], v[220:223], v[192:195], v[12:15]
    ds_read_b64_tr_b16 v[216:217], v249 offset:256
    v_mfma_f32_16x16x32_bf16 v[16:19], v[220:223], v[196:199], v[16:19]
    ds_read_b64_tr_b16 v[218:219], v249 offset:8704
    v_mfma_f32_16x16x32_bf16 v[20:23], v[220:223], v[200:203], v[20:23]
    s_waitcnt lgkmcnt(12)
    v_mfma_f32_16x16x32_bf16 v[24:27], v[224:227], v[192:195], v[24:27]
    ds_read_b64_tr_b16 v[220:221], v249 offset:288
    v_mfma_f32_16x16x32_bf16 v[28:31], v[224:227], v[196:199], v[28:31]
    ds_read_b64_tr_b16 v[222:223], v249 offset:8736
    v_mfma_f32_16x16x32_bf16 v[32:35], v[224:227], v[200:203], v[32:35]
    s_waitcnt lgkmcnt(12)
    v_mfma_f32_16x16x32_bf16 v[36:39], v[228:231], v[192:195], v[36:39]
    ds_read_b64_tr_b16 v[224:225], v249 offset:320
    v_mfma_f32_16x16x32_bf16 v[40:43], v[228:231], v[196:199], v[40:43]
    ds_read_b64_tr_b16 v[226:227], v249 offset:8768
    v_mfma_f32_16x16x32_bf16 v[44:47], v[228:231], v[200:203], v[44:47]
    s_waitcnt lgkmcnt(12)
    v_mfma_f32_16x16x32_bf16 v[48:51], v[232:235], v[192:195], v[48:51]
    ds_read_b64_tr_b16 v[228:229], v249 offset:352
    v_mfma_f32_16x16x32_bf16 v[52:55], v[232:235], v[196:199], v[52:55]
    ds_read_b64_tr_b16 v[230:231], v249 offset:8800
    v_mfma_f32_16x16x32_bf16 v[56:59], v[232:235], v[200:203], v[56:59]
    s_waitcnt lgkmcnt(12)
    v_mfma_f32_16x16x32_bf16 v[60:63], v[236:239], v[192:195], v[60:63]
    ds_read_b64_tr_b16 v[232:233], v249 offset:384
    v_mfma_f32_16x16x32_bf16 v[64:67], v[236:239], v[196:199], v[64:67]
    ds_read_b64_tr_b16 v[234:235], v249 offset:8832
    v_mfma_f32_16x16x32_bf16 v[68:71], v[236:239], v[200:203], v[68:71]
    s_waitcnt lgkmcnt(12)
    v_mfma_f32_16x16x32_bf16 v[72:75], v[240:243], v[192:195], v[72:75]
    ds_read_b64_tr_b16 v[236:237], v249 offset:416
    v_mfma_f32_16x16x32_bf16 v[76:79], v[240:243], v[196:199], v[76:79]
    ds_read_b64_tr_b16 v[238:239], v249 offset:8864
    v_mfma_f32_16x16x32_bf16 v[80:83], v[240:243], v[200:203], v[80:83]
    s_waitcnt lgkmcnt(12)
    v_mfma_f32_16x16x32_bf16 v[84:87], v[244:247], v[192:195], v[84:87]
    ds_read_b64_tr_b16 v[240:241], v249 offset:448
    v_mfma_f32_16x16x32_bf16 v[88:91], v[244:247], v[196:199], v[88:91]
    ds_read_b64_tr_b16 v[242:243], v249 offset:8896
    v_mfma_f32_16x16x32_bf16 v[92:95], v[244:247], v[200:203], v[92:95]
    s_waitcnt lgkmcnt(12)
    v_mfma_f32_16x16x32_bf16 v[96:99], v[216:219], v[192:195], v[96:99]
    ds_read_b64_tr_b16 v[244:245], v249 offset:480
    v_mfma_f32_16x16x32_bf16 v[100:103], v[216:219], v[196:199], v[100:103]
    ds_read_b64_tr_b16 v[246:247], v249 offset:8928
    v_mfma_f32_16x16x32_bf16 v[104:107], v[216:219], v[200:203], v[104:107]
    s_waitcnt lgkmcnt(12)
    v_mfma_f32_16x16x32_bf16 v[108:111], v[220:223], v[192:195], v[108:111]
    v_mfma_f32_16x16x32_bf16 v[112:115], v[220:223], v[196:199], v[112:115]
    v_mfma_f32_16x16x32_bf16 v[116:119], v[220:223], v[200:203], v[116:119]
    s_waitcnt lgkmcnt(0)
    s_barrier
    v_mfma_f32_16x16x32_bf16 v[120:123], v[224:227], v[192:195], v[120:123]
    ds_read_b128 v[204:207], v252 offset:33792
    ds_read_b128 v[208:211], v252 offset:35840
    v_mfma_f32_16x16x32_bf16 v[124:127], v[224:227], v[196:199], v[124:127]
    ds_read_b128 v[212:215], v252 offset:37888
    ds_read_b64_tr_b16 v[216:217], v250 offset:0
    v_mfma_f32_16x16x32_bf16 v[128:131], v[224:227], v[200:203], v[128:131]
    ds_read_b64_tr_b16 v[218:219], v250 offset:8448
    v_mfma_f32_16x16x32_bf16 v[132:135], v[228:231], v[192:195], v[132:135]
    ds_read_b64_tr_b16 v[220:221], v250 offset:32
    ds_read_b64_tr_b16 v[222:223], v250 offset:8480
    v_mfma_f32_16x16x32_bf16 v[136:139], v[228:231], v[196:199], v[136:139]
    ds_read_b64_tr_b16 v[224:225], v250 offset:64
    v_mfma_f32_16x16x32_bf16 v[140:143], v[228:231], v[200:203], v[140:143]
    ds_read_b64_tr_b16 v[226:227], v250 offset:8512
    v_mfma_f32_16x16x32_bf16 v[144:147], v[232:235], v[192:195], v[144:147]
    ds_read_b64_tr_b16 v[228:229], v250 offset:96
    v_mfma_f32_16x16x32_bf16 v[148:151], v[232:235], v[196:199], v[148:151]
    ds_read_b64_tr_b16 v[230:231], v250 offset:8544
    v_mfma_f32_16x16x32_bf16 v[152:155], v[232:235], v[200:203], v[152:155]
    v_mfma_f32_16x16x32_bf16 v[156:159], v[236:239], v[192:195], v[156:159]
    ds_read_b64_tr_b16 v[232:233], v250 offset:128
    v_mfma_f32_16x16x32_bf16 v[160:163], v[236:239], v[196:199], v[160:163]
    ds_read_b64_tr_b16 v[234:235], v250 offset:8576
    v_mfma_f32_16x16x32_bf16 v[164:167], v[236:239], v[200:203], v[164:167]
    v_mfma_f32_16x16x32_bf16 v[168:171], v[240:243], v[192:195], v[168:171]
    ds_read_b64_tr_b16 v[236:237], v250 offset:160
    v_mfma_f32_16x16x32_bf16 v[172:175], v[240:243], v[196:199], v[172:175]
    ds_read_b64_tr_b16 v[238:239], v250 offset:8608
    v_mfma_f32_16x16x32_bf16 v[176:179], v[240:243], v[200:203], v[176:179]
    v_mfma_f32_16x16x32_bf16 v[180:183], v[244:247], v[192:195], v[180:183]
    ds_read_b64_tr_b16 v[240:241], v250 offset:192
    v_mfma_f32_16x16x32_bf16 v[184:187], v[244:247], v[196:199], v[184:187]
    ds_read_b64_tr_b16 v[242:243], v250 offset:8640
    v_mfma_f32_16x16x32_bf16 v[188:191], v[244:247], v[200:203], v[188:191]
    s_waitcnt lgkmcnt(12)
    v_mfma_f32_16x16x32_bf16 v[0:3], v[216:219], v[204:207], v[0:3]
    ds_read_b64_tr_b16 v[244:245], v250 offset:224
    v_mfma_f32_16x16x32_bf16 v[4:7], v[216:219], v[208:211], v[4:7]
    ds_read_b64_tr_b16 v[246:247], v250 offset:8672
    v_mfma_f32_16x16x32_bf16 v[8:11], v[216:219], v[212:215], v[8:11]
    s_waitcnt lgkmcnt(12)
    v_mfma_f32_16x16x32_bf16 v[12:15], v[220:223], v[204:207], v[12:15]
    ds_read_b64_tr_b16 v[216:217], v250 offset:256
    v_mfma_f32_16x16x32_bf16 v[16:19], v[220:223], v[208:211], v[16:19]
    ds_read_b64_tr_b16 v[218:219], v250 offset:8704
    v_mfma_f32_16x16x32_bf16 v[20:23], v[220:223], v[212:215], v[20:23]
    s_waitcnt lgkmcnt(12)
    v_mfma_f32_16x16x32_bf16 v[24:27], v[224:227], v[204:207], v[24:27]
    ds_read_b64_tr_b16 v[220:221], v250 offset:288
    v_mfma_f32_16x16x32_bf16 v[28:31], v[224:227], v[208:211], v[28:31]
    ds_read_b64_tr_b16 v[222:223], v250 offset:8736
    v_mfma_f32_16x16x32_bf16 v[32:35], v[224:227], v[212:215], v[32:35]
    s_waitcnt lgkmcnt(12)
    v_mfma_f32_16x16x32_bf16 v[36:39], v[228:231], v[204:207], v[36:39]
    ds_read_b64_tr_b16 v[224:225], v250 offset:320
    v_mfma_f32_16x16x32_bf16 v[40:43], v[228:231], v[208:211], v[40:43]
    ds_read_b64_tr_b16 v[226:227], v250 offset:8768
    v_mfma_f32_16x16x32_bf16 v[44:47], v[228:231], v[212:215], v[44:47]
    s_waitcnt lgkmcnt(12)
    v_mfma_f32_16x16x32_bf16 v[48:51], v[232:235], v[204:207], v[48:51]
    ds_read_b64_tr_b16 v[228:229], v250 offset:352
    v_mfma_f32_16x16x32_bf16 v[52:55], v[232:235], v[208:211], v[52:55]
    ds_read_b64_tr_b16 v[230:231], v250 offset:8800
    v_mfma_f32_16x16x32_bf16 v[56:59], v[232:235], v[212:215], v[56:59]
    s_waitcnt lgkmcnt(12)
    v_mfma_f32_16x16x32_bf16 v[60:63], v[236:239], v[204:207], v[60:63]
    ds_read_b64_tr_b16 v[232:233], v250 offset:384
    v_mfma_f32_16x16x32_bf16 v[64:67], v[236:239], v[208:211], v[64:67]
    ds_read_b64_tr_b16 v[234:235], v250 offset:8832
    v_mfma_f32_16x16x32_bf16 v[68:71], v[236:239], v[212:215], v[68:71]
    s_waitcnt lgkmcnt(12)
    v_mfma_f32_16x16x32_bf16 v[72:75], v[240:243], v[204:207], v[72:75]
    ds_read_b64_tr_b16 v[236:237], v250 offset:416
    v_mfma_f32_16x16x32_bf16 v[76:79], v[240:243], v[208:211], v[76:79]
    ds_read_b64_tr_b16 v[238:239], v250 offset:8864
    v_mfma_f32_16x16x32_bf16 v[80:83], v[240:243], v[212:215], v[80:83]
    s_waitcnt lgkmcnt(12)
    v_mfma_f32_16x16x32_bf16 v[84:87], v[244:247], v[204:207], v[84:87]
    ds_read_b64_tr_b16 v[240:241], v250 offset:448
    v_mfma_f32_16x16x32_bf16 v[88:91], v[244:247], v[208:211], v[88:91]
    ds_read_b64_tr_b16 v[242:243], v250 offset:8896
    v_mfma_f32_16x16x32_bf16 v[92:95], v[244:247], v[212:215], v[92:95]
    s_waitcnt lgkmcnt(12)
    v_mfma_f32_16x16x32_bf16 v[96:99], v[216:219], v[204:207], v[96:99]
    ds_read_b64_tr_b16 v[244:245], v250 offset:480
    v_mfma_f32_16x16x32_bf16 v[100:103], v[216:219], v[208:211], v[100:103]
    ds_read_b64_tr_b16 v[246:247], v250 offset:8928
    v_mfma_f32_16x16x32_bf16 v[104:107], v[216:219], v[212:215], v[104:107]
    s_waitcnt lgkmcnt(12)
    v_mfma_f32_16x16x32_bf16 v[108:111], v[220:223], v[204:207], v[108:111]
    v_mfma_f32_16x16x32_bf16 v[112:115], v[220:223], v[208:211], v[112:115]
    v_mfma_f32_16x16x32_bf16 v[116:119], v[220:223], v[212:215], v[116:119]
    s_waitcnt lgkmcnt(0)
    s_barrier
    v_mfma_f32_16x16x32_bf16 v[120:123], v[224:227], v[204:207], v[120:123]
    ds_read_b128 v[192:195], v251 offset:46080
    ds_read_b128 v[196:199], v251 offset:48128
    v_mfma_f32_16x16x32_bf16 v[124:127], v[224:227], v[208:211], v[124:127]
    ds_read_b128 v[200:203], v251 offset:50176
    ds_read_b64_tr_b16 v[216:217], v248 offset:0
    v_mfma_f32_16x16x32_bf16 v[128:131], v[224:227], v[212:215], v[128:131]
    ds_read_b64_tr_b16 v[218:219], v248 offset:8448
    v_mfma_f32_16x16x32_bf16 v[132:135], v[228:231], v[204:207], v[132:135]
    ds_read_b64_tr_b16 v[220:221], v248 offset:32
    ds_read_b64_tr_b16 v[222:223], v248 offset:8480
    v_mfma_f32_16x16x32_bf16 v[136:139], v[228:231], v[208:211], v[136:139]
    ds_read_b64_tr_b16 v[224:225], v248 offset:64
    v_mfma_f32_16x16x32_bf16 v[140:143], v[228:231], v[212:215], v[140:143]
    ds_read_b64_tr_b16 v[226:227], v248 offset:8512
    v_mfma_f32_16x16x32_bf16 v[144:147], v[232:235], v[204:207], v[144:147]
    ds_read_b64_tr_b16 v[228:229], v248 offset:96
    v_mfma_f32_16x16x32_bf16 v[148:151], v[232:235], v[208:211], v[148:151]
    ds_read_b64_tr_b16 v[230:231], v248 offset:8544
    v_mfma_f32_16x16x32_bf16 v[152:155], v[232:235], v[212:215], v[152:155]
    v_mfma_f32_16x16x32_bf16 v[156:159], v[236:239], v[204:207], v[156:159]
    ds_read_b64_tr_b16 v[232:233], v248 offset:128
    v_mfma_f32_16x16x32_bf16 v[160:163], v[236:239], v[208:211], v[160:163]
    ds_read_b64_tr_b16 v[234:235], v248 offset:8576
    v_mfma_f32_16x16x32_bf16 v[164:167], v[236:239], v[212:215], v[164:167]
    v_mfma_f32_16x16x32_bf16 v[168:171], v[240:243], v[204:207], v[168:171]
    ds_read_b64_tr_b16 v[236:237], v248 offset:160
    v_mfma_f32_16x16x32_bf16 v[172:175], v[240:243], v[208:211], v[172:175]
    ds_read_b64_tr_b16 v[238:239], v248 offset:8608
    v_mfma_f32_16x16x32_bf16 v[176:179], v[240:243], v[212:215], v[176:179]
    v_mfma_f32_16x16x32_bf16 v[180:183], v[244:247], v[204:207], v[180:183]
    ds_read_b64_tr_b16 v[240:241], v248 offset:192
    v_mfma_f32_16x16x32_bf16 v[184:187], v[244:247], v[208:211], v[184:187]
    ds_read_b64_tr_b16 v[242:243], v248 offset:8640
    v_mfma_f32_16x16x32_bf16 v[188:191], v[244:247], v[212:215], v[188:191]
    s_waitcnt lgkmcnt(12)
    v_mfma_f32_16x16x32_bf16 v[0:3], v[216:219], v[192:195], v[0:3]
    ds_read_b64_tr_b16 v[244:245], v248 offset:224
    v_mfma_f32_16x16x32_bf16 v[4:7], v[216:219], v[196:199], v[4:7]
    ds_read_b64_tr_b16 v[246:247], v248 offset:8672
    v_mfma_f32_16x16x32_bf16 v[8:11], v[216:219], v[200:203], v[8:11]
    s_waitcnt lgkmcnt(12)
    v_mfma_f32_16x16x32_bf16 v[12:15], v[220:223], v[192:195], v[12:15]
    ds_read_b64_tr_b16 v[216:217], v248 offset:256
    v_mfma_f32_16x16x32_bf16 v[16:19], v[220:223], v[196:199], v[16:19]
    ds_read_b64_tr_b16 v[218:219], v248 offset:8704
    v_mfma_f32_16x16x32_bf16 v[20:23], v[220:223], v[200:203], v[20:23]
    s_waitcnt lgkmcnt(12)
    v_mfma_f32_16x16x32_bf16 v[24:27], v[224:227], v[192:195], v[24:27]
    ds_read_b64_tr_b16 v[220:221], v248 offset:288
    v_mfma_f32_16x16x32_bf16 v[28:31], v[224:227], v[196:199], v[28:31]
    ds_read_b64_tr_b16 v[222:223], v248 offset:8736
    v_mfma_f32_16x16x32_bf16 v[32:35], v[224:227], v[200:203], v[32:35]
    s_waitcnt lgkmcnt(12)
    v_mfma_f32_16x16x32_bf16 v[36:39], v[228:231], v[192:195], v[36:39]
    ds_read_b64_tr_b16 v[224:225], v248 offset:320
    v_mfma_f32_16x16x32_bf16 v[40:43], v[228:231], v[196:199], v[40:43]
    ds_read_b64_tr_b16 v[226:227], v248 offset:8768
    v_mfma_f32_16x16x32_bf16 v[44:47], v[228:231], v[200:203], v[44:47]
    s_waitcnt lgkmcnt(12)
    v_mfma_f32_16x16x32_bf16 v[48:51], v[232:235], v[192:195], v[48:51]
    ds_read_b64_tr_b16 v[228:229], v248 offset:352
    v_mfma_f32_16x16x32_bf16 v[52:55], v[232:235], v[196:199], v[52:55]
    ds_read_b64_tr_b16 v[230:231], v248 offset:8800
    v_mfma_f32_16x16x32_bf16 v[56:59], v[232:235], v[200:203], v[56:59]
    s_waitcnt lgkmcnt(12)
    v_mfma_f32_16x16x32_bf16 v[60:63], v[236:239], v[192:195], v[60:63]
    ds_read_b64_tr_b16 v[232:233], v248 offset:384
    v_mfma_f32_16x16x32_bf16 v[64:67], v[236:239], v[196:199], v[64:67]
    ds_read_b64_tr_b16 v[234:235], v248 offset:8832
    v_mfma_f32_16x16x32_bf16 v[68:71], v[236:239], v[200:203], v[68:71]
    s_waitcnt lgkmcnt(12)
    v_mfma_f32_16x16x32_bf16 v[72:75], v[240:243], v[192:195], v[72:75]
    ds_read_b64_tr_b16 v[236:237], v248 offset:416
    v_mfma_f32_16x16x32_bf16 v[76:79], v[240:243], v[196:199], v[76:79]
    ds_read_b64_tr_b16 v[238:239], v248 offset:8864
    v_mfma_f32_16x16x32_bf16 v[80:83], v[240:243], v[200:203], v[80:83]
    s_waitcnt lgkmcnt(12)
    v_mfma_f32_16x16x32_bf16 v[84:87], v[244:247], v[192:195], v[84:87]
    ds_read_b64_tr_b16 v[240:241], v248 offset:448
    v_mfma_f32_16x16x32_bf16 v[88:91], v[244:247], v[196:199], v[88:91]
    ds_read_b64_tr_b16 v[242:243], v248 offset:8896
    v_mfma_f32_16x16x32_bf16 v[92:95], v[244:247], v[200:203], v[92:95]
    s_waitcnt lgkmcnt(12)
    v_mfma_f32_16x16x32_bf16 v[96:99], v[216:219], v[192:195], v[96:99]
    ds_read_b64_tr_b16 v[244:245], v248 offset:480
    v_mfma_f32_16x16x32_bf16 v[100:103], v[216:219], v[196:199], v[100:103]
    ds_read_b64_tr_b16 v[246:247], v248 offset:8928
    v_mfma_f32_16x16x32_bf16 v[104:107], v[216:219], v[200:203], v[104:107]
    s_waitcnt lgkmcnt(12)
    v_mfma_f32_16x16x32_bf16 v[108:111], v[220:223], v[192:195], v[108:111]
    v_mfma_f32_16x16x32_bf16 v[112:115], v[220:223], v[196:199], v[112:115]
    v_mfma_f32_16x16x32_bf16 v[116:119], v[220:223], v[200:203], v[116:119]
    s_waitcnt lgkmcnt(0)
    s_barrier
    v_mfma_f32_16x16x32_bf16 v[120:123], v[224:227], v[192:195], v[120:123]
    ds_read_b128 v[204:207], v252 offset:46080
    ds_read_b128 v[208:211], v252 offset:48128
    v_mfma_f32_16x16x32_bf16 v[124:127], v[224:227], v[196:199], v[124:127]
    ds_read_b128 v[212:215], v252 offset:50176
    ds_read_b64_tr_b16 v[216:217], v249 offset:0
    v_mfma_f32_16x16x32_bf16 v[128:131], v[224:227], v[200:203], v[128:131]
    ds_read_b64_tr_b16 v[218:219], v249 offset:8448
    v_mfma_f32_16x16x32_bf16 v[132:135], v[228:231], v[192:195], v[132:135]
    ds_read_b64_tr_b16 v[220:221], v249 offset:32
    ds_read_b64_tr_b16 v[222:223], v249 offset:8480
    v_mfma_f32_16x16x32_bf16 v[136:139], v[228:231], v[196:199], v[136:139]
    ds_read_b64_tr_b16 v[224:225], v249 offset:64
    v_mfma_f32_16x16x32_bf16 v[140:143], v[228:231], v[200:203], v[140:143]
    ds_read_b64_tr_b16 v[226:227], v249 offset:8512
    v_mfma_f32_16x16x32_bf16 v[144:147], v[232:235], v[192:195], v[144:147]
    ds_read_b64_tr_b16 v[228:229], v249 offset:96
    v_mfma_f32_16x16x32_bf16 v[148:151], v[232:235], v[196:199], v[148:151]
    ds_read_b64_tr_b16 v[230:231], v249 offset:8544
    v_mfma_f32_16x16x32_bf16 v[152:155], v[232:235], v[200:203], v[152:155]
    v_mfma_f32_16x16x32_bf16 v[156:159], v[236:239], v[192:195], v[156:159]
    ds_read_b64_tr_b16 v[232:233], v249 offset:128
    v_mfma_f32_16x16x32_bf16 v[160:163], v[236:239], v[196:199], v[160:163]
    ds_read_b64_tr_b16 v[234:235], v249 offset:8576
    v_mfma_f32_16x16x32_bf16 v[164:167], v[236:239], v[200:203], v[164:167]
    v_mfma_f32_16x16x32_bf16 v[168:171], v[240:243], v[192:195], v[168:171]
    ds_read_b64_tr_b16 v[236:237], v249 offset:160
    v_mfma_f32_16x16x32_bf16 v[172:175], v[240:243], v[196:199], v[172:175]
    ds_read_b64_tr_b16 v[238:239], v249 offset:8608
    v_mfma_f32_16x16x32_bf16 v[176:179], v[240:243], v[200:203], v[176:179]
    v_mfma_f32_16x16x32_bf16 v[180:183], v[244:247], v[192:195], v[180:183]
    ds_read_b64_tr_b16 v[240:241], v249 offset:192
    v_mfma_f32_16x16x32_bf16 v[184:187], v[244:247], v[196:199], v[184:187]
    ds_read_b64_tr_b16 v[242:243], v249 offset:8640
    v_mfma_f32_16x16x32_bf16 v[188:191], v[244:247], v[200:203], v[188:191]
    s_waitcnt lgkmcnt(12)
    v_mfma_f32_16x16x32_bf16 v[0:3], v[216:219], v[204:207], v[0:3]
    ds_read_b64_tr_b16 v[244:245], v249 offset:224
    v_mfma_f32_16x16x32_bf16 v[4:7], v[216:219], v[208:211], v[4:7]
    ds_read_b64_tr_b16 v[246:247], v249 offset:8672
    v_mfma_f32_16x16x32_bf16 v[8:11], v[216:219], v[212:215], v[8:11]
    s_waitcnt lgkmcnt(12)
    v_mfma_f32_16x16x32_bf16 v[12:15], v[220:223], v[204:207], v[12:15]
    ds_read_b64_tr_b16 v[216:217], v249 offset:256
    v_mfma_f32_16x16x32_bf16 v[16:19], v[220:223], v[208:211], v[16:19]
    ds_read_b64_tr_b16 v[218:219], v249 offset:8704
    v_mfma_f32_16x16x32_bf16 v[20:23], v[220:223], v[212:215], v[20:23]
    s_waitcnt lgkmcnt(12)
    v_mfma_f32_16x16x32_bf16 v[24:27], v[224:227], v[204:207], v[24:27]
    ds_read_b64_tr_b16 v[220:221], v249 offset:288
    v_mfma_f32_16x16x32_bf16 v[28:31], v[224:227], v[208:211], v[28:31]
    ds_read_b64_tr_b16 v[222:223], v249 offset:8736
    v_mfma_f32_16x16x32_bf16 v[32:35], v[224:227], v[212:215], v[32:35]
    s_waitcnt lgkmcnt(12)
    v_mfma_f32_16x16x32_bf16 v[36:39], v[228:231], v[204:207], v[36:39]
    ds_read_b64_tr_b16 v[224:225], v249 offset:320
    v_mfma_f32_16x16x32_bf16 v[40:43], v[228:231], v[208:211], v[40:43]
    ds_read_b64_tr_b16 v[226:227], v249 offset:8768
    v_mfma_f32_16x16x32_bf16 v[44:47], v[228:231], v[212:215], v[44:47]
    s_waitcnt lgkmcnt(12)
    v_mfma_f32_16x16x32_bf16 v[48:51], v[232:235], v[204:207], v[48:51]
    ds_read_b64_tr_b16 v[228:229], v249 offset:352
    v_mfma_f32_16x16x32_bf16 v[52:55], v[232:235], v[208:211], v[52:55]
    ds_read_b64_tr_b16 v[230:231], v249 offset:8800
    v_mfma_f32_16x16x32_bf16 v[56:59], v[232:235], v[212:215], v[56:59]
    s_waitcnt lgkmcnt(12)
    v_mfma_f32_16x16x32_bf16 v[60:63], v[236:239], v[204:207], v[60:63]
    ds_read_b64_tr_b16 v[232:233], v249 offset:384
    v_mfma_f32_16x16x32_bf16 v[64:67], v[236:239], v[208:211], v[64:67]
    ds_read_b64_tr_b16 v[234:235], v249 offset:8832
    v_mfma_f32_16x16x32_bf16 v[68:71], v[236:239], v[212:215], v[68:71]
    s_waitcnt lgkmcnt(12)
    v_mfma_f32_16x16x32_bf16 v[72:75], v[240:243], v[204:207], v[72:75]
    ds_read_b64_tr_b16 v[236:237], v249 offset:416
    v_mfma_f32_16x16x32_bf16 v[76:79], v[240:243], v[208:211], v[76:79]
    ds_read_b64_tr_b16 v[238:239], v249 offset:8864
    v_mfma_f32_16x16x32_bf16 v[80:83], v[240:243], v[212:215], v[80:83]
    s_waitcnt lgkmcnt(12)
    v_mfma_f32_16x16x32_bf16 v[84:87], v[244:247], v[204:207], v[84:87]
    ds_read_b64_tr_b16 v[240:241], v249 offset:448
    v_mfma_f32_16x16x32_bf16 v[88:91], v[244:247], v[208:211], v[88:91]
    ds_read_b64_tr_b16 v[242:243], v249 offset:8896
    v_mfma_f32_16x16x32_bf16 v[92:95], v[244:247], v[212:215], v[92:95]
    s_waitcnt lgkmcnt(12)
    v_mfma_f32_16x16x32_bf16 v[96:99], v[216:219], v[204:207], v[96:99]
    ds_read_b64_tr_b16 v[244:245], v249 offset:480
    v_mfma_f32_16x16x32_bf16 v[100:103], v[216:219], v[208:211], v[100:103]
    ds_read_b64_tr_b16 v[246:247], v249 offset:8928
    v_mfma_f32_16x16x32_bf16 v[104:107], v[216:219], v[212:215], v[104:107]
    s_waitcnt lgkmcnt(12)
    v_mfma_f32_16x16x32_bf16 v[108:111], v[220:223], v[204:207], v[108:111]
    v_mfma_f32_16x16x32_bf16 v[112:115], v[220:223], v[208:211], v[112:115]
    v_mfma_f32_16x16x32_bf16 v[116:119], v[220:223], v[212:215], v[116:119]
    s_waitcnt lgkmcnt(0)
    s_barrier
    v_mfma_f32_16x16x32_bf16 v[120:123], v[224:227], v[204:207], v[120:123]
    ds_read_b128 v[192:195], v251 offset:33792
    ds_read_b128 v[196:199], v251 offset:35840
    v_mfma_f32_16x16x32_bf16 v[124:127], v[224:227], v[208:211], v[124:127]
    ds_read_b128 v[200:203], v251 offset:37888
    ds_read_b64_tr_b16 v[216:217], v250 offset:0
    v_mfma_f32_16x16x32_bf16 v[128:131], v[224:227], v[212:215], v[128:131]
    ds_read_b64_tr_b16 v[218:219], v250 offset:8448
    v_mfma_f32_16x16x32_bf16 v[132:135], v[228:231], v[204:207], v[132:135]
    ds_read_b64_tr_b16 v[220:221], v250 offset:32
    ds_read_b64_tr_b16 v[222:223], v250 offset:8480
    v_mfma_f32_16x16x32_bf16 v[136:139], v[228:231], v[208:211], v[136:139]
    ds_read_b64_tr_b16 v[224:225], v250 offset:64
    v_mfma_f32_16x16x32_bf16 v[140:143], v[228:231], v[212:215], v[140:143]
    ds_read_b64_tr_b16 v[226:227], v250 offset:8512
    v_mfma_f32_16x16x32_bf16 v[144:147], v[232:235], v[204:207], v[144:147]
    ds_read_b64_tr_b16 v[228:229], v250 offset:96
    v_mfma_f32_16x16x32_bf16 v[148:151], v[232:235], v[208:211], v[148:151]
    ds_read_b64_tr_b16 v[230:231], v250 offset:8544
    v_mfma_f32_16x16x32_bf16 v[152:155], v[232:235], v[212:215], v[152:155]
    v_mfma_f32_16x16x32_bf16 v[156:159], v[236:239], v[204:207], v[156:159]
    ds_read_b64_tr_b16 v[232:233], v250 offset:128
    v_mfma_f32_16x16x32_bf16 v[160:163], v[236:239], v[208:211], v[160:163]
    ds_read_b64_tr_b16 v[234:235], v250 offset:8576
    v_mfma_f32_16x16x32_bf16 v[164:167], v[236:239], v[212:215], v[164:167]
    v_mfma_f32_16x16x32_bf16 v[168:171], v[240:243], v[204:207], v[168:171]
    ds_read_b64_tr_b16 v[236:237], v250 offset:160
    v_mfma_f32_16x16x32_bf16 v[172:175], v[240:243], v[208:211], v[172:175]
    ds_read_b64_tr_b16 v[238:239], v250 offset:8608
    v_mfma_f32_16x16x32_bf16 v[176:179], v[240:243], v[212:215], v[176:179]
    v_mfma_f32_16x16x32_bf16 v[180:183], v[244:247], v[204:207], v[180:183]
    ds_read_b64_tr_b16 v[240:241], v250 offset:192
    v_mfma_f32_16x16x32_bf16 v[184:187], v[244:247], v[208:211], v[184:187]
    ds_read_b64_tr_b16 v[242:243], v250 offset:8640
    v_mfma_f32_16x16x32_bf16 v[188:191], v[244:247], v[212:215], v[188:191]
    s_waitcnt lgkmcnt(12)
    v_mfma_f32_16x16x32_bf16 v[0:3], v[216:219], v[192:195], v[0:3]
    ds_read_b64_tr_b16 v[244:245], v250 offset:224
    v_mfma_f32_16x16x32_bf16 v[4:7], v[216:219], v[196:199], v[4:7]
    ds_read_b64_tr_b16 v[246:247], v250 offset:8672
    v_mfma_f32_16x16x32_bf16 v[8:11], v[216:219], v[200:203], v[8:11]
    s_waitcnt lgkmcnt(12)
    v_mfma_f32_16x16x32_bf16 v[12:15], v[220:223], v[192:195], v[12:15]
    ds_read_b64_tr_b16 v[216:217], v250 offset:256
    v_mfma_f32_16x16x32_bf16 v[16:19], v[220:223], v[196:199], v[16:19]
    ds_read_b64_tr_b16 v[218:219], v250 offset:8704
    v_mfma_f32_16x16x32_bf16 v[20:23], v[220:223], v[200:203], v[20:23]
    s_waitcnt lgkmcnt(12)
    v_mfma_f32_16x16x32_bf16 v[24:27], v[224:227], v[192:195], v[24:27]
    ds_read_b64_tr_b16 v[220:221], v250 offset:288
    v_mfma_f32_16x16x32_bf16 v[28:31], v[224:227], v[196:199], v[28:31]
    ds_read_b64_tr_b16 v[222:223], v250 offset:8736
    v_mfma_f32_16x16x32_bf16 v[32:35], v[224:227], v[200:203], v[32:35]
    s_waitcnt lgkmcnt(12)
    v_mfma_f32_16x16x32_bf16 v[36:39], v[228:231], v[192:195], v[36:39]
    ds_read_b64_tr_b16 v[224:225], v250 offset:320
    v_mfma_f32_16x16x32_bf16 v[40:43], v[228:231], v[196:199], v[40:43]
    ds_read_b64_tr_b16 v[226:227], v250 offset:8768
    v_mfma_f32_16x16x32_bf16 v[44:47], v[228:231], v[200:203], v[44:47]
    s_waitcnt lgkmcnt(12)
    v_mfma_f32_16x16x32_bf16 v[48:51], v[232:235], v[192:195], v[48:51]
    ds_read_b64_tr_b16 v[228:229], v250 offset:352
    v_mfma_f32_16x16x32_bf16 v[52:55], v[232:235], v[196:199], v[52:55]
    ds_read_b64_tr_b16 v[230:231], v250 offset:8800
    v_mfma_f32_16x16x32_bf16 v[56:59], v[232:235], v[200:203], v[56:59]
    s_waitcnt lgkmcnt(12)
    v_mfma_f32_16x16x32_bf16 v[60:63], v[236:239], v[192:195], v[60:63]
    ds_read_b64_tr_b16 v[232:233], v250 offset:384
    v_mfma_f32_16x16x32_bf16 v[64:67], v[236:239], v[196:199], v[64:67]
    ds_read_b64_tr_b16 v[234:235], v250 offset:8832
    v_mfma_f32_16x16x32_bf16 v[68:71], v[236:239], v[200:203], v[68:71]
    s_waitcnt lgkmcnt(12)
    v_mfma_f32_16x16x32_bf16 v[72:75], v[240:243], v[192:195], v[72:75]
    ds_read_b64_tr_b16 v[236:237], v250 offset:416
    v_mfma_f32_16x16x32_bf16 v[76:79], v[240:243], v[196:199], v[76:79]
    ds_read_b64_tr_b16 v[238:239], v250 offset:8864
    v_mfma_f32_16x16x32_bf16 v[80:83], v[240:243], v[200:203], v[80:83]
    s_waitcnt lgkmcnt(12)
    v_mfma_f32_16x16x32_bf16 v[84:87], v[244:247], v[192:195], v[84:87]
    ds_read_b64_tr_b16 v[240:241], v250 offset:448
    v_mfma_f32_16x16x32_bf16 v[88:91], v[244:247], v[196:199], v[88:91]
    ds_read_b64_tr_b16 v[242:243], v250 offset:8896
    v_mfma_f32_16x16x32_bf16 v[92:95], v[244:247], v[200:203], v[92:95]
    s_waitcnt lgkmcnt(12)
    v_mfma_f32_16x16x32_bf16 v[96:99], v[216:219], v[192:195], v[96:99]
    ds_read_b64_tr_b16 v[244:245], v250 offset:480
    v_mfma_f32_16x16x32_bf16 v[100:103], v[216:219], v[196:199], v[100:103]
    ds_read_b64_tr_b16 v[246:247], v250 offset:8928
    v_mfma_f32_16x16x32_bf16 v[104:107], v[216:219], v[200:203], v[104:107]
    s_waitcnt lgkmcnt(12)
    v_mfma_f32_16x16x32_bf16 v[108:111], v[220:223], v[192:195], v[108:111]
    v_mfma_f32_16x16x32_bf16 v[112:115], v[220:223], v[196:199], v[112:115]
    v_mfma_f32_16x16x32_bf16 v[116:119], v[220:223], v[200:203], v[116:119]
    s_waitcnt lgkmcnt(0)
    s_barrier
    v_mfma_f32_16x16x32_bf16 v[120:123], v[224:227], v[192:195], v[120:123]
    ds_read_b128 v[204:207], v252 offset:33792
    ds_read_b128 v[208:211], v252 offset:35840
    v_mfma_f32_16x16x32_bf16 v[124:127], v[224:227], v[196:199], v[124:127]
    ds_read_b128 v[212:215], v252 offset:37888
    ds_read_b64_tr_b16 v[216:217], v248 offset:0
    v_mfma_f32_16x16x32_bf16 v[128:131], v[224:227], v[200:203], v[128:131]
    ds_read_b64_tr_b16 v[218:219], v248 offset:8448
    v_mfma_f32_16x16x32_bf16 v[132:135], v[228:231], v[192:195], v[132:135]
    ds_read_b64_tr_b16 v[220:221], v248 offset:32
    ds_read_b64_tr_b16 v[222:223], v248 offset:8480
    v_mfma_f32_16x16x32_bf16 v[136:139], v[228:231], v[196:199], v[136:139]
    ds_read_b64_tr_b16 v[224:225], v248 offset:64
    v_mfma_f32_16x16x32_bf16 v[140:143], v[228:231], v[200:203], v[140:143]
    ds_read_b64_tr_b16 v[226:227], v248 offset:8512
    v_mfma_f32_16x16x32_bf16 v[144:147], v[232:235], v[192:195], v[144:147]
    ds_read_b64_tr_b16 v[228:229], v248 offset:96
    v_mfma_f32_16x16x32_bf16 v[148:151], v[232:235], v[196:199], v[148:151]
    ds_read_b64_tr_b16 v[230:231], v248 offset:8544
    v_mfma_f32_16x16x32_bf16 v[152:155], v[232:235], v[200:203], v[152:155]
    v_mfma_f32_16x16x32_bf16 v[156:159], v[236:239], v[192:195], v[156:159]
    ds_read_b64_tr_b16 v[232:233], v248 offset:128
    v_mfma_f32_16x16x32_bf16 v[160:163], v[236:239], v[196:199], v[160:163]
    ds_read_b64_tr_b16 v[234:235], v248 offset:8576
    v_mfma_f32_16x16x32_bf16 v[164:167], v[236:239], v[200:203], v[164:167]
    v_mfma_f32_16x16x32_bf16 v[168:171], v[240:243], v[192:195], v[168:171]
    ds_read_b64_tr_b16 v[236:237], v248 offset:160
    v_mfma_f32_16x16x32_bf16 v[172:175], v[240:243], v[196:199], v[172:175]
    ds_read_b64_tr_b16 v[238:239], v248 offset:8608
    v_mfma_f32_16x16x32_bf16 v[176:179], v[240:243], v[200:203], v[176:179]
    v_mfma_f32_16x16x32_bf16 v[180:183], v[244:247], v[192:195], v[180:183]
    ds_read_b64_tr_b16 v[240:241], v248 offset:192
    v_mfma_f32_16x16x32_bf16 v[184:187], v[244:247], v[196:199], v[184:187]
    ds_read_b64_tr_b16 v[242:243], v248 offset:8640
    v_mfma_f32_16x16x32_bf16 v[188:191], v[244:247], v[200:203], v[188:191]
    s_waitcnt lgkmcnt(12)
    v_mfma_f32_16x16x32_bf16 v[0:3], v[216:219], v[204:207], v[0:3]
    ds_read_b64_tr_b16 v[244:245], v248 offset:224
    v_mfma_f32_16x16x32_bf16 v[4:7], v[216:219], v[208:211], v[4:7]
    ds_read_b64_tr_b16 v[246:247], v248 offset:8672
    v_mfma_f32_16x16x32_bf16 v[8:11], v[216:219], v[212:215], v[8:11]
    s_waitcnt lgkmcnt(12)
    v_mfma_f32_16x16x32_bf16 v[12:15], v[220:223], v[204:207], v[12:15]
    ds_read_b64_tr_b16 v[216:217], v248 offset:256
    v_mfma_f32_16x16x32_bf16 v[16:19], v[220:223], v[208:211], v[16:19]
    ds_read_b64_tr_b16 v[218:219], v248 offset:8704
    v_mfma_f32_16x16x32_bf16 v[20:23], v[220:223], v[212:215], v[20:23]
    s_waitcnt lgkmcnt(12)
    v_mfma_f32_16x16x32_bf16 v[24:27], v[224:227], v[204:207], v[24:27]
    ds_read_b64_tr_b16 v[220:221], v248 offset:288
    v_mfma_f32_16x16x32_bf16 v[28:31], v[224:227], v[208:211], v[28:31]
    ds_read_b64_tr_b16 v[222:223], v248 offset:8736
    v_mfma_f32_16x16x32_bf16 v[32:35], v[224:227], v[212:215], v[32:35]
    s_waitcnt lgkmcnt(12)
    v_mfma_f32_16x16x32_bf16 v[36:39], v[228:231], v[204:207], v[36:39]
    ds_read_b64_tr_b16 v[224:225], v248 offset:320
    v_mfma_f32_16x16x32_bf16 v[40:43], v[228:231], v[208:211], v[40:43]
    ds_read_b64_tr_b16 v[226:227], v248 offset:8768
    v_mfma_f32_16x16x32_bf16 v[44:47], v[228:231], v[212:215], v[44:47]
    s_waitcnt lgkmcnt(12)
    v_mfma_f32_16x16x32_bf16 v[48:51], v[232:235], v[204:207], v[48:51]
    ds_read_b64_tr_b16 v[228:229], v248 offset:352
    v_mfma_f32_16x16x32_bf16 v[52:55], v[232:235], v[208:211], v[52:55]
    ds_read_b64_tr_b16 v[230:231], v248 offset:8800
    v_mfma_f32_16x16x32_bf16 v[56:59], v[232:235], v[212:215], v[56:59]
    s_waitcnt lgkmcnt(12)
    v_mfma_f32_16x16x32_bf16 v[60:63], v[236:239], v[204:207], v[60:63]
    ds_read_b64_tr_b16 v[232:233], v248 offset:384
    v_mfma_f32_16x16x32_bf16 v[64:67], v[236:239], v[208:211], v[64:67]
    ds_read_b64_tr_b16 v[234:235], v248 offset:8832
    v_mfma_f32_16x16x32_bf16 v[68:71], v[236:239], v[212:215], v[68:71]
    s_waitcnt lgkmcnt(12)
    v_mfma_f32_16x16x32_bf16 v[72:75], v[240:243], v[204:207], v[72:75]
    ds_read_b64_tr_b16 v[236:237], v248 offset:416
    v_mfma_f32_16x16x32_bf16 v[76:79], v[240:243], v[208:211], v[76:79]
    ds_read_b64_tr_b16 v[238:239], v248 offset:8864
    v_mfma_f32_16x16x32_bf16 v[80:83], v[240:243], v[212:215], v[80:83]
    s_waitcnt lgkmcnt(12)
    v_mfma_f32_16x16x32_bf16 v[84:87], v[244:247], v[204:207], v[84:87]
    ds_read_b64_tr_b16 v[240:241], v248 offset:448
    v_mfma_f32_16x16x32_bf16 v[88:91], v[244:247], v[208:211], v[88:91]
    ds_read_b64_tr_b16 v[242:243], v248 offset:8896
    v_mfma_f32_16x16x32_bf16 v[92:95], v[244:247], v[212:215], v[92:95]
    s_waitcnt lgkmcnt(12)
    v_mfma_f32_16x16x32_bf16 v[96:99], v[216:219], v[204:207], v[96:99]
    ds_read_b64_tr_b16 v[244:245], v248 offset:480
    v_mfma_f32_16x16x32_bf16 v[100:103], v[216:219], v[208:211], v[100:103]
    ds_read_b64_tr_b16 v[246:247], v248 offset:8928
    v_mfma_f32_16x16x32_bf16 v[104:107], v[216:219], v[212:215], v[104:107]
    s_waitcnt lgkmcnt(12)
    v_mfma_f32_16x16x32_bf16 v[108:111], v[220:223], v[204:207], v[108:111]
    v_mfma_f32_16x16x32_bf16 v[112:115], v[220:223], v[208:211], v[112:115]
    v_mfma_f32_16x16x32_bf16 v[116:119], v[220:223], v[212:215], v[116:119]
    s_waitcnt lgkmcnt(0)
    s_barrier
    v_mfma_f32_16x16x32_bf16 v[120:123], v[224:227], v[204:207], v[120:123]
    ds_read_b128 v[192:195], v251 offset:46080
    ds_read_b128 v[196:199], v251 offset:48128
    v_mfma_f32_16x16x32_bf16 v[124:127], v[224:227], v[208:211], v[124:127]
    ds_read_b128 v[200:203], v251 offset:50176
    ds_read_b64_tr_b16 v[216:217], v249 offset:0
    v_mfma_f32_16x16x32_bf16 v[128:131], v[224:227], v[212:215], v[128:131]
    ds_read_b64_tr_b16 v[218:219], v249 offset:8448
    v_mfma_f32_16x16x32_bf16 v[132:135], v[228:231], v[204:207], v[132:135]
    ds_read_b64_tr_b16 v[220:221], v249 offset:32
    ds_read_b64_tr_b16 v[222:223], v249 offset:8480
    v_mfma_f32_16x16x32_bf16 v[136:139], v[228:231], v[208:211], v[136:139]
    ds_read_b64_tr_b16 v[224:225], v249 offset:64
    v_mfma_f32_16x16x32_bf16 v[140:143], v[228:231], v[212:215], v[140:143]
    ds_read_b64_tr_b16 v[226:227], v249 offset:8512
    v_mfma_f32_16x16x32_bf16 v[144:147], v[232:235], v[204:207], v[144:147]
    ds_read_b64_tr_b16 v[228:229], v249 offset:96
    v_mfma_f32_16x16x32_bf16 v[148:151], v[232:235], v[208:211], v[148:151]
    ds_read_b64_tr_b16 v[230:231], v249 offset:8544
    v_mfma_f32_16x16x32_bf16 v[152:155], v[232:235], v[212:215], v[152:155]
    v_mfma_f32_16x16x32_bf16 v[156:159], v[236:239], v[204:207], v[156:159]
    ds_read_b64_tr_b16 v[232:233], v249 offset:128
    v_mfma_f32_16x16x32_bf16 v[160:163], v[236:239], v[208:211], v[160:163]
    ds_read_b64_tr_b16 v[234:235], v249 offset:8576
    v_mfma_f32_16x16x32_bf16 v[164:167], v[236:239], v[212:215], v[164:167]
    v_mfma_f32_16x16x32_bf16 v[168:171], v[240:243], v[204:207], v[168:171]
    ds_read_b64_tr_b16 v[236:237], v249 offset:160
    v_mfma_f32_16x16x32_bf16 v[172:175], v[240:243], v[208:211], v[172:175]
    ds_read_b64_tr_b16 v[238:239], v249 offset:8608
    v_mfma_f32_16x16x32_bf16 v[176:179], v[240:243], v[212:215], v[176:179]
    v_mfma_f32_16x16x32_bf16 v[180:183], v[244:247], v[204:207], v[180:183]
    ds_read_b64_tr_b16 v[240:241], v249 offset:192
    v_mfma_f32_16x16x32_bf16 v[184:187], v[244:247], v[208:211], v[184:187]
    ds_read_b64_tr_b16 v[242:243], v249 offset:8640
    v_mfma_f32_16x16x32_bf16 v[188:191], v[244:247], v[212:215], v[188:191]
    s_waitcnt lgkmcnt(12)
    v_mfma_f32_16x16x32_bf16 v[0:3], v[216:219], v[192:195], v[0:3]
    ds_read_b64_tr_b16 v[244:245], v249 offset:224
    v_mfma_f32_16x16x32_bf16 v[4:7], v[216:219], v[196:199], v[4:7]
    ds_read_b64_tr_b16 v[246:247], v249 offset:8672
    v_mfma_f32_16x16x32_bf16 v[8:11], v[216:219], v[200:203], v[8:11]
    s_waitcnt lgkmcnt(12)
    v_mfma_f32_16x16x32_bf16 v[12:15], v[220:223], v[192:195], v[12:15]
    ds_read_b64_tr_b16 v[216:217], v249 offset:256
    v_mfma_f32_16x16x32_bf16 v[16:19], v[220:223], v[196:199], v[16:19]
    ds_read_b64_tr_b16 v[218:219], v249 offset:8704
    v_mfma_f32_16x16x32_bf16 v[20:23], v[220:223], v[200:203], v[20:23]
    s_waitcnt lgkmcnt(12)
    v_mfma_f32_16x16x32_bf16 v[24:27], v[224:227], v[192:195], v[24:27]
    ds_read_b64_tr_b16 v[220:221], v249 offset:288
    v_mfma_f32_16x16x32_bf16 v[28:31], v[224:227], v[196:199], v[28:31]
    ds_read_b64_tr_b16 v[222:223], v249 offset:8736
    v_mfma_f32_16x16x32_bf16 v[32:35], v[224:227], v[200:203], v[32:35]
    s_waitcnt lgkmcnt(12)
    v_mfma_f32_16x16x32_bf16 v[36:39], v[228:231], v[192:195], v[36:39]
    ds_read_b64_tr_b16 v[224:225], v249 offset:320
    v_mfma_f32_16x16x32_bf16 v[40:43], v[228:231], v[196:199], v[40:43]
    ds_read_b64_tr_b16 v[226:227], v249 offset:8768
    v_mfma_f32_16x16x32_bf16 v[44:47], v[228:231], v[200:203], v[44:47]
    s_waitcnt lgkmcnt(12)
    v_mfma_f32_16x16x32_bf16 v[48:51], v[232:235], v[192:195], v[48:51]
    ds_read_b64_tr_b16 v[228:229], v249 offset:352
    v_mfma_f32_16x16x32_bf16 v[52:55], v[232:235], v[196:199], v[52:55]
    ds_read_b64_tr_b16 v[230:231], v249 offset:8800
    v_mfma_f32_16x16x32_bf16 v[56:59], v[232:235], v[200:203], v[56:59]
    s_waitcnt lgkmcnt(12)
    v_mfma_f32_16x16x32_bf16 v[60:63], v[236:239], v[192:195], v[60:63]
    ds_read_b64_tr_b16 v[232:233], v249 offset:384
    v_mfma_f32_16x16x32_bf16 v[64:67], v[236:239], v[196:199], v[64:67]
    ds_read_b64_tr_b16 v[234:235], v249 offset:8832
    v_mfma_f32_16x16x32_bf16 v[68:71], v[236:239], v[200:203], v[68:71]
    s_waitcnt lgkmcnt(12)
    v_mfma_f32_16x16x32_bf16 v[72:75], v[240:243], v[192:195], v[72:75]
    ds_read_b64_tr_b16 v[236:237], v249 offset:416
    v_mfma_f32_16x16x32_bf16 v[76:79], v[240:243], v[196:199], v[76:79]
    ds_read_b64_tr_b16 v[238:239], v249 offset:8864
    v_mfma_f32_16x16x32_bf16 v[80:83], v[240:243], v[200:203], v[80:83]
    s_waitcnt lgkmcnt(12)
    v_mfma_f32_16x16x32_bf16 v[84:87], v[244:247], v[192:195], v[84:87]
    ds_read_b64_tr_b16 v[240:241], v249 offset:448
    v_mfma_f32_16x16x32_bf16 v[88:91], v[244:247], v[196:199], v[88:91]
    ds_read_b64_tr_b16 v[242:243], v249 offset:8896
    v_mfma_f32_16x16x32_bf16 v[92:95], v[244:247], v[200:203], v[92:95]
    s_waitcnt lgkmcnt(12)
    v_mfma_f32_16x16x32_bf16 v[96:99], v[216:219], v[192:195], v[96:99]
    ds_read_b64_tr_b16 v[244:245], v249 offset:480
    v_mfma_f32_16x16x32_bf16 v[100:103], v[216:219], v[196:199], v[100:103]
    ds_read_b64_tr_b16 v[246:247], v249 offset:8928
    v_mfma_f32_16x16x32_bf16 v[104:107], v[216:219], v[200:203], v[104:107]
    s_waitcnt lgkmcnt(12)
    v_mfma_f32_16x16x32_bf16 v[108:111], v[220:223], v[192:195], v[108:111]
    v_mfma_f32_16x16x32_bf16 v[112:115], v[220:223], v[196:199], v[112:115]
    v_mfma_f32_16x16x32_bf16 v[116:119], v[220:223], v[200:203], v[116:119]
    s_waitcnt lgkmcnt(0)
    s_barrier
    v_mfma_f32_16x16x32_bf16 v[120:123], v[224:227], v[192:195], v[120:123]
    ds_read_b128 v[204:207], v252 offset:46080
    ds_read_b128 v[208:211], v252 offset:48128
    v_mfma_f32_16x16x32_bf16 v[124:127], v[224:227], v[196:199], v[124:127]
    ds_read_b128 v[212:215], v252 offset:50176
    ds_read_b64_tr_b16 v[216:217], v250 offset:0
    v_mfma_f32_16x16x32_bf16 v[128:131], v[224:227], v[200:203], v[128:131]
    ds_read_b64_tr_b16 v[218:219], v250 offset:8448
    v_mfma_f32_16x16x32_bf16 v[132:135], v[228:231], v[192:195], v[132:135]
    ds_read_b64_tr_b16 v[220:221], v250 offset:32
    ds_read_b64_tr_b16 v[222:223], v250 offset:8480
    v_mfma_f32_16x16x32_bf16 v[136:139], v[228:231], v[196:199], v[136:139]
    ds_read_b64_tr_b16 v[224:225], v250 offset:64
    v_mfma_f32_16x16x32_bf16 v[140:143], v[228:231], v[200:203], v[140:143]
    ds_read_b64_tr_b16 v[226:227], v250 offset:8512
    v_mfma_f32_16x16x32_bf16 v[144:147], v[232:235], v[192:195], v[144:147]
    ds_read_b64_tr_b16 v[228:229], v250 offset:96
    v_mfma_f32_16x16x32_bf16 v[148:151], v[232:235], v[196:199], v[148:151]
    ds_read_b64_tr_b16 v[230:231], v250 offset:8544
    v_mfma_f32_16x16x32_bf16 v[152:155], v[232:235], v[200:203], v[152:155]
    v_mfma_f32_16x16x32_bf16 v[156:159], v[236:239], v[192:195], v[156:159]
    ds_read_b64_tr_b16 v[232:233], v250 offset:128
    v_mfma_f32_16x16x32_bf16 v[160:163], v[236:239], v[196:199], v[160:163]
    ds_read_b64_tr_b16 v[234:235], v250 offset:8576
    v_mfma_f32_16x16x32_bf16 v[164:167], v[236:239], v[200:203], v[164:167]
    v_mfma_f32_16x16x32_bf16 v[168:171], v[240:243], v[192:195], v[168:171]
    ds_read_b64_tr_b16 v[236:237], v250 offset:160
    v_mfma_f32_16x16x32_bf16 v[172:175], v[240:243], v[196:199], v[172:175]
    ds_read_b64_tr_b16 v[238:239], v250 offset:8608
    v_mfma_f32_16x16x32_bf16 v[176:179], v[240:243], v[200:203], v[176:179]
    v_mfma_f32_16x16x32_bf16 v[180:183], v[244:247], v[192:195], v[180:183]
    ds_read_b64_tr_b16 v[240:241], v250 offset:192
    v_mfma_f32_16x16x32_bf16 v[184:187], v[244:247], v[196:199], v[184:187]
    ds_read_b64_tr_b16 v[242:243], v250 offset:8640
    v_mfma_f32_16x16x32_bf16 v[188:191], v[244:247], v[200:203], v[188:191]
    s_waitcnt lgkmcnt(12)
    v_mfma_f32_16x16x32_bf16 v[0:3], v[216:219], v[204:207], v[0:3]
    ds_read_b64_tr_b16 v[244:245], v250 offset:224
    v_mfma_f32_16x16x32_bf16 v[4:7], v[216:219], v[208:211], v[4:7]
    ds_read_b64_tr_b16 v[246:247], v250 offset:8672
    v_mfma_f32_16x16x32_bf16 v[8:11], v[216:219], v[212:215], v[8:11]
    s_waitcnt lgkmcnt(12)
    v_mfma_f32_16x16x32_bf16 v[12:15], v[220:223], v[204:207], v[12:15]
    ds_read_b64_tr_b16 v[216:217], v250 offset:256
    v_mfma_f32_16x16x32_bf16 v[16:19], v[220:223], v[208:211], v[16:19]
    ds_read_b64_tr_b16 v[218:219], v250 offset:8704
    v_mfma_f32_16x16x32_bf16 v[20:23], v[220:223], v[212:215], v[20:23]
    s_waitcnt lgkmcnt(12)
    v_mfma_f32_16x16x32_bf16 v[24:27], v[224:227], v[204:207], v[24:27]
    ds_read_b64_tr_b16 v[220:221], v250 offset:288
    v_mfma_f32_16x16x32_bf16 v[28:31], v[224:227], v[208:211], v[28:31]
    ds_read_b64_tr_b16 v[222:223], v250 offset:8736
    v_mfma_f32_16x16x32_bf16 v[32:35], v[224:227], v[212:215], v[32:35]
    s_waitcnt lgkmcnt(12)
    v_mfma_f32_16x16x32_bf16 v[36:39], v[228:231], v[204:207], v[36:39]
    ds_read_b64_tr_b16 v[224:225], v250 offset:320
    v_mfma_f32_16x16x32_bf16 v[40:43], v[228:231], v[208:211], v[40:43]
    ds_read_b64_tr_b16 v[226:227], v250 offset:8768
    v_mfma_f32_16x16x32_bf16 v[44:47], v[228:231], v[212:215], v[44:47]
    s_waitcnt lgkmcnt(12)
    v_mfma_f32_16x16x32_bf16 v[48:51], v[232:235], v[204:207], v[48:51]
    ds_read_b64_tr_b16 v[228:229], v250 offset:352
    v_mfma_f32_16x16x32_bf16 v[52:55], v[232:235], v[208:211], v[52:55]
    ds_read_b64_tr_b16 v[230:231], v250 offset:8800
    v_mfma_f32_16x16x32_bf16 v[56:59], v[232:235], v[212:215], v[56:59]
    s_waitcnt lgkmcnt(12)
    v_mfma_f32_16x16x32_bf16 v[60:63], v[236:239], v[204:207], v[60:63]
    ds_read_b64_tr_b16 v[232:233], v250 offset:384
    v_mfma_f32_16x16x32_bf16 v[64:67], v[236:239], v[208:211], v[64:67]
    ds_read_b64_tr_b16 v[234:235], v250 offset:8832
    v_mfma_f32_16x16x32_bf16 v[68:71], v[236:239], v[212:215], v[68:71]
    s_waitcnt lgkmcnt(12)
    v_mfma_f32_16x16x32_bf16 v[72:75], v[240:243], v[204:207], v[72:75]
    ds_read_b64_tr_b16 v[236:237], v250 offset:416
    v_mfma_f32_16x16x32_bf16 v[76:79], v[240:243], v[208:211], v[76:79]
    ds_read_b64_tr_b16 v[238:239], v250 offset:8864
    v_mfma_f32_16x16x32_bf16 v[80:83], v[240:243], v[212:215], v[80:83]
    s_waitcnt lgkmcnt(12)
    v_mfma_f32_16x16x32_bf16 v[84:87], v[244:247], v[204:207], v[84:87]
    ds_read_b64_tr_b16 v[240:241], v250 offset:448
    v_mfma_f32_16x16x32_bf16 v[88:91], v[244:247], v[208:211], v[88:91]
    ds_read_b64_tr_b16 v[242:243], v250 offset:8896
    v_mfma_f32_16x16x32_bf16 v[92:95], v[244:247], v[212:215], v[92:95]
    s_waitcnt lgkmcnt(12)
    v_mfma_f32_16x16x32_bf16 v[96:99], v[216:219], v[204:207], v[96:99]
    ds_read_b64_tr_b16 v[244:245], v250 offset:480
    v_mfma_f32_16x16x32_bf16 v[100:103], v[216:219], v[208:211], v[100:103]
    ds_read_b64_tr_b16 v[246:247], v250 offset:8928
    v_mfma_f32_16x16x32_bf16 v[104:107], v[216:219], v[212:215], v[104:107]
    s_waitcnt lgkmcnt(12)
    v_mfma_f32_16x16x32_bf16 v[108:111], v[220:223], v[204:207], v[108:111]
    v_mfma_f32_16x16x32_bf16 v[112:115], v[220:223], v[208:211], v[112:115]
    v_mfma_f32_16x16x32_bf16 v[116:119], v[220:223], v[212:215], v[116:119]
    s_waitcnt lgkmcnt(0)
    s_barrier
    v_mfma_f32_16x16x32_bf16 v[120:123], v[224:227], v[204:207], v[120:123]
    ds_read_b128 v[192:195], v251 offset:33792
    ds_read_b128 v[196:199], v251 offset:35840
    v_mfma_f32_16x16x32_bf16 v[124:127], v[224:227], v[208:211], v[124:127]
    ds_read_b128 v[200:203], v251 offset:37888
    ds_read_b64_tr_b16 v[216:217], v248 offset:0
    v_mfma_f32_16x16x32_bf16 v[128:131], v[224:227], v[212:215], v[128:131]
    ds_read_b64_tr_b16 v[218:219], v248 offset:8448
    v_mfma_f32_16x16x32_bf16 v[132:135], v[228:231], v[204:207], v[132:135]
    ds_read_b64_tr_b16 v[220:221], v248 offset:32
    ds_read_b64_tr_b16 v[222:223], v248 offset:8480
    v_mfma_f32_16x16x32_bf16 v[136:139], v[228:231], v[208:211], v[136:139]
    ds_read_b64_tr_b16 v[224:225], v248 offset:64
    v_mfma_f32_16x16x32_bf16 v[140:143], v[228:231], v[212:215], v[140:143]
    ds_read_b64_tr_b16 v[226:227], v248 offset:8512
    v_mfma_f32_16x16x32_bf16 v[144:147], v[232:235], v[204:207], v[144:147]
    ds_read_b64_tr_b16 v[228:229], v248 offset:96
    v_mfma_f32_16x16x32_bf16 v[148:151], v[232:235], v[208:211], v[148:151]
    ds_read_b64_tr_b16 v[230:231], v248 offset:8544
    v_mfma_f32_16x16x32_bf16 v[152:155], v[232:235], v[212:215], v[152:155]
    v_mfma_f32_16x16x32_bf16 v[156:159], v[236:239], v[204:207], v[156:159]
    ds_read_b64_tr_b16 v[232:233], v248 offset:128
    v_mfma_f32_16x16x32_bf16 v[160:163], v[236:239], v[208:211], v[160:163]
    ds_read_b64_tr_b16 v[234:235], v248 offset:8576
    v_mfma_f32_16x16x32_bf16 v[164:167], v[236:239], v[212:215], v[164:167]
    v_mfma_f32_16x16x32_bf16 v[168:171], v[240:243], v[204:207], v[168:171]
    ds_read_b64_tr_b16 v[236:237], v248 offset:160
    v_mfma_f32_16x16x32_bf16 v[172:175], v[240:243], v[208:211], v[172:175]
    ds_read_b64_tr_b16 v[238:239], v248 offset:8608
    v_mfma_f32_16x16x32_bf16 v[176:179], v[240:243], v[212:215], v[176:179]
    v_mfma_f32_16x16x32_bf16 v[180:183], v[244:247], v[204:207], v[180:183]
    ds_read_b64_tr_b16 v[240:241], v248 offset:192
    v_mfma_f32_16x16x32_bf16 v[184:187], v[244:247], v[208:211], v[184:187]
    ds_read_b64_tr_b16 v[242:243], v248 offset:8640
    v_mfma_f32_16x16x32_bf16 v[188:191], v[244:247], v[212:215], v[188:191]
    s_waitcnt lgkmcnt(12)
    v_mfma_f32_16x16x32_bf16 v[0:3], v[216:219], v[192:195], v[0:3]
    ds_read_b64_tr_b16 v[244:245], v248 offset:224
    v_mfma_f32_16x16x32_bf16 v[4:7], v[216:219], v[196:199], v[4:7]
    ds_read_b64_tr_b16 v[246:247], v248 offset:8672
    v_mfma_f32_16x16x32_bf16 v[8:11], v[216:219], v[200:203], v[8:11]
    s_waitcnt lgkmcnt(12)
    v_mfma_f32_16x16x32_bf16 v[12:15], v[220:223], v[192:195], v[12:15]
    ds_read_b64_tr_b16 v[216:217], v248 offset:256
    v_mfma_f32_16x16x32_bf16 v[16:19], v[220:223], v[196:199], v[16:19]
    ds_read_b64_tr_b16 v[218:219], v248 offset:8704
    v_mfma_f32_16x16x32_bf16 v[20:23], v[220:223], v[200:203], v[20:23]
    s_waitcnt lgkmcnt(12)
    v_mfma_f32_16x16x32_bf16 v[24:27], v[224:227], v[192:195], v[24:27]
    ds_read_b64_tr_b16 v[220:221], v248 offset:288
    v_mfma_f32_16x16x32_bf16 v[28:31], v[224:227], v[196:199], v[28:31]
    ds_read_b64_tr_b16 v[222:223], v248 offset:8736
    v_mfma_f32_16x16x32_bf16 v[32:35], v[224:227], v[200:203], v[32:35]
    s_waitcnt lgkmcnt(12)
    v_mfma_f32_16x16x32_bf16 v[36:39], v[228:231], v[192:195], v[36:39]
    ds_read_b64_tr_b16 v[224:225], v248 offset:320
    v_mfma_f32_16x16x32_bf16 v[40:43], v[228:231], v[196:199], v[40:43]
    ds_read_b64_tr_b16 v[226:227], v248 offset:8768
    v_mfma_f32_16x16x32_bf16 v[44:47], v[228:231], v[200:203], v[44:47]
    s_waitcnt lgkmcnt(12)
    v_mfma_f32_16x16x32_bf16 v[48:51], v[232:235], v[192:195], v[48:51]
    ds_read_b64_tr_b16 v[228:229], v248 offset:352
    v_mfma_f32_16x16x32_bf16 v[52:55], v[232:235], v[196:199], v[52:55]
    ds_read_b64_tr_b16 v[230:231], v248 offset:8800
    v_mfma_f32_16x16x32_bf16 v[56:59], v[232:235], v[200:203], v[56:59]
    s_waitcnt lgkmcnt(12)
    v_mfma_f32_16x16x32_bf16 v[60:63], v[236:239], v[192:195], v[60:63]
    ds_read_b64_tr_b16 v[232:233], v248 offset:384
    v_mfma_f32_16x16x32_bf16 v[64:67], v[236:239], v[196:199], v[64:67]
    ds_read_b64_tr_b16 v[234:235], v248 offset:8832
    v_mfma_f32_16x16x32_bf16 v[68:71], v[236:239], v[200:203], v[68:71]
    s_waitcnt lgkmcnt(12)
    v_mfma_f32_16x16x32_bf16 v[72:75], v[240:243], v[192:195], v[72:75]
    ds_read_b64_tr_b16 v[236:237], v248 offset:416
    v_mfma_f32_16x16x32_bf16 v[76:79], v[240:243], v[196:199], v[76:79]
    ds_read_b64_tr_b16 v[238:239], v248 offset:8864
    v_mfma_f32_16x16x32_bf16 v[80:83], v[240:243], v[200:203], v[80:83]
    s_waitcnt lgkmcnt(12)
    v_mfma_f32_16x16x32_bf16 v[84:87], v[244:247], v[192:195], v[84:87]
    ds_read_b64_tr_b16 v[240:241], v248 offset:448
    v_mfma_f32_16x16x32_bf16 v[88:91], v[244:247], v[196:199], v[88:91]
    ds_read_b64_tr_b16 v[242:243], v248 offset:8896
    v_mfma_f32_16x16x32_bf16 v[92:95], v[244:247], v[200:203], v[92:95]
    s_waitcnt lgkmcnt(12)
    v_mfma_f32_16x16x32_bf16 v[96:99], v[216:219], v[192:195], v[96:99]
    ds_read_b64_tr_b16 v[244:245], v248 offset:480
    v_mfma_f32_16x16x32_bf16 v[100:103], v[216:219], v[196:199], v[100:103]
    ds_read_b64_tr_b16 v[246:247], v248 offset:8928
    v_mfma_f32_16x16x32_bf16 v[104:107], v[216:219], v[200:203], v[104:107]
    s_waitcnt lgkmcnt(12)
    v_mfma_f32_16x16x32_bf16 v[108:111], v[220:223], v[192:195], v[108:111]
    v_mfma_f32_16x16x32_bf16 v[112:115], v[220:223], v[196:199], v[112:115]
    v_mfma_f32_16x16x32_bf16 v[116:119], v[220:223], v[200:203], v[116:119]
    s_waitcnt lgkmcnt(0)
    s_barrier
    v_mfma_f32_16x16x32_bf16 v[120:123], v[224:227], v[192:195], v[120:123]
    ds_read_b128 v[204:207], v252 offset:33792
    ds_read_b128 v[208:211], v252 offset:35840
    v_mfma_f32_16x16x32_bf16 v[124:127], v[224:227], v[196:199], v[124:127]
    ds_read_b128 v[212:215], v252 offset:37888
    ds_read_b64_tr_b16 v[216:217], v249 offset:0
    v_mfma_f32_16x16x32_bf16 v[128:131], v[224:227], v[200:203], v[128:131]
    ds_read_b64_tr_b16 v[218:219], v249 offset:8448
    v_mfma_f32_16x16x32_bf16 v[132:135], v[228:231], v[192:195], v[132:135]
    ds_read_b64_tr_b16 v[220:221], v249 offset:32
    ds_read_b64_tr_b16 v[222:223], v249 offset:8480
    v_mfma_f32_16x16x32_bf16 v[136:139], v[228:231], v[196:199], v[136:139]
    ds_read_b64_tr_b16 v[224:225], v249 offset:64
    v_mfma_f32_16x16x32_bf16 v[140:143], v[228:231], v[200:203], v[140:143]
    ds_read_b64_tr_b16 v[226:227], v249 offset:8512
    v_mfma_f32_16x16x32_bf16 v[144:147], v[232:235], v[192:195], v[144:147]
    ds_read_b64_tr_b16 v[228:229], v249 offset:96
    v_mfma_f32_16x16x32_bf16 v[148:151], v[232:235], v[196:199], v[148:151]
    ds_read_b64_tr_b16 v[230:231], v249 offset:8544
    v_mfma_f32_16x16x32_bf16 v[152:155], v[232:235], v[200:203], v[152:155]
    v_mfma_f32_16x16x32_bf16 v[156:159], v[236:239], v[192:195], v[156:159]
    ds_read_b64_tr_b16 v[232:233], v249 offset:128
    v_mfma_f32_16x16x32_bf16 v[160:163], v[236:239], v[196:199], v[160:163]
    ds_read_b64_tr_b16 v[234:235], v249 offset:8576
    v_mfma_f32_16x16x32_bf16 v[164:167], v[236:239], v[200:203], v[164:167]
    v_mfma_f32_16x16x32_bf16 v[168:171], v[240:243], v[192:195], v[168:171]
    ds_read_b64_tr_b16 v[236:237], v249 offset:160
    v_mfma_f32_16x16x32_bf16 v[172:175], v[240:243], v[196:199], v[172:175]
    ds_read_b64_tr_b16 v[238:239], v249 offset:8608
    v_mfma_f32_16x16x32_bf16 v[176:179], v[240:243], v[200:203], v[176:179]
    v_mfma_f32_16x16x32_bf16 v[180:183], v[244:247], v[192:195], v[180:183]
    ds_read_b64_tr_b16 v[240:241], v249 offset:192
    v_mfma_f32_16x16x32_bf16 v[184:187], v[244:247], v[196:199], v[184:187]
    ds_read_b64_tr_b16 v[242:243], v249 offset:8640
    v_mfma_f32_16x16x32_bf16 v[188:191], v[244:247], v[200:203], v[188:191]
    s_waitcnt lgkmcnt(12)
    v_mfma_f32_16x16x32_bf16 v[0:3], v[216:219], v[204:207], v[0:3]
    ds_read_b64_tr_b16 v[244:245], v249 offset:224
    v_mfma_f32_16x16x32_bf16 v[4:7], v[216:219], v[208:211], v[4:7]
    ds_read_b64_tr_b16 v[246:247], v249 offset:8672
    v_mfma_f32_16x16x32_bf16 v[8:11], v[216:219], v[212:215], v[8:11]
    s_waitcnt lgkmcnt(12)
    v_mfma_f32_16x16x32_bf16 v[12:15], v[220:223], v[204:207], v[12:15]
    ds_read_b64_tr_b16 v[216:217], v249 offset:256
    v_mfma_f32_16x16x32_bf16 v[16:19], v[220:223], v[208:211], v[16:19]
    ds_read_b64_tr_b16 v[218:219], v249 offset:8704
    v_mfma_f32_16x16x32_bf16 v[20:23], v[220:223], v[212:215], v[20:23]
    s_waitcnt lgkmcnt(12)
    v_mfma_f32_16x16x32_bf16 v[24:27], v[224:227], v[204:207], v[24:27]
    ds_read_b64_tr_b16 v[220:221], v249 offset:288
    v_cvt_pk_bf16_f32 v0, v0, v1
    v_mfma_f32_16x16x32_bf16 v[28:31], v[224:227], v[208:211], v[28:31]
    ds_read_b64_tr_b16 v[222:223], v249 offset:8736
    v_cvt_pk_bf16_f32 v1, v2, v3
    v_mfma_f32_16x16x32_bf16 v[32:35], v[224:227], v[212:215], v[32:35]
    v_cvt_pk_bf16_f32 v2, v12, v13
    v_cvt_pk_bf16_f32 v3, v14, v15
    s_waitcnt lgkmcnt(12)
    v_mfma_f32_16x16x32_bf16 v[36:39], v[228:231], v[204:207], v[36:39]
    ds_read_b64_tr_b16 v[224:225], v249 offset:320
    v_cvt_pk_bf16_f32 v4, v4, v5
    v_mfma_f32_16x16x32_bf16 v[40:43], v[228:231], v[208:211], v[40:43]
    ds_read_b64_tr_b16 v[226:227], v249 offset:8768
    v_cvt_pk_bf16_f32 v5, v6, v7
    v_mfma_f32_16x16x32_bf16 v[44:47], v[228:231], v[212:215], v[44:47]
    v_cvt_pk_bf16_f32 v6, v16, v17
    v_cvt_pk_bf16_f32 v7, v18, v19
    s_waitcnt lgkmcnt(12)
    v_mfma_f32_16x16x32_bf16 v[48:51], v[232:235], v[204:207], v[48:51]
    ds_read_b64_tr_b16 v[228:229], v249 offset:352
    v_cvt_pk_bf16_f32 v8, v8, v9
    v_mfma_f32_16x16x32_bf16 v[52:55], v[232:235], v[208:211], v[52:55]
    ds_read_b64_tr_b16 v[230:231], v249 offset:8800
    v_cvt_pk_bf16_f32 v9, v10, v11
    v_mfma_f32_16x16x32_bf16 v[56:59], v[232:235], v[212:215], v[56:59]
    v_cvt_pk_bf16_f32 v10, v20, v21
    v_cvt_pk_bf16_f32 v11, v22, v23
    s_waitcnt lgkmcnt(12)
    v_mfma_f32_16x16x32_bf16 v[60:63], v[236:239], v[204:207], v[60:63]
    ds_read_b64_tr_b16 v[232:233], v249 offset:384
    v_cvt_pk_bf16_f32 v24, v24, v25
    v_mfma_f32_16x16x32_bf16 v[64:67], v[236:239], v[208:211], v[64:67]
    ds_read_b64_tr_b16 v[234:235], v249 offset:8832
    v_cvt_pk_bf16_f32 v25, v26, v27
    v_mfma_f32_16x16x32_bf16 v[68:71], v[236:239], v[212:215], v[68:71]
    v_cvt_pk_bf16_f32 v26, v36, v37
    v_cvt_pk_bf16_f32 v27, v38, v39
    s_waitcnt lgkmcnt(12)
    v_mfma_f32_16x16x32_bf16 v[72:75], v[240:243], v[204:207], v[72:75]
    ds_read_b64_tr_b16 v[236:237], v249 offset:416
    v_cvt_pk_bf16_f32 v28, v28, v29
    v_mfma_f32_16x16x32_bf16 v[76:79], v[240:243], v[208:211], v[76:79]
    ds_read_b64_tr_b16 v[238:239], v249 offset:8864
    v_cvt_pk_bf16_f32 v29, v30, v31
    v_mfma_f32_16x16x32_bf16 v[80:83], v[240:243], v[212:215], v[80:83]
    v_cvt_pk_bf16_f32 v30, v40, v41
    v_cvt_pk_bf16_f32 v31, v42, v43
    s_waitcnt lgkmcnt(12)
    v_mfma_f32_16x16x32_bf16 v[84:87], v[244:247], v[204:207], v[84:87]
    ds_read_b64_tr_b16 v[240:241], v249 offset:448
    v_cvt_pk_bf16_f32 v32, v32, v33
    v_mfma_f32_16x16x32_bf16 v[88:91], v[244:247], v[208:211], v[88:91]
    ds_read_b64_tr_b16 v[242:243], v249 offset:8896
    v_cvt_pk_bf16_f32 v33, v34, v35
    v_mfma_f32_16x16x32_bf16 v[92:95], v[244:247], v[212:215], v[92:95]
    v_cvt_pk_bf16_f32 v34, v44, v45
    v_cvt_pk_bf16_f32 v35, v46, v47
    s_waitcnt lgkmcnt(12)
    v_mfma_f32_16x16x32_bf16 v[96:99], v[216:219], v[204:207], v[96:99]
    ds_read_b64_tr_b16 v[244:245], v249 offset:480
    v_cvt_pk_bf16_f32 v48, v48, v49
    v_mfma_f32_16x16x32_bf16 v[100:103], v[216:219], v[208:211], v[100:103]
    ds_read_b64_tr_b16 v[246:247], v249 offset:8928
    v_cvt_pk_bf16_f32 v49, v50, v51
    v_mfma_f32_16x16x32_bf16 v[104:107], v[216:219], v[212:215], v[104:107]
    v_cvt_pk_bf16_f32 v50, v60, v61
    v_cvt_pk_bf16_f32 v51, v62, v63
    s_waitcnt lgkmcnt(12)
    v_mfma_f32_16x16x32_bf16 v[108:111], v[220:223], v[204:207], v[108:111]
    v_cvt_pk_bf16_f32 v52, v52, v53
    v_cvt_pk_bf16_f32 v53, v54, v55
    v_mfma_f32_16x16x32_bf16 v[112:115], v[220:223], v[208:211], v[112:115]
    v_cvt_pk_bf16_f32 v54, v64, v65
    v_cvt_pk_bf16_f32 v55, v66, v67
    v_mfma_f32_16x16x32_bf16 v[116:119], v[220:223], v[212:215], v[116:119]
    v_cvt_pk_bf16_f32 v56, v56, v57
    v_cvt_pk_bf16_f32 v57, v58, v59
    s_waitcnt lgkmcnt(0)
    s_barrier
    v_mfma_f32_16x16x32_bf16 v[120:123], v[224:227], v[204:207], v[120:123]
    ds_read_b64 v[216:217], v253 offset:0
    ds_read_b64 v[218:219], v253 offset:32
    v_mfma_f32_16x16x32_bf16 v[124:127], v[224:227], v[208:211], v[124:127]
    ds_read_b64 v[220:221], v253 offset:64
    v_cvt_pk_bf16_f32 v58, v68, v69
    v_mfma_f32_16x16x32_bf16 v[128:131], v[224:227], v[212:215], v[128:131]
    ds_read_b64 v[222:223], v253 offset:96
    v_cvt_pk_bf16_f32 v59, v70, v71
    v_mfma_f32_16x16x32_bf16 v[132:135], v[228:231], v[204:207], v[132:135]
    ds_read_b64 v[224:225], v253 offset:128
    v_cvt_pk_bf16_f32 v72, v72, v73
    v_mfma_f32_16x16x32_bf16 v[136:139], v[228:231], v[208:211], v[136:139]
    ds_read_b64 v[226:227], v253 offset:160
    v_cvt_pk_bf16_f32 v73, v74, v75
    v_mfma_f32_16x16x32_bf16 v[140:143], v[228:231], v[212:215], v[140:143]
    v_cvt_pk_bf16_f32 v74, v84, v85
    v_cvt_pk_bf16_f32 v75, v86, v87
    v_mfma_f32_16x16x32_bf16 v[144:147], v[232:235], v[204:207], v[144:147]
    ds_read_b64 v[228:229], v253 offset:192
    v_cvt_pk_bf16_f32 v76, v76, v77
    v_mfma_f32_16x16x32_bf16 v[148:151], v[232:235], v[208:211], v[148:151]
    ds_read_b64 v[230:231], v253 offset:224
    v_cvt_pk_bf16_f32 v77, v78, v79
    v_mfma_f32_16x16x32_bf16 v[152:155], v[232:235], v[212:215], v[152:155]
    v_cvt_pk_bf16_f32 v78, v88, v89
    v_cvt_pk_bf16_f32 v79, v90, v91
    v_mfma_f32_16x16x32_bf16 v[156:159], v[236:239], v[204:207], v[156:159]
    ds_read_b64 v[232:233], v253 offset:256
    v_cvt_pk_bf16_f32 v80, v80, v81
    v_mfma_f32_16x16x32_bf16 v[160:163], v[236:239], v[208:211], v[160:163]
    ds_read_b64 v[234:235], v253 offset:288
    v_cvt_pk_bf16_f32 v81, v82, v83
    v_mfma_f32_16x16x32_bf16 v[164:167], v[236:239], v[212:215], v[164:167]
    v_cvt_pk_bf16_f32 v82, v92, v93
    v_cvt_pk_bf16_f32 v83, v94, v95
    v_mfma_f32_16x16x32_bf16 v[168:171], v[240:243], v[204:207], v[168:171]
    ds_read_b64 v[236:237], v253 offset:320
    v_cvt_pk_bf16_f32 v96, v96, v97
    v_mfma_f32_16x16x32_bf16 v[172:175], v[240:243], v[208:211], v[172:175]
    ds_read_b64 v[238:239], v253 offset:352
    v_cvt_pk_bf16_f32 v97, v98, v99
    v_mfma_f32_16x16x32_bf16 v[176:179], v[240:243], v[212:215], v[176:179]
    v_cvt_pk_bf16_f32 v98, v108, v109
    v_cvt_pk_bf16_f32 v99, v110, v111
    v_mfma_f32_16x16x32_bf16 v[180:183], v[244:247], v[204:207], v[180:183]
    ds_read_b64 v[240:241], v253 offset:384
    v_cvt_pk_bf16_f32 v100, v100, v101
    v_mfma_f32_16x16x32_bf16 v[184:187], v[244:247], v[208:211], v[184:187]
    ds_read_b64 v[242:243], v253 offset:416
    v_cvt_pk_bf16_f32 v101, v102, v103
    v_mfma_f32_16x16x32_bf16 v[188:191], v[244:247], v[212:215], v[188:191]
    v_cvt_pk_bf16_f32 v102, v112, v113
    v_cvt_pk_bf16_f32 v103, v114, v115
    s_waitcnt lgkmcnt(12)
    v_mfma_f32_16x16x32_bf16 v[12:15], v[216:219], v[0:3], 0
    ds_read_b64 v[244:245], v253 offset:448
    v_cvt_pk_bf16_f32 v104, v104, v105
    v_mfma_f32_16x16x32_bf16 v[16:19], v[216:219], v[4:7], 0
    ds_read_b64 v[246:247], v253 offset:480
    v_cvt_pk_bf16_f32 v105, v106, v107
    v_mfma_f32_16x16x32_bf16 v[20:23], v[216:219], v[8:11], 0
    v_cvt_pk_bf16_f32 v106, v116, v117
    v_cvt_pk_bf16_f32 v107, v118, v119
    s_waitcnt lgkmcnt(12)
    v_mfma_f32_16x16x32_bf16 v[12:15], v[220:223], v[24:27], v[12:15]
    ds_read_b64 v[216:217], v253 offset:8448
    v_cvt_pk_bf16_f32 v120, v120, v121
    v_mfma_f32_16x16x32_bf16 v[16:19], v[220:223], v[28:31], v[16:19]
    ds_read_b64 v[218:219], v253 offset:8480
    v_cvt_pk_bf16_f32 v121, v122, v123
    v_mfma_f32_16x16x32_bf16 v[20:23], v[220:223], v[32:35], v[20:23]
    v_cvt_pk_bf16_f32 v122, v132, v133
    v_cvt_pk_bf16_f32 v123, v134, v135
    s_waitcnt lgkmcnt(12)
    v_mfma_f32_16x16x32_bf16 v[12:15], v[224:227], v[48:51], v[12:15]
    ds_read_b64 v[220:221], v253 offset:8512
    v_cvt_pk_bf16_f32 v124, v124, v125
    v_mfma_f32_16x16x32_bf16 v[16:19], v[224:227], v[52:55], v[16:19]
    ds_read_b64 v[222:223], v253 offset:8544
    v_cvt_pk_bf16_f32 v125, v126, v127
    v_mfma_f32_16x16x32_bf16 v[20:23], v[224:227], v[56:59], v[20:23]
    v_cvt_pk_bf16_f32 v126, v136, v137
    v_cvt_pk_bf16_f32 v127, v138, v139
    s_waitcnt lgkmcnt(12)
    v_mfma_f32_16x16x32_bf16 v[12:15], v[228:231], v[72:75], v[12:15]
    ds_read_b64 v[224:225], v253 offset:8576
    v_cvt_pk_bf16_f32 v128, v128, v129
    v_mfma_f32_16x16x32_bf16 v[16:19], v[228:231], v[76:79], v[16:19]
    ds_read_b64 v[226:227], v253 offset:8608
    v_cvt_pk_bf16_f32 v129, v130, v131
    v_mfma_f32_16x16x32_bf16 v[20:23], v[228:231], v[80:83], v[20:23]
    v_cvt_pk_bf16_f32 v130, v140, v141
    v_cvt_pk_bf16_f32 v131, v142, v143
    s_waitcnt lgkmcnt(12)
    v_mfma_f32_16x16x32_bf16 v[12:15], v[232:235], v[96:99], v[12:15]
    ds_read_b64 v[228:229], v253 offset:8640
    v_cvt_pk_bf16_f32 v144, v144, v145
    v_mfma_f32_16x16x32_bf16 v[16:19], v[232:235], v[100:103], v[16:19]
    ds_read_b64 v[230:231], v253 offset:8672
    v_cvt_pk_bf16_f32 v145, v146, v147
    v_mfma_f32_16x16x32_bf16 v[20:23], v[232:235], v[104:107], v[20:23]
    v_cvt_pk_bf16_f32 v146, v156, v157
    v_cvt_pk_bf16_f32 v147, v158, v159
    s_waitcnt lgkmcnt(12)
    v_mfma_f32_16x16x32_bf16 v[12:15], v[236:239], v[120:123], v[12:15]
    ds_read_b64 v[232:233], v253 offset:8704
    v_cvt_pk_bf16_f32 v148, v148, v149
    v_mfma_f32_16x16x32_bf16 v[16:19], v[236:239], v[124:127], v[16:19]
    ds_read_b64 v[234:235], v253 offset:8736
    v_cvt_pk_bf16_f32 v149, v150, v151
    v_mfma_f32_16x16x32_bf16 v[20:23], v[236:239], v[128:131], v[20:23]
    v_cvt_pk_bf16_f32 v150, v160, v161
    v_cvt_pk_bf16_f32 v151, v162, v163
    v_cvt_pk_bf16_f32 v152, v152, v153
    v_cvt_pk_bf16_f32 v153, v154, v155
    v_cvt_pk_bf16_f32 v154, v164, v165
    v_cvt_pk_bf16_f32 v155, v166, v167
    s_waitcnt lgkmcnt(12)
    v_mfma_f32_16x16x32_bf16 v[12:15], v[240:243], v[144:147], v[12:15]
    ds_read_b64 v[236:237], v253 offset:8768
    v_cvt_pk_bf16_f32 v168, v168, v169
    v_mfma_f32_16x16x32_bf16 v[16:19], v[240:243], v[148:151], v[16:19]
    ds_read_b64 v[238:239], v253 offset:8800
    v_cvt_pk_bf16_f32 v169, v170, v171
    v_mfma_f32_16x16x32_bf16 v[20:23], v[240:243], v[152:155], v[20:23]
    v_cvt_pk_bf16_f32 v170, v180, v181
    v_cvt_pk_bf16_f32 v171, v182, v183
    v_cvt_pk_bf16_f32 v172, v172, v173
    v_cvt_pk_bf16_f32 v173, v174, v175
    v_cvt_pk_bf16_f32 v174, v184, v185
    v_cvt_pk_bf16_f32 v175, v186, v187
    v_cvt_pk_bf16_f32 v176, v176, v177
    v_cvt_pk_bf16_f32 v177, v178, v179
    v_cvt_pk_bf16_f32 v178, v188, v189
    v_cvt_pk_bf16_f32 v179, v190, v191
    s_waitcnt lgkmcnt(12)
    v_mfma_f32_16x16x32_bf16 v[12:15], v[244:247], v[168:171], v[12:15]
    ds_read_b64 v[240:241], v253 offset:8832
    v_mfma_f32_16x16x32_bf16 v[16:19], v[244:247], v[172:175], v[16:19]
    ds_read_b64 v[242:243], v253 offset:8864
    v_mfma_f32_16x16x32_bf16 v[20:23], v[244:247], v[176:179], v[20:23]
    s_waitcnt lgkmcnt(12)
    v_mfma_f32_16x16x32_bf16 v[36:39], v[216:219], v[0:3], 0
    ds_read_b64 v[244:245], v253 offset:8896
    s_nop 0
    v_max3_f32 v192, v12, v13, v14
    v_mfma_f32_16x16x32_bf16 v[40:43], v[216:219], v[4:7], 0
    ds_read_b64 v[246:247], v253 offset:8928
    v_max_f32 v192, v192, v15
    v_mfma_f32_16x16x32_bf16 v[44:47], v[216:219], v[8:11], 0
    v_max3_f32 v194, v16, v17, v18
    v_max_f32 v194, v194, v19
    s_waitcnt lgkmcnt(12)
    v_mfma_f32_16x16x32_bf16 v[36:39], v[220:223], v[24:27], v[36:39]
    v_max3_f32 v196, v20, v21, v22
    v_max_f32 v196, v196, v23
    v_mfma_f32_16x16x32_bf16 v[40:43], v[220:223], v[28:31], v[40:43]
    v_mfma_f32_16x16x32_bf16 v[44:47], v[220:223], v[32:35], v[44:47]
    s_waitcnt lgkmcnt(0)
    s_barrier
    v_mfma_f32_16x16x32_bf16 v[36:39], v[224:227], v[48:51], v[36:39]
    ds_read_b64 v[216:217], v253 offset:33792
    ds_read_b64 v[218:219], v253 offset:33824
    v_mfma_f32_16x16x32_bf16 v[40:43], v[224:227], v[52:55], v[40:43]
    ds_read_b64 v[220:221], v253 offset:33856
    v_mfma_f32_16x16x32_bf16 v[44:47], v[224:227], v[56:59], v[44:47]
    ds_read_b64 v[222:223], v253 offset:33888
    v_mfma_f32_16x16x32_bf16 v[36:39], v[228:231], v[72:75], v[36:39]
    ds_read_b64 v[224:225], v253 offset:33920
    v_mfma_f32_16x16x32_bf16 v[40:43], v[228:231], v[76:79], v[40:43]
    ds_read_b64 v[226:227], v253 offset:33952
    v_mfma_f32_16x16x32_bf16 v[44:47], v[228:231], v[80:83], v[44:47]
    v_mfma_f32_16x16x32_bf16 v[36:39], v[232:235], v[96:99], v[36:39]
    ds_read_b64 v[228:229], v253 offset:33984
    v_mfma_f32_16x16x32_bf16 v[40:43], v[232:235], v[100:103], v[40:43]
    ds_read_b64 v[230:231], v253 offset:34016
    v_mfma_f32_16x16x32_bf16 v[44:47], v[232:235], v[104:107], v[44:47]
    v_mfma_f32_16x16x32_bf16 v[36:39], v[236:239], v[120:123], v[36:39]
    ds_read_b64 v[232:233], v253 offset:34048
    v_mfma_f32_16x16x32_bf16 v[40:43], v[236:239], v[124:127], v[40:43]
    ds_read_b64 v[234:235], v253 offset:34080
    v_mfma_f32_16x16x32_bf16 v[44:47], v[236:239], v[128:131], v[44:47]
    v_mfma_f32_16x16x32_bf16 v[36:39], v[240:243], v[144:147], v[36:39]
    ds_read_b64 v[236:237], v253 offset:34112
    v_mfma_f32_16x16x32_bf16 v[40:43], v[240:243], v[148:151], v[40:43]
    ds_read_b64 v[238:239], v253 offset:34144
    v_mfma_f32_16x16x32_bf16 v[44:47], v[240:243], v[152:155], v[44:47]
    v_mfma_f32_16x16x32_bf16 v[36:39], v[244:247], v[168:171], v[36:39]
    ds_read_b64 v[240:241], v253 offset:34176
    v_mfma_f32_16x16x32_bf16 v[40:43], v[244:247], v[172:175], v[40:43]
    ds_read_b64 v[242:243], v253 offset:34208
    v_mfma_f32_16x16x32_bf16 v[44:47], v[244:247], v[176:179], v[44:47]
    s_waitcnt lgkmcnt(12)
    v_mfma_f32_16x16x32_bf16 v[60:63], v[216:219], v[0:3], 0
    ds_read_b64 v[244:245], v253 offset:34240
    s_nop 0
    v_max3_f32 v192, v192, v36, v37
    v_mfma_f32_16x16x32_bf16 v[64:67], v[216:219], v[4:7], 0
    ds_read_b64 v[246:247], v253 offset:34272
    v_max3_f32 v192, v192, v38, v39
    v_mfma_f32_16x16x32_bf16 v[68:71], v[216:219], v[8:11], 0
    v_max3_f32 v194, v194, v40, v41
    v_max3_f32 v194, v194, v42, v43
    s_waitcnt lgkmcnt(12)
    v_mfma_f32_16x16x32_bf16 v[60:63], v[220:223], v[24:27], v[60:63]
    ds_read_b64 v[216:217], v253 offset:42240
    v_max3_f32 v196, v196, v44, v45
    v_mfma_f32_16x16x32_bf16 v[64:67], v[220:223], v[28:31], v[64:67]
    ds_read_b64 v[218:219], v253 offset:42272
    v_max3_f32 v196, v196, v46, v47
    v_mfma_f32_16x16x32_bf16 v[68:71], v[220:223], v[32:35], v[68:71]
    s_waitcnt lgkmcnt(12)
    v_mfma_f32_16x16x32_bf16 v[60:63], v[224:227], v[48:51], v[60:63]
    ds_read_b64 v[220:221], v253 offset:42304
    v_mfma_f32_16x16x32_bf16 v[64:67], v[224:227], v[52:55], v[64:67]
    ds_read_b64 v[222:223], v253 offset:42336
    v_mfma_f32_16x16x32_bf16 v[68:71], v[224:227], v[56:59], v[68:71]
    s_waitcnt lgkmcnt(12)
    v_mfma_f32_16x16x32_bf16 v[60:63], v[228:231], v[72:75], v[60:63]
    ds_read_b64 v[224:225], v253 offset:42368
    v_mfma_f32_16x16x32_bf16 v[64:67], v[228:231], v[76:79], v[64:67]
    ds_read_b64 v[226:227], v253 offset:42400
    v_mfma_f32_16x16x32_bf16 v[68:71], v[228:231], v[80:83], v[68:71]
    s_waitcnt lgkmcnt(12)
    v_mfma_f32_16x16x32_bf16 v[60:63], v[232:235], v[96:99], v[60:63]
    ds_read_b64 v[228:229], v253 offset:42432
    v_mfma_f32_16x16x32_bf16 v[64:67], v[232:235], v[100:103], v[64:67]
    ds_read_b64 v[230:231], v253 offset:42464
    v_mfma_f32_16x16x32_bf16 v[68:71], v[232:235], v[104:107], v[68:71]
    s_waitcnt lgkmcnt(12)
    v_mfma_f32_16x16x32_bf16 v[60:63], v[236:239], v[120:123], v[60:63]
    ds_read_b64 v[232:233], v253 offset:42496
    v_mfma_f32_16x16x32_bf16 v[64:67], v[236:239], v[124:127], v[64:67]
    ds_read_b64 v[234:235], v253 offset:42528
    v_mfma_f32_16x16x32_bf16 v[68:71], v[236:239], v[128:131], v[68:71]
    s_waitcnt lgkmcnt(12)
    v_mfma_f32_16x16x32_bf16 v[60:63], v[240:243], v[144:147], v[60:63]
    ds_read_b64 v[236:237], v253 offset:42560
    v_mfma_f32_16x16x32_bf16 v[64:67], v[240:243], v[148:151], v[64:67]
    ds_read_b64 v[238:239], v253 offset:42592
    v_mfma_f32_16x16x32_bf16 v[68:71], v[240:243], v[152:155], v[68:71]
    s_waitcnt lgkmcnt(12)
    v_mfma_f32_16x16x32_bf16 v[60:63], v[244:247], v[168:171], v[60:63]
    ds_read_b64 v[240:241], v253 offset:42624
    v_mfma_f32_16x16x32_bf16 v[64:67], v[244:247], v[172:175], v[64:67]
    ds_read_b64 v[242:243], v253 offset:42656
    v_mfma_f32_16x16x32_bf16 v[68:71], v[244:247], v[176:179], v[68:71]
    s_waitcnt lgkmcnt(12)
    v_mfma_f32_16x16x32_bf16 v[84:87], v[216:219], v[0:3], 0
    ds_read_b64 v[244:245], v253 offset:42688
    s_nop 0
    v_max3_f32 v192, v192, v60, v61
    v_mfma_f32_16x16x32_bf16 v[88:91], v[216:219], v[4:7], 0
    ds_read_b64 v[246:247], v253 offset:42720
    v_max3_f32 v192, v192, v62, v63
    v_mfma_f32_16x16x32_bf16 v[92:95], v[216:219], v[8:11], 0
    v_max3_f32 v194, v194, v64, v65
    v_max3_f32 v194, v194, v66, v67
    s_waitcnt lgkmcnt(12)
    v_mfma_f32_16x16x32_bf16 v[84:87], v[220:223], v[24:27], v[84:87]
    v_max3_f32 v196, v196, v68, v69
    v_max3_f32 v196, v196, v70, v71
    v_mfma_f32_16x16x32_bf16 v[88:91], v[220:223], v[28:31], v[88:91]
    v_mfma_f32_16x16x32_bf16 v[92:95], v[220:223], v[32:35], v[92:95]
    s_waitcnt lgkmcnt(0)
    s_barrier
    v_mfma_f32_16x16x32_bf16 v[84:87], v[224:227], v[48:51], v[84:87]
    v_add_u32 v253, 67584, v253
    ds_read_b64 v[216:217], v253 offset:0
    v_mfma_f32_16x16x32_bf16 v[88:91], v[224:227], v[52:55], v[88:91]
    ds_read_b64 v[218:219], v253 offset:32
    v_mfma_f32_16x16x32_bf16 v[92:95], v[224:227], v[56:59], v[92:95]
    ds_read_b64 v[220:221], v253 offset:64
    v_mfma_f32_16x16x32_bf16 v[84:87], v[228:231], v[72:75], v[84:87]
    ds_read_b64 v[222:223], v253 offset:96
    v_mfma_f32_16x16x32_bf16 v[88:91], v[228:231], v[76:79], v[88:91]
    ds_read_b64 v[224:225], v253 offset:128
    v_mfma_f32_16x16x32_bf16 v[92:95], v[228:231], v[80:83], v[92:95]
    ds_read_b64 v[226:227], v253 offset:160
    v_mfma_f32_16x16x32_bf16 v[84:87], v[232:235], v[96:99], v[84:87]
    ds_read_b64 v[228:229], v253 offset:192
    v_mfma_f32_16x16x32_bf16 v[88:91], v[232:235], v[100:103], v[88:91]
    ds_read_b64 v[230:231], v253 offset:224
    v_mfma_f32_16x16x32_bf16 v[92:95], v[232:235], v[104:107], v[92:95]
    v_mfma_f32_16x16x32_bf16 v[84:87], v[236:239], v[120:123], v[84:87]
    ds_read_b64 v[232:233], v253 offset:256
    v_mfma_f32_16x16x32_bf16 v[88:91], v[236:239], v[124:127], v[88:91]
    ds_read_b64 v[234:235], v253 offset:288
    v_mfma_f32_16x16x32_bf16 v[92:95], v[236:239], v[128:131], v[92:95]
    v_mfma_f32_16x16x32_bf16 v[84:87], v[240:243], v[144:147], v[84:87]
    ds_read_b64 v[236:237], v253 offset:320
    v_mfma_f32_16x16x32_bf16 v[88:91], v[240:243], v[148:151], v[88:91]
    ds_read_b64 v[238:239], v253 offset:352
    v_mfma_f32_16x16x32_bf16 v[92:95], v[240:243], v[152:155], v[92:95]
    v_mfma_f32_16x16x32_bf16 v[84:87], v[244:247], v[168:171], v[84:87]
    ds_read_b64 v[240:241], v253 offset:384
    v_mfma_f32_16x16x32_bf16 v[88:91], v[244:247], v[172:175], v[88:91]
    ds_read_b64 v[242:243], v253 offset:416
    v_mfma_f32_16x16x32_bf16 v[92:95], v[244:247], v[176:179], v[92:95]
    s_waitcnt lgkmcnt(12)
    v_mfma_f32_16x16x32_bf16 v[108:111], v[216:219], v[0:3], 0
    ds_read_b64 v[244:245], v253 offset:448
    s_nop 0
    v_max3_f32 v192, v192, v84, v85
    v_mfma_f32_16x16x32_bf16 v[112:115], v[216:219], v[4:7], 0
    ds_read_b64 v[246:247], v253 offset:480
    v_max3_f32 v192, v192, v86, v87
    v_mfma_f32_16x16x32_bf16 v[116:119], v[216:219], v[8:11], 0
    v_max3_f32 v194, v194, v88, v89
    v_max3_f32 v194, v194, v90, v91
    s_waitcnt lgkmcnt(12)
    v_mfma_f32_16x16x32_bf16 v[108:111], v[220:223], v[24:27], v[108:111]
    ds_read_b64 v[216:217], v253 offset:8448
    v_max3_f32 v196, v196, v92, v93
    v_mfma_f32_16x16x32_bf16 v[112:115], v[220:223], v[28:31], v[112:115]
    ds_read_b64 v[218:219], v253 offset:8480
    v_max3_f32 v196, v196, v94, v95
    v_mfma_f32_16x16x32_bf16 v[116:119], v[220:223], v[32:35], v[116:119]
    s_waitcnt lgkmcnt(12)
    v_mfma_f32_16x16x32_bf16 v[108:111], v[224:227], v[48:51], v[108:111]
    ds_read_b64 v[220:221], v253 offset:8512
    v_mfma_f32_16x16x32_bf16 v[112:115], v[224:227], v[52:55], v[112:115]
    ds_read_b64 v[222:223], v253 offset:8544
    v_mfma_f32_16x16x32_bf16 v[116:119], v[224:227], v[56:59], v[116:119]
    s_waitcnt lgkmcnt(12)
    v_mfma_f32_16x16x32_bf16 v[108:111], v[228:231], v[72:75], v[108:111]
    ds_read_b64 v[224:225], v253 offset:8576
    v_mfma_f32_16x16x32_bf16 v[112:115], v[228:231], v[76:79], v[112:115]
    ds_read_b64 v[226:227], v253 offset:8608
    v_mfma_f32_16x16x32_bf16 v[116:119], v[228:231], v[80:83], v[116:119]
    s_waitcnt lgkmcnt(12)
    v_mfma_f32_16x16x32_bf16 v[108:111], v[232:235], v[96:99], v[108:111]
    ds_read_b64 v[228:229], v253 offset:8640
    v_mfma_f32_16x16x32_bf16 v[112:115], v[232:235], v[100:103], v[112:115]
    ds_read_b64 v[230:231], v253 offset:8672
    v_mfma_f32_16x16x32_bf16 v[116:119], v[232:235], v[104:107], v[116:119]
    s_waitcnt lgkmcnt(12)
    v_mfma_f32_16x16x32_bf16 v[108:111], v[236:239], v[120:123], v[108:111]
    ds_read_b64 v[232:233], v253 offset:8704
    v_mfma_f32_16x16x32_bf16 v[112:115], v[236:239], v[124:127], v[112:115]
    ds_read_b64 v[234:235], v253 offset:8736
    v_mfma_f32_16x16x32_bf16 v[116:119], v[236:239], v[128:131], v[116:119]
    s_waitcnt lgkmcnt(12)
    v_mfma_f32_16x16x32_bf16 v[108:111], v[240:243], v[144:147], v[108:111]
    ds_read_b64 v[236:237], v253 offset:8768
    v_mfma_f32_16x16x32_bf16 v[112:115], v[240:243], v[148:151], v[112:115]
    ds_read_b64 v[238:239], v253 offset:8800
    v_mfma_f32_16x16x32_bf16 v[116:119], v[240:243], v[152:155], v[116:119]
    s_waitcnt lgkmcnt(12)
    v_mfma_f32_16x16x32_bf16 v[108:111], v[244:247], v[168:171], v[108:111]
    ds_read_b64 v[240:241], v253 offset:8832
    v_mfma_f32_16x16x32_bf16 v[112:115], v[244:247], v[172:175], v[112:115]
    ds_read_b64 v[242:243], v253 offset:8864
    v_mfma_f32_16x16x32_bf16 v[116:119], v[244:247], v[176:179], v[116:119]
    s_waitcnt lgkmcnt(12)
    v_mfma_f32_16x16x32_bf16 v[132:135], v[216:219], v[0:3], 0
    ds_read_b64 v[244:245], v253 offset:8896
    s_nop 0
    v_max3_f32 v192, v192, v108, v109
    v_mfma_f32_16x16x32_bf16 v[136:139], v[216:219], v[4:7], 0
    ds_read_b64 v[246:247], v253 offset:8928
    v_max3_f32 v192, v192, v110, v111
    v_mfma_f32_16x16x32_bf16 v[140:143], v[216:219], v[8:11], 0
    v_max3_f32 v194, v194, v112, v113
    v_max3_f32 v194, v194, v114, v115
    s_waitcnt lgkmcnt(12)
    v_mfma_f32_16x16x32_bf16 v[132:135], v[220:223], v[24:27], v[132:135]
    v_max3_f32 v196, v196, v116, v117
    v_max3_f32 v196, v196, v118, v119
    v_mfma_f32_16x16x32_bf16 v[136:139], v[220:223], v[28:31], v[136:139]
    v_mfma_f32_16x16x32_bf16 v[140:143], v[220:223], v[32:35], v[140:143]
    s_waitcnt lgkmcnt(0)
    s_barrier
    v_mfma_f32_16x16x32_bf16 v[132:135], v[224:227], v[48:51], v[132:135]
    v_mfma_f32_16x16x32_bf16 v[136:139], v[224:227], v[52:55], v[136:139]
    v_mfma_f32_16x16x32_bf16 v[140:143], v[224:227], v[56:59], v[140:143]
    v_mfma_f32_16x16x32_bf16 v[132:135], v[228:231], v[72:75], v[132:135]
    v_mfma_f32_16x16x32_bf16 v[136:139], v[228:231], v[76:79], v[136:139]
    v_mfma_f32_16x16x32_bf16 v[140:143], v[228:231], v[80:83], v[140:143]
    v_mfma_f32_16x16x32_bf16 v[132:135], v[232:235], v[96:99], v[132:135]
    v_mfma_f32_16x16x32_bf16 v[136:139], v[232:235], v[100:103], v[136:139]
    v_mfma_f32_16x16x32_bf16 v[140:143], v[232:235], v[104:107], v[140:143]
    v_mfma_f32_16x16x32_bf16 v[132:135], v[236:239], v[120:123], v[132:135]
    v_mfma_f32_16x16x32_bf16 v[136:139], v[236:239], v[124:127], v[136:139]
    v_mfma_f32_16x16x32_bf16 v[140:143], v[236:239], v[128:131], v[140:143]
    v_mfma_f32_16x16x32_bf16 v[132:135], v[240:243], v[144:147], v[132:135]
    v_mfma_f32_16x16x32_bf16 v[136:139], v[240:243], v[148:151], v[136:139]
    v_mfma_f32_16x16x32_bf16 v[140:143], v[240:243], v[152:155], v[140:143]
    v_mfma_f32_16x16x32_bf16 v[132:135], v[244:247], v[168:171], v[132:135]
    v_mfma_f32_16x16x32_bf16 v[136:139], v[244:247], v[172:175], v[136:139]
    v_mfma_f32_16x16x32_bf16 v[140:143], v[244:247], v[176:179], v[140:143]
    s_nop 5
    v_max3_f32 v192, v192, v132, v133
    v_max3_f32 v192, v192, v134, v135
    v_max3_f32 v194, v194, v136, v137
    v_max3_f32 v194, v194, v138, v139
    v_max3_f32 v196, v196, v140, v141
    v_max3_f32 v196, v196, v142, v143
    v_mov_b32 v193, v192
    v_mov_b32 v195, v194
    v_mov_b32 v197, v196
    v_permlane32_swap_b32 v192, v193
    v_permlane32_swap_b32 v194, v195
    v_permlane32_swap_b32 v196, v197
    v_max_f32 v192, v192, v193
    v_max_f32 v194, v194, v195
    v_max_f32 v196, v196, v197
    v_mov_b32 v193, v192
    v_mov_b32 v195, v194
    v_mov_b32 v197, v196
    v_permlane16_swap_b32 v192, v193
    v_permlane16_swap_b32 v194, v195
    v_permlane16_swap_b32 v196, v197
    v_max_f32 v192, v192, v193
    v_max_f32 v194, v194, v195
    v_max_f32 v196, v196, v197
    v_mul_f32 v192, s76, v192
    v_mul_f32 v194, s76, v194
    v_mul_f32 v196, s76, v196
    v_lshlrev_b32 v195, 3, v255
    v_add_u32 v252, s22, v195
    v_add_u32 v253, s23, v195
    v_pk_fma_f32 v[12:13], v[12:13], s[76:77], v[192:193] op_sel_hi:[1,1,0] neg_lo:[0,0,1] neg_hi:[0,0,1]
    v_pk_fma_f32 v[14:15], v[14:15], s[76:77], v[192:193] op_sel_hi:[1,1,0] neg_lo:[0,0,1] neg_hi:[0,0,1]
    v_exp_f32 v12, v12
    v_exp_f32 v13, v13
    v_exp_f32 v14, v14
    v_exp_f32 v15, v15
    v_pk_fma_f32 v[16:17], v[16:17], s[76:77], v[194:195] op_sel_hi:[1,1,0] neg_lo:[0,0,1] neg_hi:[0,0,1]
    v_pk_fma_f32 v[18:19], v[18:19], s[76:77], v[194:195] op_sel_hi:[1,1,0] neg_lo:[0,0,1] neg_hi:[0,0,1]
    v_exp_f32 v16, v16
    v_exp_f32 v17, v17
    v_exp_f32 v18, v18
    v_exp_f32 v19, v19
    v_pk_fma_f32 v[20:21], v[20:21], s[76:77], v[196:197] op_sel_hi:[1,1,0] neg_lo:[0,0,1] neg_hi:[0,0,1]
    v_pk_fma_f32 v[22:23], v[22:23], s[76:77], v[196:197] op_sel_hi:[1,1,0] neg_lo:[0,0,1] neg_hi:[0,0,1]
    v_exp_f32 v20, v20
    v_exp_f32 v21, v21
    v_exp_f32 v22, v22
    v_exp_f32 v23, v23
    v_pk_fma_f32 v[36:37], v[36:37], s[76:77], v[192:193] op_sel_hi:[1,1,0] neg_lo:[0,0,1] neg_hi:[0,0,1]
    v_pk_fma_f32 v[38:39], v[38:39], s[76:77], v[192:193] op_sel_hi:[1,1,0] neg_lo:[0,0,1] neg_hi:[0,0,1]
    v_exp_f32 v36, v36
    v_exp_f32 v37, v37
    v_exp_f32 v38, v38
    v_exp_f32 v39, v39
    v_pk_fma_f32 v[40:41], v[40:41], s[76:77], v[194:195] op_sel_hi:[1,1,0] neg_lo:[0,0,1] neg_hi:[0,0,1]
    v_pk_fma_f32 v[42:43], v[42:43], s[76:77], v[194:195] op_sel_hi:[1,1,0] neg_lo:[0,0,1] neg_hi:[0,0,1]
    v_exp_f32 v40, v40
    v_exp_f32 v41, v41
    v_exp_f32 v42, v42
    v_exp_f32 v43, v43
    v_pk_fma_f32 v[44:45], v[44:45], s[76:77], v[196:197] op_sel_hi:[1,1,0] neg_lo:[0,0,1] neg_hi:[0,0,1]
    v_pk_fma_f32 v[46:47], v[46:47], s[76:77], v[196:197] op_sel_hi:[1,1,0] neg_lo:[0,0,1] neg_hi:[0,0,1]
    v_exp_f32 v44, v44
    v_exp_f32 v45, v45
    v_exp_f32 v46, v46
    v_exp_f32 v47, v47
    v_pk_add_f32 v[198:199], v[12:13], v[14:15]
    v_pk_add_f32 v[200:201], v[16:17], v[18:19]
    v_pk_add_f32 v[202:203], v[20:21], v[22:23]
    v_pk_fma_f32 v[60:61], v[60:61], s[76:77], v[192:193] op_sel_hi:[1,1,0] neg_lo:[0,0,1] neg_hi:[0,0,1]
    v_pk_fma_f32 v[62:63], v[62:63], s[76:77], v[192:193] op_sel_hi:[1,1,0] neg_lo:[0,0,1] neg_hi:[0,0,1]
    v_exp_f32 v60, v60
    v_exp_f32 v61, v61
    v_exp_f32 v62, v62
    v_exp_f32 v63, v63
    v_pk_fma_f32 v[64:65], v[64:65], s[76:77], v[194:195] op_sel_hi:[1,1,0] neg_lo:[0,0,1] neg_hi:[0,0,1]
    v_pk_fma_f32 v[66:67], v[66:67], s[76:77], v[194:195] op_sel_hi:[1,1,0] neg_lo:[0,0,1] neg_hi:[0,0,1]
    v_exp_f32 v64, v64
    v_exp_f32 v65, v65
    v_exp_f32 v66, v66
    v_exp_f32 v67, v67
    v_pk_fma_f32 v[68:69], v[68:69], s[76:77], v[196:197] op_sel_hi:[1,1,0] neg_lo:[0,0,1] neg_hi:[0,0,1]
    v_pk_fma_f32 v[70:71], v[70:71], s[76:77], v[196:197] op_sel_hi:[1,1,0] neg_lo:[0,0,1] neg_hi:[0,0,1]
    v_exp_f32 v68, v68
    v_exp_f32 v69, v69
    v_exp_f32 v70, v70
    v_exp_f32 v71, v71
    v_pk_add_f32 v[198:199], v[198:199], v[36:37]
    v_pk_add_f32 v[198:199], v[198:199], v[38:39]
    v_pk_add_f32 v[200:201], v[200:201], v[40:41]
    v_pk_add_f32 v[200:201], v[200:201], v[42:43]
    v_pk_add_f32 v[202:203], v[202:203], v[44:45]
    v_pk_add_f32 v[202:203], v[202:203], v[46:47]
    v_pk_fma_f32 v[84:85], v[84:85], s[76:77], v[192:193] op_sel_hi:[1,1,0] neg_lo:[0,0,1] neg_hi:[0,0,1]
    v_pk_fma_f32 v[86:87], v[86:87], s[76:77], v[192:193] op_sel_hi:[1,1,0] neg_lo:[0,0,1] neg_hi:[0,0,1]
    v_exp_f32 v84, v84
    v_exp_f32 v85, v85
    v_exp_f32 v86, v86
    v_exp_f32 v87, v87
    v_pk_fma_f32 v[88:89], v[88:89], s[76:77], v[194:195] op_sel_hi:[1,1,0] neg_lo:[0,0,1] neg_hi:[0,0,1]
    v_pk_fma_f32 v[90:91], v[90:91], s[76:77], v[194:195] op_sel_hi:[1,1,0] neg_lo:[0,0,1] neg_hi:[0,0,1]
    v_exp_f32 v88, v88
    v_exp_f32 v89, v89
    v_exp_f32 v90, v90
    v_exp_f32 v91, v91
    v_pk_fma_f32 v[92:93], v[92:93], s[76:77], v[196:197] op_sel_hi:[1,1,0] neg_lo:[0,0,1] neg_hi:[0,0,1]
    v_pk_fma_f32 v[94:95], v[94:95], s[76:77], v[196:197] op_sel_hi:[1,1,0] neg_lo:[0,0,1] neg_hi:[0,0,1]
    v_exp_f32 v92, v92
    v_exp_f32 v93, v93
    v_exp_f32 v94, v94
    v_exp_f32 v95, v95
    v_pk_add_f32 v[198:199], v[198:199], v[60:61]
    v_pk_add_f32 v[198:199], v[198:199], v[62:63]
    v_pk_add_f32 v[200:201], v[200:201], v[64:65]
    v_pk_add_f32 v[200:201], v[200:201], v[66:67]
    v_pk_add_f32 v[202:203], v[202:203], v[68:69]
    v_pk_add_f32 v[202:203], v[202:203], v[70:71]
    v_pk_fma_f32 v[108:109], v[108:109], s[76:77], v[192:193] op_sel_hi:[1,1,0] neg_lo:[0,0,1] neg_hi:[0,0,1]
    v_pk_fma_f32 v[110:111], v[110:111], s[76:77], v[192:193] op_sel_hi:[1,1,0] neg_lo:[0,0,1] neg_hi:[0,0,1]
    v_exp_f32 v108, v108
    v_exp_f32 v109, v109
    v_exp_f32 v110, v110
    v_exp_f32 v111, v111
    v_pk_fma_f32 v[112:113], v[112:113], s[76:77], v[194:195] op_sel_hi:[1,1,0] neg_lo:[0,0,1] neg_hi:[0,0,1]
    v_pk_fma_f32 v[114:115], v[114:115], s[76:77], v[194:195] op_sel_hi:[1,1,0] neg_lo:[0,0,1] neg_hi:[0,0,1]
    v_exp_f32 v112, v112
    v_exp_f32 v113, v113
    v_exp_f32 v114, v114
    v_exp_f32 v115, v115
    v_pk_fma_f32 v[116:117], v[116:117], s[76:77], v[196:197] op_sel_hi:[1,1,0] neg_lo:[0,0,1] neg_hi:[0,0,1]
    v_pk_fma_f32 v[118:119], v[118:119], s[76:77], v[196:197] op_sel_hi:[1,1,0] neg_lo:[0,0,1] neg_hi:[0,0,1]
    v_exp_f32 v116, v116
    v_exp_f32 v117, v117
    v_exp_f32 v118, v118
    v_exp_f32 v119, v119
    v_pk_add_f32 v[198:199], v[198:199], v[84:85]
    v_pk_add_f32 v[198:199], v[198:199], v[86:87]
    v_pk_add_f32 v[200:201], v[200:201], v[88:89]
    v_pk_add_f32 v[200:201], v[200:201], v[90:91]
    v_pk_add_f32 v[202:203], v[202:203], v[92:93]
    v_pk_add_f32 v[202:203], v[202:203], v[94:95]
    v_pk_fma_f32 v[132:133], v[132:133], s[76:77], v[192:193] op_sel_hi:[1,1,0] neg_lo:[0,0,1] neg_hi:[0,0,1]
    v_pk_fma_f32 v[134:135], v[134:135], s[76:77], v[192:193] op_sel_hi:[1,1,0] neg_lo:[0,0,1] neg_hi:[0,0,1]
    v_exp_f32 v132, v132
    v_exp_f32 v133, v133
    v_exp_f32 v134, v134
    v_exp_f32 v135, v135
    v_pk_fma_f32 v[136:137], v[136:137], s[76:77], v[194:195] op_sel_hi:[1,1,0] neg_lo:[0,0,1] neg_hi:[0,0,1]
    v_pk_fma_f32 v[138:139], v[138:139], s[76:77], v[194:195] op_sel_hi:[1,1,0] neg_lo:[0,0,1] neg_hi:[0,0,1]
    v_exp_f32 v136, v136
    v_exp_f32 v137, v137
    v_exp_f32 v138, v138
    v_exp_f32 v139, v139
    v_pk_fma_f32 v[140:141], v[140:141], s[76:77], v[196:197] op_sel_hi:[1,1,0] neg_lo:[0,0,1] neg_hi:[0,0,1]
    v_pk_fma_f32 v[142:143], v[142:143], s[76:77], v[196:197] op_sel_hi:[1,1,0] neg_lo:[0,0,1] neg_hi:[0,0,1]
    v_exp_f32 v140, v140
    v_exp_f32 v141, v141
    v_exp_f32 v142, v142
    v_exp_f32 v143, v143
    v_pk_add_f32 v[198:199], v[198:199], v[108:109]
    v_pk_add_f32 v[198:199], v[198:199], v[110:111]
    v_pk_add_f32 v[200:201], v[200:201], v[112:113]
    v_pk_add_f32 v[200:201], v[200:201], v[114:115]
    v_pk_add_f32 v[202:203], v[202:203], v[116:117]
    v_pk_add_f32 v[202:203], v[202:203], v[118:119]
    v_pk_add_f32 v[198:199], v[198:199], v[132:133]
    v_pk_add_f32 v[198:199], v[198:199], v[134:135]
    v_pk_add_f32 v[200:201], v[200:201], v[136:137]
    v_pk_add_f32 v[200:201], v[200:201], v[138:139]
    v_pk_add_f32 v[202:203], v[202:203], v[140:141]
    v_pk_add_f32 v[202:203], v[202:203], v[142:143]
    v_add_f32 v198, v198, v199
    v_add_f32 v200, v200, v201
    v_add_f32 v202, v202, v203
    v_mov_b32 v193, v198
    v_mov_b32 v195, v200
    v_mov_b32 v197, v202
    v_permlane32_swap_b32 v198, v193
    v_permlane32_swap_b32 v200, v195
    v_permlane32_swap_b32 v202, v197
    v_add_f32 v198, v198, v193
    v_add_f32 v200, v200, v195
    v_add_f32 v202, v202, v197
    v_mov_b32 v193, v198
    v_mov_b32 v195, v200
    v_mov_b32 v197, v202
    v_permlane16_swap_b32 v198, v193
    v_permlane16_swap_b32 v200, v195
    v_permlane16_swap_b32 v202, v197
    v_add_f32 v198, v198, v193
    v_add_f32 v200, v200, v195
    v_add_f32 v202, v202, v197
    s_barrier
    ds_read_b64_tr_b16 v[216:217], v254 offset:0
    ds_read_b64_tr_b16 v[218:219], v254 offset:512
    ds_read_b64_tr_b16 v[220:221], v254 offset:8448
    ds_read_b64_tr_b16 v[222:223], v254 offset:8960
    ds_read_b64_tr_b16 v[224:225], v254 offset:16896
    ds_read_b64_tr_b16 v[226:227], v254 offset:17408
    ds_read_b64_tr_b16 v[228:229], v254 offset:32
    ds_read_b64_tr_b16 v[230:231], v254 offset:544
    ds_read_b64_tr_b16 v[232:233], v254 offset:8480
    ds_read_b64_tr_b16 v[234:235], v254 offset:8992
    v_rcp_f32 v198, v198
    v_rcp_f32 v200, v200
    v_rcp_f32 v202, v202
    v_pk_mul_f32 v[12:13], v[12:13], v[198:199] op_sel_hi:[1,0]
    v_pk_mul_f32 v[14:15], v[14:15], v[198:199] op_sel_hi:[1,0]
    v_pk_mul_f32 v[36:37], v[36:37], v[198:199] op_sel_hi:[1,0]
    v_pk_mul_f32 v[38:39], v[38:39], v[198:199] op_sel_hi:[1,0]
    v_cvt_pk_bf16_f32 v12, v12, v13
    v_cvt_pk_bf16_f32 v13, v14, v15
    v_cvt_pk_bf16_f32 v14, v36, v37
    v_cvt_pk_bf16_f32 v15, v38, v39
    v_pk_mul_f32 v[16:17], v[16:17], v[200:201] op_sel_hi:[1,0]
    v_pk_mul_f32 v[18:19], v[18:19], v[200:201] op_sel_hi:[1,0]
    v_pk_mul_f32 v[40:41], v[40:41], v[200:201] op_sel_hi:[1,0]
    v_pk_mul_f32 v[42:43], v[42:43], v[200:201] op_sel_hi:[1,0]
    v_cvt_pk_bf16_f32 v16, v16, v17
    v_cvt_pk_bf16_f32 v17, v18, v19
    v_cvt_pk_bf16_f32 v18, v40, v41
    v_cvt_pk_bf16_f32 v19, v42, v43
    v_pk_mul_f32 v[20:21], v[20:21], v[202:203] op_sel_hi:[1,0]
    v_pk_mul_f32 v[22:23], v[22:23], v[202:203] op_sel_hi:[1,0]
    v_pk_mul_f32 v[44:45], v[44:45], v[202:203] op_sel_hi:[1,0]
    v_pk_mul_f32 v[46:47], v[46:47], v[202:203] op_sel_hi:[1,0]
    v_cvt_pk_bf16_f32 v20, v20, v21
    v_cvt_pk_bf16_f32 v21, v22, v23
    v_cvt_pk_bf16_f32 v22, v44, v45
    v_cvt_pk_bf16_f32 v23, v46, v47
    v_pk_mul_f32 v[60:61], v[60:61], v[198:199] op_sel_hi:[1,0]
    v_pk_mul_f32 v[62:63], v[62:63], v[198:199] op_sel_hi:[1,0]
    v_pk_mul_f32 v[84:85], v[84:85], v[198:199] op_sel_hi:[1,0]
    v_pk_mul_f32 v[86:87], v[86:87], v[198:199] op_sel_hi:[1,0]
    v_cvt_pk_bf16_f32 v60, v60, v61
    v_cvt_pk_bf16_f32 v61, v62, v63
    v_cvt_pk_bf16_f32 v62, v84, v85
    v_cvt_pk_bf16_f32 v63, v86, v87
    v_pk_mul_f32 v[64:65], v[64:65], v[200:201] op_sel_hi:[1,0]
    v_pk_mul_f32 v[66:67], v[66:67], v[200:201] op_sel_hi:[1,0]
    v_pk_mul_f32 v[88:89], v[88:89], v[200:201] op_sel_hi:[1,0]
    v_pk_mul_f32 v[90:91], v[90:91], v[200:201] op_sel_hi:[1,0]
    v_cvt_pk_bf16_f32 v64, v64, v65
    v_cvt_pk_bf16_f32 v65, v66, v67
    v_cvt_pk_bf16_f32 v66, v88, v89
    v_cvt_pk_bf16_f32 v67, v90, v91
    v_pk_mul_f32 v[68:69], v[68:69], v[202:203] op_sel_hi:[1,0]
    v_pk_mul_f32 v[70:71], v[70:71], v[202:203] op_sel_hi:[1,0]
    v_pk_mul_f32 v[92:93], v[92:93], v[202:203] op_sel_hi:[1,0]
    v_pk_mul_f32 v[94:95], v[94:95], v[202:203] op_sel_hi:[1,0]
    v_cvt_pk_bf16_f32 v68, v68, v69
    v_cvt_pk_bf16_f32 v69, v70, v71
    v_cvt_pk_bf16_f32 v70, v92, v93
    v_cvt_pk_bf16_f32 v71, v94, v95
    v_pk_mul_f32 v[108:109], v[108:109], v[198:199] op_sel_hi:[1,0]
    v_pk_mul_f32 v[110:111], v[110:111], v[198:199] op_sel_hi:[1,0]
    v_pk_mul_f32 v[132:133], v[132:133], v[198:199] op_sel_hi:[1,0]
    v_pk_mul_f32 v[134:135], v[134:135], v[198:199] op_sel_hi:[1,0]
    v_cvt_pk_bf16_f32 v108, v108, v109
    v_cvt_pk_bf16_f32 v109, v110, v111
    v_cvt_pk_bf16_f32 v110, v132, v133
    v_cvt_pk_bf16_f32 v111, v134, v135
    v_pk_mul_f32 v[112:113], v[112:113], v[200:201] op_sel_hi:[1,0]
    v_pk_mul_f32 v[114:115], v[114:115], v[200:201] op_sel_hi:[1,0]
    v_pk_mul_f32 v[136:137], v[136:137], v[200:201] op_sel_hi:[1,0]
    v_pk_mul_f32 v[138:139], v[138:139], v[200:201] op_sel_hi:[1,0]
    v_cvt_pk_bf16_f32 v112, v112, v113
    v_cvt_pk_bf16_f32 v113, v114, v115
    v_cvt_pk_bf16_f32 v114, v136, v137
    v_cvt_pk_bf16_f32 v115, v138, v139
    v_pk_mul_f32 v[116:117], v[116:117], v[202:203] op_sel_hi:[1,0]
    v_pk_mul_f32 v[118:119], v[118:119], v[202:203] op_sel_hi:[1,0]
    v_pk_mul_f32 v[140:141], v[140:141], v[202:203] op_sel_hi:[1,0]
    v_pk_mul_f32 v[142:143], v[142:143], v[202:203] op_sel_hi:[1,0]
    v_cvt_pk_bf16_f32 v116, v116, v117
    v_cvt_pk_bf16_f32 v117, v118, v119
    v_cvt_pk_bf16_f32 v118, v140, v141
    v_cvt_pk_bf16_f32 v119, v142, v143
    s_waitcnt lgkmcnt(8)
    v_mfma_f32_16x16x32_bf16 v[0:3], v[216:219], v[12:15], 0
    ds_read_b64_tr_b16 v[236:237], v254 offset:16928
    v_mfma_f32_16x16x32_bf16 v[4:7], v[216:219], v[16:19], 0
    ds_read_b64_tr_b16 v[238:239], v254 offset:17440
    v_mfma_f32_16x16x32_bf16 v[8:11], v[216:219], v[20:23], 0
    s_waitcnt lgkmcnt(8)
    v_mfma_f32_16x16x32_bf16 v[0:3], v[220:223], v[60:63], v[0:3]
    ds_read_b64_tr_b16 v[216:217], v254 offset:64
    v_mfma_f32_16x16x32_bf16 v[4:7], v[220:223], v[64:67], v[4:7]
    ds_read_b64_tr_b16 v[218:219], v254 offset:576
    v_mfma_f32_16x16x32_bf16 v[8:11], v[220:223], v[68:71], v[8:11]
    s_waitcnt lgkmcnt(8)
    v_mfma_f32_16x16x32_bf16 v[0:3], v[224:227], v[108:111], v[0:3]
    ds_read_b64_tr_b16 v[220:221], v254 offset:8512
    v_mfma_f32_16x16x32_bf16 v[4:7], v[224:227], v[112:115], v[4:7]
    ds_read_b64_tr_b16 v[222:223], v254 offset:9024
    v_mfma_f32_16x16x32_bf16 v[8:11], v[224:227], v[116:119], v[8:11]
    s_waitcnt lgkmcnt(8)
    v_mfma_f32_16x16x32_bf16 v[156:159], v[228:231], v[12:15], 0
    ds_read_b64_tr_b16 v[224:225], v254 offset:16960
    v_mfma_f32_16x16x32_bf16 v[160:163], v[228:231], v[16:19], 0
    ds_read_b64_tr_b16 v[226:227], v254 offset:17472
    v_cvt_pk_bf16_f32 v0, v0, v1
    v_mfma_f32_16x16x32_bf16 v[164:167], v[228:231], v[20:23], 0
    v_cvt_pk_bf16_f32 v1, v2, v3
    s_waitcnt lgkmcnt(8)
    v_mfma_f32_16x16x32_bf16 v[156:159], v[232:235], v[60:63], v[156:159]
    ds_read_b64_tr_b16 v[228:229], v254 offset:96
    v_mfma_f32_16x16x32_bf16 v[160:163], v[232:235], v[64:67], v[160:163]
    ds_read_b64_tr_b16 v[230:231], v254 offset:608
    v_cvt_pk_bf16_f32 v4, v4, v5
    v_mfma_f32_16x16x32_bf16 v[164:167], v[232:235], v[68:71], v[164:167]
    v_cvt_pk_bf16_f32 v5, v6, v7
    s_waitcnt lgkmcnt(8)
    v_mfma_f32_16x16x32_bf16 v[156:159], v[236:239], v[108:111], v[156:159]
    ds_read_b64_tr_b16 v[232:233], v254 offset:8544
    v_mfma_f32_16x16x32_bf16 v[160:163], v[236:239], v[112:115], v[160:163]
    ds_read_b64_tr_b16 v[234:235], v254 offset:9056
    v_cvt_pk_bf16_f32 v8, v8, v9
    v_mfma_f32_16x16x32_bf16 v[164:167], v[236:239], v[116:119], v[164:167]
    v_cvt_pk_bf16_f32 v9, v10, v11
    s_waitcnt lgkmcnt(8)
    v_mfma_f32_16x16x32_bf16 v[24:27], v[216:219], v[12:15], 0
    ds_read_b64_tr_b16 v[236:237], v254 offset:16992
    v_mfma_f32_16x16x32_bf16 v[28:31], v[216:219], v[16:19], 0
    ds_read_b64_tr_b16 v[238:239], v254 offset:17504
    v_cvt_pk_bf16_f32 v2, v156, v157
    v_mfma_f32_16x16x32_bf16 v[32:35], v[216:219], v[20:23], 0
    v_cvt_pk_bf16_f32 v3, v158, v159
    s_waitcnt lgkmcnt(8)
    v_mfma_f32_16x16x32_bf16 v[24:27], v[220:223], v[60:63], v[24:27]
    ds_read_b64_tr_b16 v[216:217], v254 offset:128
    v_mfma_f32_16x16x32_bf16 v[28:31], v[220:223], v[64:67], v[28:31]
    ds_read_b64_tr_b16 v[218:219], v254 offset:640
    v_cvt_pk_bf16_f32 v6, v160, v161
    v_mfma_f32_16x16x32_bf16 v[32:35], v[220:223], v[68:71], v[32:35]
    ds_write_b64 v252, v[0:1] offset:0
    v_cvt_pk_bf16_f32 v7, v162, v163
    s_waitcnt lgkmcnt(9)
    v_mfma_f32_16x16x32_bf16 v[24:27], v[224:227], v[108:111], v[24:27]
    ds_read_b64_tr_b16 v[220:221], v254 offset:8576
    v_mfma_f32_16x16x32_bf16 v[28:31], v[224:227], v[112:115], v[28:31]
    ds_read_b64_tr_b16 v[222:223], v254 offset:9088
    v_cvt_pk_bf16_f32 v10, v164, v165
    v_mfma_f32_16x16x32_bf16 v[32:35], v[224:227], v[116:119], v[32:35]
    ds_write_b64 v252, v[4:5] offset:1024
    v_cvt_pk_bf16_f32 v11, v166, v167
    s_waitcnt lgkmcnt(10)
    v_mfma_f32_16x16x32_bf16 v[180:183], v[228:231], v[12:15], 0
    ds_read_b64_tr_b16 v[224:225], v254 offset:17024
    v_mfma_f32_16x16x32_bf16 v[184:187], v[228:231], v[16:19], 0
    ds_read_b64_tr_b16 v[226:227], v254 offset:17536
    v_cvt_pk_bf16_f32 v24, v24, v25
    v_mfma_f32_16x16x32_bf16 v[188:191], v[228:231], v[20:23], 0
    ds_write_b64 v252, v[8:9] offset:2048
    v_cvt_pk_bf16_f32 v25, v26, v27
    s_waitcnt lgkmcnt(11)
    v_mfma_f32_16x16x32_bf16 v[180:183], v[232:235], v[60:63], v[180:183]
    ds_read_b64_tr_b16 v[228:229], v254 offset:160
    ds_write_b64 v252, v[10:11] offset:2560
    v_mfma_f32_16x16x32_bf16 v[184:187], v[232:235], v[64:67], v[184:187]
    ds_read_b64_tr_b16 v[230:231], v254 offset:672
    v_cvt_pk_bf16_f32 v28, v28, v29
    v_mfma_f32_16x16x32_bf16 v[188:191], v[232:235], v[68:71], v[188:191]
    ds_write_b64 v252, v[2:3] offset:512
    v_cvt_pk_bf16_f32 v29, v30, v31
    s_waitcnt lgkmcnt(13)
    v_mfma_f32_16x16x32_bf16 v[180:183], v[236:239], v[108:111], v[180:183]
    ds_read_b64_tr_b16 v[232:233], v254 offset:8608
    v_mfma_f32_16x16x32_bf16 v[184:187], v[236:239], v[112:115], v[184:187]
    ds_read_b64_tr_b16 v[234:235], v254 offset:9120
    v_cvt_pk_bf16_f32 v32, v32, v33
    v_mfma_f32_16x16x32_bf16 v[188:191], v[236:239], v[116:119], v[188:191]
    ds_write_b64 v252, v[6:7] offset:1536
    v_cvt_pk_bf16_f32 v33, v34, v35
    s_waitcnt lgkmcnt(14)
    v_mfma_f32_16x16x32_bf16 v[48:51], v[216:219], v[12:15], 0
    ds_read_b64_tr_b16 v[236:237], v254 offset:17056
    v_mfma_f32_16x16x32_bf16 v[52:55], v[216:219], v[16:19], 0
    ds_read_b64_tr_b16 v[238:239], v254 offset:17568
    v_cvt_pk_bf16_f32 v26, v180, v181
    v_mfma_f32_16x16x32_bf16 v[56:59], v[216:219], v[20:23], 0
    v_cvt_pk_bf16_f32 v27, v182, v183
    s_waitcnt lgkmcnt(2)
    s_barrier
    v_mfma_f32_16x16x32_bf16 v[48:51], v[220:223], v[60:63], v[48:51]
    ds_read_b64_tr_b16 v[216:217], v254 offset:192
    ds_read2st64_b64 v[36:39], v253 offset0:0 offset1:1
    v_mfma_f32_16x16x32_bf16 v[52:55], v[220:223], v[64:67], v[52:55]
    ds_read_b64_tr_b16 v[218:219], v254 offset:704
    v_cvt_pk_bf16_f32 v30, v184, v185
    v_mfma_f32_16x16x32_bf16 v[56:59], v[220:223], v[68:71], v[56:59]
    ds_write_b64 v252, v[24:25] offset:12288
    v_cvt_pk_bf16_f32 v31, v186, v187
    v_mfma_f32_16x16x32_bf16 v[48:51], v[224:227], v[108:111], v[48:51]
    ds_read_b64_tr_b16 v[220:221], v254 offset:8640
    ds_read2st64_b64 v[40:43], v253 offset0:2 offset1:3
    v_mfma_f32_16x16x32_bf16 v[52:55], v[224:227], v[112:115], v[52:55]
    ds_read_b64_tr_b16 v[222:223], v254 offset:9152
    v_cvt_pk_bf16_f32 v34, v188, v189
    v_mfma_f32_16x16x32_bf16 v[56:59], v[224:227], v[116:119], v[56:59]
    ds_write_b64 v252, v[28:29] offset:13312
    v_cvt_pk_bf16_f32 v35, v190, v191
    v_mfma_f32_16x16x32_bf16 v[156:159], v[228:231], v[12:15], 0
    ds_read_b64_tr_b16 v[224:225], v254 offset:17088
    ds_read2st64_b64 v[44:47], v253 offset0:4 offset1:5
    v_mfma_f32_16x16x32_bf16 v[160:163], v[228:231], v[16:19], 0
    ds_read_b64_tr_b16 v[226:227], v254 offset:17600
    v_cvt_pk_bf16_f32 v48, v48, v49
    v_mfma_f32_16x16x32_bf16 v[164:167], v[228:231], v[20:23], 0
    ds_write_b64 v252, v[32:33] offset:14336
    v_cvt_pk_bf16_f32 v49, v50, v51
    v_mfma_f32_16x16x32_bf16 v[156:159], v[232:235], v[60:63], v[156:159]
    ds_read_b64_tr_b16 v[228:229], v254 offset:224
    ds_write_b64 v252, v[34:35] offset:14848
    v_mfma_f32_16x16x32_bf16 v[160:163], v[232:235], v[64:67], v[160:163]
    ds_read_b64_tr_b16 v[230:231], v254 offset:736
    v_cvt_pk_bf16_f32 v52, v52, v53
    v_mfma_f32_16x16x32_bf16 v[164:167], v[232:235], v[68:71], v[164:167]
    ds_write_b64 v252, v[26:27] offset:12800
    v_cvt_pk_bf16_f32 v53, v54, v55
    s_waitcnt lgkmcnt(14)
    v_mfma_f32_16x16x32_bf16 v[156:159], v[236:239], v[108:111], v[156:159]
    ds_read_b64_tr_b16 v[232:233], v254 offset:8672
    v_mfma_f32_16x16x32_bf16 v[160:163], v[236:239], v[112:115], v[160:163]
    ds_read_b64_tr_b16 v[234:235], v254 offset:9184
    v_cvt_pk_bf16_f32 v56, v56, v57
    v_mfma_f32_16x16x32_bf16 v[164:167], v[236:239], v[116:119], v[164:167]
    ds_write_b64 v252, v[30:31] offset:13824
    v_cvt_pk_bf16_f32 v57, v58, v59
    s_waitcnt lgkmcnt(14)
    v_mfma_f32_16x16x32_bf16 v[72:75], v[216:219], v[12:15], 0
    ds_read_b64_tr_b16 v[236:237], v254 offset:17120
    v_mfma_f32_16x16x32_bf16 v[76:79], v[216:219], v[16:19], 0
    ds_read_b64_tr_b16 v[238:239], v254 offset:17632
    v_cvt_pk_bf16_f32 v50, v156, v157
    v_mfma_f32_16x16x32_bf16 v[80:83], v[216:219], v[20:23], 0
    v_cvt_pk_bf16_f32 v51, v158, v159
    s_waitcnt lgkmcnt(2)
    s_barrier
    v_mfma_f32_16x16x32_bf16 v[72:75], v[220:223], v[60:63], v[72:75]
    v_add_u32 v254, 50688, v254
    ds_read_b64_tr_b16 v[216:217], v254 offset:0
    ds_read2st64_b64 v[84:87], v253 offset0:24 offset1:25
    v_mfma_f32_16x16x32_bf16 v[76:79], v[220:223], v[64:67], v[76:79]
    ds_read_b64_tr_b16 v[218:219], v254 offset:512
    v_cvt_pk_bf16_f32 v54, v160, v161
    v_mfma_f32_16x16x32_bf16 v[80:83], v[220:223], v[68:71], v[80:83]
    ds_write_b64 v252, v[48:49] offset:0
    v_cvt_pk_bf16_f32 v55, v162, v163
    v_mfma_f32_16x16x32_bf16 v[72:75], v[224:227], v[108:111], v[72:75]
    ds_read_b64_tr_b16 v[220:221], v254 offset:8448
    ds_read2st64_b64 v[88:91], v253 offset0:26 offset1:27
    v_mfma_f32_16x16x32_bf16 v[76:79], v[224:227], v[112:115], v[76:79]
    ds_read_b64_tr_b16 v[222:223], v254 offset:8960
    v_cvt_pk_bf16_f32 v58, v164, v165
    v_mfma_f32_16x16x32_bf16 v[80:83], v[224:227], v[116:119], v[80:83]
    ds_write_b64 v252, v[52:53] offset:1024
    v_cvt_pk_bf16_f32 v59, v166, v167
    v_mfma_f32_16x16x32_bf16 v[180:183], v[228:231], v[12:15], 0
    ds_read_b64_tr_b16 v[224:225], v254 offset:16896
    ds_read2st64_b64 v[92:95], v253 offset0:28 offset1:29
    v_mfma_f32_16x16x32_bf16 v[184:187], v[228:231], v[16:19], 0
    ds_read_b64_tr_b16 v[226:227], v254 offset:17408
    v_cvt_pk_bf16_f32 v72, v72, v73
    v_mfma_f32_16x16x32_bf16 v[188:191], v[228:231], v[20:23], 0
    ds_write_b64 v252, v[56:57] offset:2048
    v_cvt_pk_bf16_f32 v73, v74, v75
    v_mfma_f32_16x16x32_bf16 v[180:183], v[232:235], v[60:63], v[180:183]
    ds_read_b64_tr_b16 v[228:229], v254 offset:32
    ds_write_b64 v252, v[58:59] offset:2560
    v_mfma_f32_16x16x32_bf16 v[184:187], v[232:235], v[64:67], v[184:187]
    ds_read_b64_tr_b16 v[230:231], v254 offset:544
    v_cvt_pk_bf16_f32 v76, v76, v77
    v_mfma_f32_16x16x32_bf16 v[188:191], v[232:235], v[68:71], v[188:191]
    ds_write_b64 v252, v[50:51] offset:512
    v_cvt_pk_bf16_f32 v77, v78, v79
    s_waitcnt lgkmcnt(14)
    v_mfma_f32_16x16x32_bf16 v[180:183], v[236:239], v[108:111], v[180:183]
    ds_read_b64_tr_b16 v[232:233], v254 offset:8480
    v_mfma_f32_16x16x32_bf16 v[184:187], v[236:239], v[112:115], v[184:187]
    ds_read_b64_tr_b16 v[234:235], v254 offset:8992
    v_cvt_pk_bf16_f32 v80, v80, v81
    v_mfma_f32_16x16x32_bf16 v[188:191], v[236:239], v[116:119], v[188:191]
    ds_write_b64 v252, v[54:55] offset:1536
    v_cvt_pk_bf16_f32 v81, v82, v83
    s_waitcnt lgkmcnt(14)
    v_mfma_f32_16x16x32_bf16 v[96:99], v[216:219], v[12:15], 0
    ds_read_b64_tr_b16 v[236:237], v254 offset:16928
    v_mfma_f32_16x16x32_bf16 v[100:103], v[216:219], v[16:19], 0
    ds_read_b64_tr_b16 v[238:239], v254 offset:17440
    v_cvt_pk_bf16_f32 v74, v180, v181
    v_mfma_f32_16x16x32_bf16 v[104:107], v[216:219], v[20:23], 0
    v_cvt_pk_bf16_f32 v75, v182, v183
    s_waitcnt lgkmcnt(2)
    s_barrier
    v_mfma_f32_16x16x32_bf16 v[96:99], v[220:223], v[60:63], v[96:99]
    ds_read_b64_tr_b16 v[216:217], v254 offset:64
    ds_read2st64_b64 v[132:135], v253 offset0:0 offset1:1
    v_mfma_f32_16x16x32_bf16 v[100:103], v[220:223], v[64:67], v[100:103]
    ds_read_b64_tr_b16 v[218:219], v254 offset:576
    v_cvt_pk_bf16_f32 v78, v184, v185
    v_mfma_f32_16x16x32_bf16 v[104:107], v[220:223], v[68:71], v[104:107]
    ds_write_b64 v252, v[72:73] offset:12288
    v_cvt_pk_bf16_f32 v79, v186, v187
    v_mfma_f32_16x16x32_bf16 v[96:99], v[224:227], v[108:111], v[96:99]
    ds_read_b64_tr_b16 v[220:221], v254 offset:8512
    ds_read2st64_b64 v[136:139], v253 offset0:2 offset1:3
    v_mfma_f32_16x16x32_bf16 v[100:103], v[224:227], v[112:115], v[100:103]
    ds_read_b64_tr_b16 v[222:223], v254 offset:9024
    v_cvt_pk_bf16_f32 v82, v188, v189
    v_mfma_f32_16x16x32_bf16 v[104:107], v[224:227], v[116:119], v[104:107]
    ds_write_b64 v252, v[76:77] offset:13312
    v_cvt_pk_bf16_f32 v83, v190, v191
    v_mfma_f32_16x16x32_bf16 v[156:159], v[228:231], v[12:15], 0
    ds_read_b64_tr_b16 v[224:225], v254 offset:16960
    ds_read2st64_b64 v[140:143], v253 offset0:4 offset1:5
    v_mfma_f32_16x16x32_bf16 v[160:163], v[228:231], v[16:19], 0
    ds_read_b64_tr_b16 v[226:227], v254 offset:17472
    v_cvt_pk_bf16_f32 v96, v96, v97
    v_mfma_f32_16x16x32_bf16 v[164:167], v[228:231], v[20:23], 0
    ds_write_b64 v252, v[80:81] offset:14336
    v_cvt_pk_bf16_f32 v97, v98, v99
    v_mfma_f32_16x16x32_bf16 v[156:159], v[232:235], v[60:63], v[156:159]
    ds_read_b64_tr_b16 v[228:229], v254 offset:96
    ds_write_b64 v252, v[82:83] offset:14848
    v_mfma_f32_16x16x32_bf16 v[160:163], v[232:235], v[64:67], v[160:163]
    ds_read_b64_tr_b16 v[230:231], v254 offset:608
    v_cvt_pk_bf16_f32 v100, v100, v101
    v_mfma_f32_16x16x32_bf16 v[164:167], v[232:235], v[68:71], v[164:167]
    ds_write_b64 v252, v[74:75] offset:12800
    v_cvt_pk_bf16_f32 v101, v102, v103
    s_waitcnt lgkmcnt(14)
    v_mfma_f32_16x16x32_bf16 v[156:159], v[236:239], v[108:111], v[156:159]
    ds_read_b64_tr_b16 v[232:233], v254 offset:8544
    v_mfma_f32_16x16x32_bf16 v[160:163], v[236:239], v[112:115], v[160:163]
    ds_read_b64_tr_b16 v[234:235], v254 offset:9056
    v_cvt_pk_bf16_f32 v104, v104, v105
    v_mfma_f32_16x16x32_bf16 v[164:167], v[236:239], v[116:119], v[164:167]
    ds_write_b64 v252, v[78:79] offset:13824
    v_cvt_pk_bf16_f32 v105, v106, v107
    s_waitcnt lgkmcnt(14)
    v_mfma_f32_16x16x32_bf16 v[120:123], v[216:219], v[12:15], 0
    ds_read_b64_tr_b16 v[236:237], v254 offset:16992
    v_mfma_f32_16x16x32_bf16 v[124:127], v[216:219], v[16:19], 0
    ds_read_b64_tr_b16 v[238:239], v254 offset:17504
    v_cvt_pk_bf16_f32 v98, v156, v157
    v_mfma_f32_16x16x32_bf16 v[128:131], v[216:219], v[20:23], 0
    v_cvt_pk_bf16_f32 v99, v158, v159
    s_waitcnt lgkmcnt(2)
    s_barrier
    v_mfma_f32_16x16x32_bf16 v[120:123], v[220:223], v[60:63], v[120:123]
    ds_read_b64_tr_b16 v[216:217], v254 offset:128
    ds_read2st64_b64 v[192:195], v253 offset0:24 offset1:25
    v_mfma_f32_16x16x32_bf16 v[124:127], v[220:223], v[64:67], v[124:127]
    ds_read_b64_tr_b16 v[218:219], v254 offset:640
    v_cvt_pk_bf16_f32 v102, v160, v161
    v_mfma_f32_16x16x32_bf16 v[128:131], v[220:223], v[68:71], v[128:131]
    ds_write_b64 v252, v[96:97] offset:0
    v_cvt_pk_bf16_f32 v103, v162, v163
    v_mfma_f32_16x16x32_bf16 v[120:123], v[224:227], v[108:111], v[120:123]
    ds_read_b64_tr_b16 v[220:221], v254 offset:8576
    ds_read2st64_b64 v[196:199], v253 offset0:26 offset1:27
    v_mfma_f32_16x16x32_bf16 v[124:127], v[224:227], v[112:115], v[124:127]
    ds_read_b64_tr_b16 v[222:223], v254 offset:9088
    v_cvt_pk_bf16_f32 v106, v164, v165
    v_mfma_f32_16x16x32_bf16 v[128:131], v[224:227], v[116:119], v[128:131]
    ds_write_b64 v252, v[100:101] offset:1024
    v_cvt_pk_bf16_f32 v107, v166, v167
    v_mfma_f32_16x16x32_bf16 v[180:183], v[228:231], v[12:15], 0
    ds_read_b64_tr_b16 v[224:225], v254 offset:17024
    ds_read2st64_b64 v[200:203], v253 offset0:28 offset1:29
    v_mfma_f32_16x16x32_bf16 v[184:187], v[228:231], v[16:19], 0
    ds_read_b64_tr_b16 v[226:227], v254 offset:17536
    v_cvt_pk_bf16_f32 v120, v120, v121
    v_mfma_f32_16x16x32_bf16 v[188:191], v[228:231], v[20:23], 0
    ds_write_b64 v252, v[104:105] offset:2048
    v_cvt_pk_bf16_f32 v121, v122, v123
    v_mfma_f32_16x16x32_bf16 v[180:183], v[232:235], v[60:63], v[180:183]
    ds_read_b64_tr_b16 v[228:229], v254 offset:160
    ds_write_b64 v252, v[106:107] offset:2560
    v_mfma_f32_16x16x32_bf16 v[184:187], v[232:235], v[64:67], v[184:187]
    ds_read_b64_tr_b16 v[230:231], v254 offset:672
    v_cvt_pk_bf16_f32 v124, v124, v125
    v_mfma_f32_16x16x32_bf16 v[188:191], v[232:235], v[68:71], v[188:191]
    ds_write_b64 v252, v[98:99] offset:512
    v_cvt_pk_bf16_f32 v125, v126, v127
    s_waitcnt lgkmcnt(14)
    v_mfma_f32_16x16x32_bf16 v[180:183], v[236:239], v[108:111], v[180:183]
    ds_read_b64_tr_b16 v[232:233], v254 offset:8608
    v_mfma_f32_16x16x32_bf16 v[184:187], v[236:239], v[112:115], v[184:187]
    ds_read_b64_tr_b16 v[234:235], v254 offset:9120
    v_cvt_pk_bf16_f32 v128, v128, v129
    v_mfma_f32_16x16x32_bf16 v[188:191], v[236:239], v[116:119], v[188:191]
    ds_write_b64 v252, v[102:103] offset:1536
    v_cvt_pk_bf16_f32 v129, v130, v131
    s_waitcnt lgkmcnt(14)
    v_mfma_f32_16x16x32_bf16 v[144:147], v[216:219], v[12:15], 0
    ds_read_b64_tr_b16 v[236:237], v254 offset:17056
    v_mfma_f32_16x16x32_bf16 v[148:151], v[216:219], v[16:19], 0
    ds_read_b64_tr_b16 v[238:239], v254 offset:17568
    v_cvt_pk_bf16_f32 v122, v180, v181
    v_mfma_f32_16x16x32_bf16 v[152:155], v[216:219], v[20:23], 0
    v_cvt_pk_bf16_f32 v123, v182, v183
    s_waitcnt lgkmcnt(2)
    s_barrier
    v_mfma_f32_16x16x32_bf16 v[144:147], v[220:223], v[60:63], v[144:147]
    ds_read_b64_tr_b16 v[216:217], v254 offset:192
    ds_read2st64_b64 v[204:207], v253 offset0:0 offset1:1
    v_mfma_f32_16x16x32_bf16 v[148:151], v[220:223], v[64:67], v[148:151]
    ds_read_b64_tr_b16 v[218:219], v254 offset:704
    v_cvt_pk_bf16_f32 v126, v184, v185
    v_mfma_f32_16x16x32_bf16 v[152:155], v[220:223], v[68:71], v[152:155]
    ds_write_b64 v252, v[120:121] offset:12288
    v_cvt_pk_bf16_f32 v127, v186, v187
    v_mfma_f32_16x16x32_bf16 v[144:147], v[224:227], v[108:111], v[144:147]
    ds_read_b64_tr_b16 v[220:221], v254 offset:8640
    ds_read2st64_b64 v[208:211], v253 offset0:2 offset1:3
    v_mfma_f32_16x16x32_bf16 v[148:151], v[224:227], v[112:115], v[148:151]
    ds_read_b64_tr_b16 v[222:223], v254 offset:9152
    v_cvt_pk_bf16_f32 v130, v188, v189
    v_mfma_f32_16x16x32_bf16 v[152:155], v[224:227], v[116:119], v[152:155]
    ds_write_b64 v252, v[124:125] offset:13312
    v_cvt_pk_bf16_f32 v131, v190, v191
    v_mfma_f32_16x16x32_bf16 v[156:159], v[228:231], v[12:15], 0
    ds_read_b64_tr_b16 v[224:225], v254 offset:17088
    ds_read2st64_b64 v[212:215], v253 offset0:4 offset1:5
    v_mfma_f32_16x16x32_bf16 v[160:163], v[228:231], v[16:19], 0
    ds_read_b64_tr_b16 v[226:227], v254 offset:17600
    v_cvt_pk_bf16_f32 v144, v144, v145
    v_mfma_f32_16x16x32_bf16 v[164:167], v[228:231], v[20:23], 0
    ds_write_b64 v252, v[128:129] offset:14336
    v_cvt_pk_bf16_f32 v145, v146, v147
    v_mfma_f32_16x16x32_bf16 v[156:159], v[232:235], v[60:63], v[156:159]
    ds_read_b64_tr_b16 v[228:229], v254 offset:224
    ds_write_b64 v252, v[130:131] offset:14848
    v_mfma_f32_16x16x32_bf16 v[160:163], v[232:235], v[64:67], v[160:163]
    ds_read_b64_tr_b16 v[230:231], v254 offset:736
    v_cvt_pk_bf16_f32 v148, v148, v149
    v_mfma_f32_16x16x32_bf16 v[164:167], v[232:235], v[68:71], v[164:167]
    ds_write_b64 v252, v[122:123] offset:12800
    v_cvt_pk_bf16_f32 v149, v150, v151
    s_waitcnt lgkmcnt(14)
    v_mfma_f32_16x16x32_bf16 v[156:159], v[236:239], v[108:111], v[156:159]
    ds_read_b64_tr_b16 v[232:233], v254 offset:8672
    v_mfma_f32_16x16x32_bf16 v[160:163], v[236:239], v[112:115], v[160:163]
    ds_read_b64_tr_b16 v[234:235], v254 offset:9184
    v_cvt_pk_bf16_f32 v152, v152, v153
    v_mfma_f32_16x16x32_bf16 v[164:167], v[236:239], v[116:119], v[164:167]
    ds_write_b64 v252, v[126:127] offset:13824
    v_cvt_pk_bf16_f32 v153, v154, v155
    s_waitcnt lgkmcnt(14)
    v_mfma_f32_16x16x32_bf16 v[168:171], v[216:219], v[12:15], 0
    ds_read_b64_tr_b16 v[236:237], v254 offset:17120
    v_mfma_f32_16x16x32_bf16 v[172:175], v[216:219], v[16:19], 0
    ds_read_b64_tr_b16 v[238:239], v254 offset:17632
    v_cvt_pk_bf16_f32 v146, v156, v157
    v_mfma_f32_16x16x32_bf16 v[176:179], v[216:219], v[20:23], 0
    v_cvt_pk_bf16_f32 v147, v158, v159
    s_waitcnt lgkmcnt(2)
    s_barrier
    v_mfma_f32_16x16x32_bf16 v[168:171], v[220:223], v[60:63], v[168:171]
    v_add_u32 v255, s80, v254
    v_add_u32 v254, s79, v254
    ds_read_b64_tr_b16 v[216:217], v254 offset:33792
    ds_read2st64_b64 v[240:243], v253 offset0:24 offset1:25
    v_mfma_f32_16x16x32_bf16 v[172:175], v[220:223], v[64:67], v[172:175]
    ds_read_b64_tr_b16 v[218:219], v254 offset:33920
    v_cvt_pk_bf16_f32 v150, v160, v161
    v_mfma_f32_16x16x32_bf16 v[176:179], v[220:223], v[68:71], v[176:179]
    ds_write_b64 v252, v[144:145] offset:0
    v_cvt_pk_bf16_f32 v151, v162, v163
    v_mfma_f32_16x16x32_bf16 v[168:171], v[224:227], v[108:111], v[168:171]
    ds_read_b64_tr_b16 v[220:221], v254 offset:34304
    ds_read2st64_b64 v[244:247], v253 offset0:26 offset1:27
    v_mfma_f32_16x16x32_bf16 v[172:175], v[224:227], v[112:115], v[172:175]
    ds_read_b64_tr_b16 v[222:223], v254 offset:34432
    v_cvt_pk_bf16_f32 v154, v164, v165
    v_mfma_f32_16x16x32_bf16 v[176:179], v[224:227], v[116:119], v[176:179]
    ds_write_b64 v252, v[148:149] offset:1024
    v_cvt_pk_bf16_f32 v155, v166, v167
    v_mfma_f32_16x16x32_bf16 v[180:183], v[228:231], v[12:15], 0
    ds_read_b64_tr_b16 v[224:225], v254 offset:33824
    ds_read2st64_b64 v[248:251], v253 offset0:28 offset1:29
    v_mfma_f32_16x16x32_bf16 v[184:187], v[228:231], v[16:19], 0
    ds_read_b64_tr_b16 v[226:227], v254 offset:33952
    v_cvt_pk_bf16_f32 v168, v168, v169
    v_mfma_f32_16x16x32_bf16 v[188:191], v[228:231], v[20:23], 0
    ds_write_b64 v252, v[152:153] offset:2048
    v_cvt_pk_bf16_f32 v169, v170, v171
    v_mfma_f32_16x16x32_bf16 v[180:183], v[232:235], v[60:63], v[180:183]
    ds_read_b64_tr_b16 v[228:229], v254 offset:34336
    ds_write_b64 v252, v[154:155] offset:2560
    v_mfma_f32_16x16x32_bf16 v[184:187], v[232:235], v[64:67], v[184:187]
    ds_read_b64_tr_b16 v[230:231], v254 offset:34464
    v_cvt_pk_bf16_f32 v172, v172, v173
    v_mfma_f32_16x16x32_bf16 v[188:191], v[232:235], v[68:71], v[188:191]
    ds_write_b64 v252, v[146:147] offset:512
    v_cvt_pk_bf16_f32 v173, v174, v175
    s_waitcnt lgkmcnt(14)
    v_mfma_f32_16x16x32_bf16 v[180:183], v[236:239], v[108:111], v[180:183]
    ds_read_b64_tr_b16 v[232:233], v254 offset:42240
    v_mfma_f32_16x16x32_bf16 v[184:187], v[236:239], v[112:115], v[184:187]
    ds_read_b64_tr_b16 v[234:235], v254 offset:42368
    v_cvt_pk_bf16_f32 v176, v176, v177
    v_mfma_f32_16x16x32_bf16 v[188:191], v[236:239], v[116:119], v[188:191]
    ds_write_b64 v252, v[150:151] offset:1536
    v_cvt_pk_bf16_f32 v177, v178, v179
    s_waitcnt lgkmcnt(14)
    v_mfma_f32_16x16x32_bf16 v[12:15], v[216:219], v[0:3], 0
    ds_read_b64_tr_b16 v[236:237], v254 offset:42752
    v_mfma_f32_16x16x32_bf16 v[16:19], v[216:219], v[4:7], 0
    ds_read_b64_tr_b16 v[238:239], v254 offset:42880
    v_cvt_pk_bf16_f32 v170, v180, v181
    v_mfma_f32_16x16x32_bf16 v[20:23], v[216:219], v[8:11], 0
    v_cvt_pk_bf16_f32 v171, v182, v183
    s_waitcnt lgkmcnt(2)
    s_barrier
    v_mfma_f32_16x16x32_bf16 v[12:15], v[220:223], v[24:27], v[12:15]
    ds_read_b64_tr_b16 v[216:217], v254 offset:42272
    ds_read2st64_b64 v[108:111], v253 offset0:0 offset1:1
    v_mfma_f32_16x16x32_bf16 v[16:19], v[220:223], v[28:31], v[16:19]
    ds_read_b64_tr_b16 v[218:219], v254 offset:42400
    v_cvt_pk_bf16_f32 v174, v184, v185
    v_mfma_f32_16x16x32_bf16 v[20:23], v[220:223], v[32:35], v[20:23]
    ds_write_b64 v252, v[168:169] offset:12288
    v_cvt_pk_bf16_f32 v175, v186, v187
    v_mfma_f32_16x16x32_bf16 v[60:63], v[224:227], v[0:3], 0
    ds_read_b64_tr_b16 v[220:221], v254 offset:42784
    ds_read2st64_b64 v[112:115], v253 offset0:2 offset1:3
    v_mfma_f32_16x16x32_bf16 v[64:67], v[224:227], v[4:7], 0
    ds_read_b64_tr_b16 v[222:223], v254 offset:42912
    v_cvt_pk_bf16_f32 v178, v188, v189
    v_mfma_f32_16x16x32_bf16 v[68:71], v[224:227], v[8:11], 0
    ds_write_b64 v252, v[172:173] offset:13312
    v_cvt_pk_bf16_f32 v179, v190, v191
    v_mfma_f32_16x16x32_bf16 v[60:63], v[228:231], v[24:27], v[60:63]
    ds_read_b64_tr_b16 v[224:225], v255 offset:33792
    ds_read2st64_b64 v[116:119], v253 offset0:4 offset1:5
    v_mfma_f32_16x16x32_bf16 v[64:67], v[228:231], v[28:31], v[64:67]
    ds_read_b64_tr_b16 v[226:227], v255 offset:33920
    v_mfma_f32_16x16x32_bf16 v[68:71], v[228:231], v[32:35], v[68:71]
    ds_write_b64 v252, v[176:177] offset:14336
    v_mfma_f32_16x16x32_bf16 v[12:15], v[232:235], v[48:51], v[12:15]
    ds_read_b64_tr_b16 v[228:229], v255 offset:34304
    ds_write_b64 v252, v[178:179] offset:14848
    v_mfma_f32_16x16x32_bf16 v[16:19], v[232:235], v[52:55], v[16:19]
    ds_read_b64_tr_b16 v[230:231], v255 offset:34432
    v_mfma_f32_16x16x32_bf16 v[20:23], v[232:235], v[56:59], v[20:23]
    ds_write_b64 v252, v[170:171] offset:12800
    s_waitcnt lgkmcnt(14)
    v_mfma_f32_16x16x32_bf16 v[12:15], v[236:239], v[72:75], v[12:15]
    ds_read_b64_tr_b16 v[232:233], v255 offset:33824
    v_mfma_f32_16x16x32_bf16 v[16:19], v[236:239], v[76:79], v[16:19]
    ds_read_b64_tr_b16 v[234:235], v255 offset:33952
    v_mfma_f32_16x16x32_bf16 v[20:23], v[236:239], v[80:83], v[20:23]
    ds_write_b64 v252, v[174:175] offset:13824
    s_waitcnt lgkmcnt(14)
    v_mfma_f32_16x16x32_bf16 v[60:63], v[216:219], v[48:51], v[60:63]
    ds_read_b64_tr_b16 v[236:237], v255 offset:34336
    v_mfma_f32_16x16x32_bf16 v[64:67], v[216:219], v[52:55], v[64:67]
    ds_read_b64_tr_b16 v[238:239], v255 offset:34464
    v_mfma_f32_16x16x32_bf16 v[68:71], v[216:219], v[56:59], v[68:71]
    s_waitcnt lgkmcnt(14)
    v_mfma_f32_16x16x32_bf16 v[60:63], v[220:223], v[72:75], v[60:63]
    ds_read_b64_tr_b16 v[216:217], v255 offset:42240
    v_mfma_f32_16x16x32_bf16 v[64:67], v[220:223], v[76:79], v[64:67]
    ds_read_b64_tr_b16 v[218:219], v255 offset:42368
    v_mfma_f32_16x16x32_bf16 v[68:71], v[220:223], v[80:83], v[68:71]
    s_waitcnt lgkmcnt(12)
    v_mfma_f32_16x16x32_bf16 v[12:15], v[224:227], v[36:39], v[12:15]
    ds_read_b64_tr_b16 v[220:221], v255 offset:42752
    v_mfma_f32_16x16x32_bf16 v[16:19], v[224:227], v[40:43], v[16:19]
    ds_read_b64_tr_b16 v[222:223], v255 offset:42880
    v_mfma_f32_16x16x32_bf16 v[20:23], v[224:227], v[44:47], v[20:23]
    s_waitcnt lgkmcnt(10)
    v_mfma_f32_16x16x32_bf16 v[12:15], v[228:231], v[84:87], v[12:15]
    ds_read_b64_tr_b16 v[224:225], v255 offset:42272
    v_mfma_f32_16x16x32_bf16 v[16:19], v[228:231], v[88:91], v[16:19]
    ds_read_b64_tr_b16 v[226:227], v255 offset:42400
    v_mfma_f32_16x16x32_bf16 v[20:23], v[228:231], v[92:95], v[20:23]
    s_waitcnt lgkmcnt(9)
    v_mfma_f32_16x16x32_bf16 v[60:63], v[232:235], v[36:39], v[60:63]
    ds_read_b64_tr_b16 v[228:229], v255 offset:42784
    v_mfma_f32_16x16x32_bf16 v[64:67], v[232:235], v[40:43], v[64:67]
    ds_read_b64_tr_b16 v[230:231], v255 offset:42912
    v_mfma_f32_16x16x32_bf16 v[68:71], v[232:235], v[44:47], v[68:71]
    s_waitcnt lgkmcnt(8)
    v_mfma_f32_16x16x32_bf16 v[60:63], v[236:239], v[84:87], v[60:63]
    v_mfma_f32_16x16x32_bf16 v[64:67], v[236:239], v[88:91], v[64:67]
    v_mfma_f32_16x16x32_bf16 v[68:71], v[236:239], v[92:95], v[68:71]
    s_waitcnt lgkmcnt(0)
    s_barrier
    v_mfma_f32_16x16x32_bf16 v[12:15], v[216:219], v[132:135], v[12:15]
    v_subrev_u32 v254, 67584, v254
    v_subrev_u32 v255, 67584, v255
    v_mfma_f32_16x16x32_bf16 v[16:19], v[216:219], v[136:139], v[16:19]
    ds_read_b64_tr_b16 v[232:233], v254 offset:0
    ds_read_b64_tr_b16 v[234:235], v254 offset:128
    v_mfma_f32_16x16x32_bf16 v[20:23], v[216:219], v[140:143], v[20:23]
    ds_read_b64_tr_b16 v[236:237], v254 offset:512
    ds_read2st64_b64 v[156:159], v253 offset0:24 offset1:25
    v_mfma_f32_16x16x32_bf16 v[12:15], v[220:223], v[192:195], v[12:15]
    ds_read_b64_tr_b16 v[238:239], v254 offset:640
    ds_read2st64_b64 v[160:163], v253 offset0:26 offset1:27
    v_mfma_f32_16x16x32_bf16 v[16:19], v[220:223], v[196:199], v[16:19]
    ds_read_b64_tr_b16 v[216:217], v254 offset:32
    ds_read2st64_b64 v[164:167], v253 offset0:28 offset1:29
    v_mfma_f32_16x16x32_bf16 v[20:23], v[220:223], v[200:203], v[20:23]
    ds_read_b64_tr_b16 v[218:219], v254 offset:160
    v_lshl_add_u32 v253, v252, 1, s78
    v_mfma_f32_16x16x32_bf16 v[60:63], v[224:227], v[132:135], v[60:63]
    ds_read_b64_tr_b16 v[220:221], v254 offset:544
    v_mov_b32 v252, -1
    v_mfma_f32_16x16x32_bf16 v[64:67], v[224:227], v[136:139], v[64:67]
    ds_read_b64_tr_b16 v[222:223], v254 offset:672
    v_mfma_f32_16x16x32_bf16 v[68:71], v[224:227], v[140:143], v[68:71]
    v_mfma_f32_16x16x32_bf16 v[60:63], v[228:231], v[192:195], v[60:63]
    ds_read_b64_tr_b16 v[224:225], v254 offset:8448
    v_mfma_f32_16x16x32_bf16 v[64:67], v[228:231], v[196:199], v[64:67]
    ds_read_b64_tr_b16 v[226:227], v254 offset:8576
    v_mfma_f32_16x16x32_bf16 v[68:71], v[228:231], v[200:203], v[68:71]
    s_waitcnt lgkmcnt(11)
    v_mfma_f32_16x16x32_bf16 v[12:15], v[232:235], v[96:99], v[12:15]
    ds_read_b64_tr_b16 v[228:229], v254 offset:8960
    v_mfma_f32_16x16x32_bf16 v[16:19], v[232:235], v[100:103], v[16:19]
    ds_read_b64_tr_b16 v[230:231], v254 offset:9088
    v_mfma_f32_16x16x32_bf16 v[20:23], v[232:235], v[104:107], v[20:23]
    s_waitcnt lgkmcnt(10)
    v_mfma_f32_16x16x32_bf16 v[12:15], v[236:239], v[120:123], v[12:15]
    ds_read_b64_tr_b16 v[232:233], v254 offset:8480
    v_mfma_f32_16x16x32_bf16 v[16:19], v[236:239], v[124:127], v[16:19]
    ds_read_b64_tr_b16 v[234:235], v254 offset:8608
    v_mfma_f32_16x16x32_bf16 v[20:23], v[236:239], v[128:131], v[20:23]
    s_waitcnt lgkmcnt(8)
    v_mfma_f32_16x16x32_bf16 v[60:63], v[216:219], v[96:99], v[60:63]
    ds_read_b64_tr_b16 v[236:237], v254 offset:8992
    v_mfma_f32_16x16x32_bf16 v[64:67], v[216:219], v[100:103], v[64:67]
    ds_read_b64_tr_b16 v[238:239], v254 offset:9120
    v_mfma_f32_16x16x32_bf16 v[68:71], v[216:219], v[104:107], v[68:71]
    s_waitcnt lgkmcnt(8)
    v_mfma_f32_16x16x32_bf16 v[60:63], v[220:223], v[120:123], v[60:63]
    ds_read_b64_tr_b16 v[216:217], v255 offset:0
    v_mfma_f32_16x16x32_bf16 v[64:67], v[220:223], v[124:127], v[64:67]
    ds_read_b64_tr_b16 v[218:219], v255 offset:128
    v_mfma_f32_16x16x32_bf16 v[68:71], v[220:223], v[128:131], v[68:71]
    s_waitcnt lgkmcnt(8)
    v_mfma_f32_16x16x32_bf16 v[12:15], v[224:227], v[144:147], v[12:15]
    ds_read_b64_tr_b16 v[220:221], v255 offset:512
    v_mfma_f32_16x16x32_bf16 v[16:19], v[224:227], v[148:151], v[16:19]
    ds_read_b64_tr_b16 v[222:223], v255 offset:640
    v_mfma_f32_16x16x32_bf16 v[20:23], v[224:227], v[152:155], v[20:23]
    s_waitcnt lgkmcnt(8)
    v_mfma_f32_16x16x32_bf16 v[12:15], v[228:231], v[168:171], v[12:15]
    ds_read_b64_tr_b16 v[224:225], v255 offset:32
    v_mfma_f32_16x16x32_bf16 v[16:19], v[228:231], v[172:175], v[16:19]
    ds_read_b64_tr_b16 v[226:227], v255 offset:160
    v_mfma_f32_16x16x32_bf16 v[20:23], v[228:231], v[176:179], v[20:23]
    s_waitcnt lgkmcnt(8)
    v_mfma_f32_16x16x32_bf16 v[60:63], v[232:235], v[144:147], v[60:63]
    ds_read_b64_tr_b16 v[228:229], v255 offset:544
    v_mfma_f32_16x16x32_bf16 v[64:67], v[232:235], v[148:151], v[64:67]
    ds_read_b64_tr_b16 v[230:231], v255 offset:672
    v_mfma_f32_16x16x32_bf16 v[68:71], v[232:235], v[152:155], v[68:71]
    s_waitcnt lgkmcnt(8)
    v_mfma_f32_16x16x32_bf16 v[60:63], v[236:239], v[168:171], v[60:63]
    ds_read_b64_tr_b16 v[232:233], v255 offset:8448
    v_mfma_f32_16x16x32_bf16 v[64:67], v[236:239], v[172:175], v[64:67]
    ds_read_b64_tr_b16 v[234:235], v255 offset:8576
    v_mfma_f32_16x16x32_bf16 v[68:71], v[236:239], v[176:179], v[68:71]
    s_waitcnt lgkmcnt(8)
    v_mfma_f32_16x16x32_bf16 v[12:15], v[216:219], v[204:207], v[12:15]
    ds_read_b64_tr_b16 v[236:237], v255 offset:8960
    v_mfma_f32_16x16x32_bf16 v[16:19], v[216:219], v[208:211], v[16:19]
    ds_read_b64_tr_b16 v[238:239], v255 offset:9088
    v_mfma_f32_16x16x32_bf16 v[20:23], v[216:219], v[212:215], v[20:23]
    s_waitcnt lgkmcnt(8)
    v_mfma_f32_16x16x32_bf16 v[12:15], v[220:223], v[240:243], v[12:15]
    ds_read_b64_tr_b16 v[216:217], v255 offset:8480
    v_mfma_f32_16x16x32_bf16 v[16:19], v[220:223], v[244:247], v[16:19]
    ds_read_b64_tr_b16 v[218:219], v255 offset:8608
    v_mfma_f32_16x16x32_bf16 v[20:23], v[220:223], v[248:251], v[20:23]
    s_waitcnt lgkmcnt(8)
    v_mfma_f32_16x16x32_bf16 v[60:63], v[224:227], v[204:207], v[60:63]
    ds_read_b64_tr_b16 v[220:221], v255 offset:8992
    v_mfma_f32_16x16x32_bf16 v[64:67], v[224:227], v[208:211], v[64:67]
    ds_read_b64_tr_b16 v[222:223], v255 offset:9120
    v_mfma_f32_16x16x32_bf16 v[68:71], v[224:227], v[212:215], v[68:71]
    s_waitcnt lgkmcnt(8)
    v_mfma_f32_16x16x32_bf16 v[60:63], v[228:231], v[240:243], v[60:63]
    v_mfma_f32_16x16x32_bf16 v[64:67], v[228:231], v[244:247], v[64:67]
    v_mfma_f32_16x16x32_bf16 v[68:71], v[228:231], v[248:251], v[68:71]
    s_waitcnt lgkmcnt(0)
    s_barrier
    v_mfma_f32_16x16x32_bf16 v[12:15], v[232:235], v[108:111], v[12:15]
    ds_read_b64_tr_b16 v[224:225], v254 offset:33792
    ds_read_b64_tr_b16 v[226:227], v254 offset:33920
    v_mfma_f32_16x16x32_bf16 v[16:19], v[232:235], v[112:115], v[16:19]
    ds_read_b64_tr_b16 v[228:229], v254 offset:34304
    v_mfma_f32_16x16x32_bf16 v[20:23], v[232:235], v[116:119], v[20:23]
    ds_read_b64_tr_b16 v[230:231], v254 offset:34432
    v_mfma_f32_16x16x32_bf16 v[12:15], v[236:239], v[156:159], v[12:15]
    ds_read_b64_tr_b16 v[232:233], v254 offset:33824
    v_mfma_f32_16x16x32_bf16 v[16:19], v[236:239], v[160:163], v[16:19]
    ds_read_b64_tr_b16 v[234:235], v254 offset:33952
    v_mfma_f32_16x16x32_bf16 v[20:23], v[236:239], v[164:167], v[20:23]
    v_mfma_f32_16x16x32_bf16 v[60:63], v[216:219], v[108:111], v[60:63]
    ds_read_b64_tr_b16 v[236:237], v254 offset:34336
    s_nop 1
    v_cvt_pk_bf16_f32 v180, v12, v13
    v_mfma_f32_16x16x32_bf16 v[64:67], v[216:219], v[112:115], v[64:67]
    ds_read_b64_tr_b16 v[238:239], v254 offset:34464
    v_cvt_pk_bf16_f32 v181, v14, v15
    v_mfma_f32_16x16x32_bf16 v[68:71], v[216:219], v[116:119], v[68:71]
    v_cvt_pk_bf16_f32 v184, v16, v17
    v_cvt_pk_bf16_f32 v185, v18, v19
    v_mfma_f32_16x16x32_bf16 v[60:63], v[220:223], v[156:159], v[60:63]
    ds_read_b64_tr_b16 v[216:217], v254 offset:42240
    v_cvt_pk_bf16_f32 v188, v20, v21
    v_mfma_f32_16x16x32_bf16 v[64:67], v[220:223], v[160:163], v[64:67]
    ds_read_b64_tr_b16 v[218:219], v254 offset:42368
    v_cvt_pk_bf16_f32 v189, v22, v23
    v_mfma_f32_16x16x32_bf16 v[68:71], v[220:223], v[164:167], v[68:71]
    s_waitcnt lgkmcnt(8)
    v_mfma_f32_16x16x32_bf16 v[12:15], v[224:227], v[0:3], 0
    ds_read_b64_tr_b16 v[220:221], v254 offset:42752
    v_cvt_pk_bf16_f32 v182, v60, v61
    v_mfma_f32_16x16x32_bf16 v[16:19], v[224:227], v[4:7], 0
    ds_read_b64_tr_b16 v[222:223], v254 offset:42880
    v_cvt_pk_bf16_f32 v183, v62, v63
    v_mfma_f32_16x16x32_bf16 v[20:23], v[224:227], v[8:11], 0
    v_cvt_pk_bf16_f32 v186, v64, v65
    v_cvt_pk_bf16_f32 v187, v66, v67
    s_waitcnt lgkmcnt(8)
    v_mfma_f32_16x16x32_bf16 v[12:15], v[228:231], v[24:27], v[12:15]
    ds_read_b64_tr_b16 v[224:225], v254 offset:42272
    v_cvt_pk_bf16_f32 v190, v68, v69
    v_mfma_f32_16x16x32_bf16 v[16:19], v[228:231], v[28:31], v[16:19]
    ds_read_b64_tr_b16 v[226:227], v254 offset:42400
    v_cvt_pk_bf16_f32 v191, v70, v71
    v_mfma_f32_16x16x32_bf16 v[20:23], v[228:231], v[32:35], v[20:23]
    s_waitcnt lgkmcnt(8)
    v_mfma_f32_16x16x32_bf16 v[60:63], v[232:235], v[0:3], 0
    ds_read_b64_tr_b16 v[228:229], v254 offset:42784
    v_mfma_f32_16x16x32_bf16 v[64:67], v[232:235], v[4:7], 0
    ds_read_b64_tr_b16 v[230:231], v254 offset:42912
    v_mfma_f32_16x16x32_bf16 v[68:71], v[232:235], v[8:11], 0
    buffer_store_dwordx4 v[180:183], v253, s[60:63], s89 offen offset:0 sc1
    s_waitcnt lgkmcnt(8)
    v_mfma_f32_16x16x32_bf16 v[60:63], v[236:239], v[24:27], v[60:63]
    ds_read_b64_tr_b16 v[232:233], v255 offset:33792
    v_mfma_f32_16x16x32_bf16 v[64:67], v[236:239], v[28:31], v[64:67]
    ds_read_b64_tr_b16 v[234:235], v255 offset:33920
    v_mfma_f32_16x16x32_bf16 v[68:71], v[236:239], v[32:35], v[68:71]
    s_waitcnt lgkmcnt(8)
    v_mfma_f32_16x16x32_bf16 v[12:15], v[216:219], v[48:51], v[12:15]
    ds_read_b64_tr_b16 v[236:237], v255 offset:34304
    v_mfma_f32_16x16x32_bf16 v[16:19], v[216:219], v[52:55], v[16:19]
    ds_read_b64_tr_b16 v[238:239], v255 offset:34432
    v_mfma_f32_16x16x32_bf16 v[20:23], v[216:219], v[56:59], v[20:23]
    buffer_store_dwordx4 v[184:187], v253, s[60:63], s89 offen offset:1024 sc1
    s_waitcnt lgkmcnt(8)
    v_mfma_f32_16x16x32_bf16 v[12:15], v[220:223], v[72:75], v[12:15]
    ds_read_b64_tr_b16 v[216:217], v255 offset:33824
    v_mfma_f32_16x16x32_bf16 v[16:19], v[220:223], v[76:79], v[16:19]
    ds_read_b64_tr_b16 v[218:219], v255 offset:33952
    v_mfma_f32_16x16x32_bf16 v[20:23], v[220:223], v[80:83], v[20:23]
    s_waitcnt lgkmcnt(8)
    v_mfma_f32_16x16x32_bf16 v[60:63], v[224:227], v[48:51], v[60:63]
    ds_read_b64_tr_b16 v[220:221], v255 offset:34336
    v_mfma_f32_16x16x32_bf16 v[64:67], v[224:227], v[52:55], v[64:67]
    ds_read_b64_tr_b16 v[222:223], v255 offset:34464
    v_mfma_f32_16x16x32_bf16 v[68:71], v[224:227], v[56:59], v[68:71]
    buffer_store_dwordx4 v[188:191], v253, s[60:63], s89 offen offset:2048 sc1
    s_waitcnt lgkmcnt(8)
    v_mfma_f32_16x16x32_bf16 v[60:63], v[228:231], v[72:75], v[60:63]
    ds_read_b64_tr_b16 v[224:225], v255 offset:42240
    s_add_u32 s89, s13, 2
    v_mfma_f32_16x16x32_bf16 v[64:67], v[228:231], v[76:79], v[64:67]
    ds_read_b64_tr_b16 v[226:227], v255 offset:42368
    s_sub_u32 s74, s89, 7
    s_cselect_b32 s89, s89, s74
    v_mfma_f32_16x16x32_bf16 v[68:71], v[228:231], v[80:83], v[68:71]
    s_cmp_eq_u32 s12, 7
    s_cselect_b32 s74, 3, 1
    s_waitcnt lgkmcnt(8)
    v_mfma_f32_16x16x32_bf16 v[12:15], v[232:235], v[36:39], v[12:15]
    ds_read_b64_tr_b16 v[228:229], v255 offset:42752
    s_lshl_b32 s18, s89, 7
    v_mfma_f32_16x16x32_bf16 v[16:19], v[232:235], v[40:43], v[16:19]
    ds_read_b64_tr_b16 v[230:231], v255 offset:42880
    s_add_u32 s18, s18, s74
    v_mfma_f32_16x16x32_bf16 v[20:23], v[232:235], v[44:47], v[20:23]
    s_lshl2_add_u32 s18, s18, s16
    s_waitcnt lgkmcnt(8)
    v_mfma_f32_16x16x32_bf16 v[12:15], v[236:239], v[84:87], v[12:15]
    ds_read_b64_tr_b16 v[232:233], v255 offset:42272
    s_mul_i32 s89, s89, 7
    v_mfma_f32_16x16x32_bf16 v[16:19], v[236:239], v[88:91], v[16:19]
    ds_read_b64_tr_b16 v[234:235], v255 offset:42400
    s_add_u32 s89, s89, s74
    v_mfma_f32_16x16x32_bf16 v[20:23], v[236:239], v[92:95], v[20:23]
    s_mul_i32 s89, s89, 12288
    s_waitcnt lgkmcnt(8)
    v_mfma_f32_16x16x32_bf16 v[60:63], v[216:219], v[36:39], v[60:63]
    ds_read_b64_tr_b16 v[236:237], v255 offset:42784
    v_mfma_f32_16x16x32_bf16 v[64:67], v[216:219], v[40:43], v[64:67]
    ds_read_b64_tr_b16 v[238:239], v255 offset:42912
    v_mfma_f32_16x16x32_bf16 v[68:71], v[216:219], v[44:47], v[68:71]
    s_waitcnt lgkmcnt(8)
    v_mfma_f32_16x16x32_bf16 v[60:63], v[220:223], v[84:87], v[60:63]
    v_mfma_f32_16x16x32_bf16 v[64:67], v[220:223], v[88:91], v[64:67]
    v_mfma_f32_16x16x32_bf16 v[68:71], v[220:223], v[92:95], v[68:71]
    s_waitcnt lgkmcnt(0)
    s_barrier
    v_mfma_f32_16x16x32_bf16 v[12:15], v[224:227], v[132:135], v[12:15]
    v_add_u32 v254, 67584, v254
    v_add_u32 v255, 67584, v255
    v_mfma_f32_16x16x32_bf16 v[16:19], v[224:227], v[136:139], v[16:19]
    ds_read_b64_tr_b16 v[216:217], v254 offset:0
    ds_read_b64_tr_b16 v[218:219], v254 offset:128
    v_mfma_f32_16x16x32_bf16 v[20:23], v[224:227], v[140:143], v[20:23]
    ds_read_b64_tr_b16 v[220:221], v254 offset:512
    v_mfma_f32_16x16x32_bf16 v[12:15], v[228:231], v[192:195], v[12:15]
    ds_read_b64_tr_b16 v[222:223], v254 offset:640
    v_mfma_f32_16x16x32_bf16 v[16:19], v[228:231], v[196:199], v[16:19]
    ds_read_b64_tr_b16 v[224:225], v254 offset:32
    v_mfma_f32_16x16x32_bf16 v[20:23], v[228:231], v[200:203], v[20:23]
    ds_read_b64_tr_b16 v[226:227], v254 offset:160
    v_mfma_f32_16x16x32_bf16 v[60:63], v[232:235], v[132:135], v[60:63]
    ds_read_b64_tr_b16 v[228:229], v254 offset:544
    v_mfma_f32_16x16x32_bf16 v[64:67], v[232:235], v[136:139], v[64:67]
    ds_read_b64_tr_b16 v[230:231], v254 offset:672
    v_mfma_f32_16x16x32_bf16 v[68:71], v[232:235], v[140:143], v[68:71]
    v_mfma_f32_16x16x32_bf16 v[60:63], v[236:239], v[192:195], v[60:63]
    ds_read_b64_tr_b16 v[232:233], v254 offset:8448
    v_mfma_f32_16x16x32_bf16 v[64:67], v[236:239], v[196:199], v[64:67]
    ds_read_b64_tr_b16 v[234:235], v254 offset:8576
    v_mfma_f32_16x16x32_bf16 v[68:71], v[236:239], v[200:203], v[68:71]
    s_waitcnt lgkmcnt(8)
    v_mfma_f32_16x16x32_bf16 v[12:15], v[216:219], v[96:99], v[12:15]
    ds_read_b64_tr_b16 v[236:237], v254 offset:8960
    v_mfma_f32_16x16x32_bf16 v[16:19], v[216:219], v[100:103], v[16:19]
    ds_read_b64_tr_b16 v[238:239], v254 offset:9088
    v_mfma_f32_16x16x32_bf16 v[20:23], v[216:219], v[104:107], v[20:23]
    s_waitcnt lgkmcnt(8)
    v_mfma_f32_16x16x32_bf16 v[12:15], v[220:223], v[120:123], v[12:15]
    ds_read_b64_tr_b16 v[216:217], v254 offset:8480
    v_mfma_f32_16x16x32_bf16 v[16:19], v[220:223], v[124:127], v[16:19]
    ds_read_b64_tr_b16 v[218:219], v254 offset:8608
    v_mfma_f32_16x16x32_bf16 v[20:23], v[220:223], v[128:131], v[20:23]
    s_waitcnt lgkmcnt(8)
    v_mfma_f32_16x16x32_bf16 v[60:63], v[224:227], v[96:99], v[60:63]
    ds_read_b64_tr_b16 v[220:221], v254 offset:8992
    v_mfma_f32_16x16x32_bf16 v[64:67], v[224:227], v[100:103], v[64:67]
    ds_read_b64_tr_b16 v[222:223], v254 offset:9120
    v_mfma_f32_16x16x32_bf16 v[68:71], v[224:227], v[104:107], v[68:71]
    s_waitcnt lgkmcnt(8)
    v_mfma_f32_16x16x32_bf16 v[60:63], v[228:231], v[120:123], v[60:63]
    ds_read_b64_tr_b16 v[224:225], v255 offset:0
    v_mfma_f32_16x16x32_bf16 v[64:67], v[228:231], v[124:127], v[64:67]
    ds_read_b64_tr_b16 v[226:227], v255 offset:128
    v_mfma_f32_16x16x32_bf16 v[68:71], v[228:231], v[128:131], v[68:71]
    s_waitcnt lgkmcnt(8)
    v_mfma_f32_16x16x32_bf16 v[12:15], v[232:235], v[144:147], v[12:15]
    ds_read_b64_tr_b16 v[228:229], v255 offset:512
    v_mfma_f32_16x16x32_bf16 v[16:19], v[232:235], v[148:151], v[16:19]
    ds_read_b64_tr_b16 v[230:231], v255 offset:640
    v_mfma_f32_16x16x32_bf16 v[20:23], v[232:235], v[152:155], v[20:23]
    s_waitcnt lgkmcnt(8)
    v_mfma_f32_16x16x32_bf16 v[12:15], v[236:239], v[168:171], v[12:15]
    ds_read_b64_tr_b16 v[232:233], v255 offset:32
    v_mfma_f32_16x16x32_bf16 v[16:19], v[236:239], v[172:175], v[16:19]
    ds_read_b64_tr_b16 v[234:235], v255 offset:160
    v_mfma_f32_16x16x32_bf16 v[20:23], v[236:239], v[176:179], v[20:23]
    s_waitcnt lgkmcnt(8)
    v_mfma_f32_16x16x32_bf16 v[60:63], v[216:219], v[144:147], v[60:63]
    ds_read_b64_tr_b16 v[236:237], v255 offset:544
    v_mfma_f32_16x16x32_bf16 v[64:67], v[216:219], v[148:151], v[64:67]
    ds_read_b64_tr_b16 v[238:239], v255 offset:672
    v_mfma_f32_16x16x32_bf16 v[68:71], v[216:219], v[152:155], v[68:71]
    s_waitcnt lgkmcnt(8)
    v_mfma_f32_16x16x32_bf16 v[60:63], v[220:223], v[168:171], v[60:63]
    ds_read_b64_tr_b16 v[216:217], v255 offset:8448
    v_mfma_f32_16x16x32_bf16 v[64:67], v[220:223], v[172:175], v[64:67]
    ds_read_b64_tr_b16 v[218:219], v255 offset:8576
    v_mfma_f32_16x16x32_bf16 v[68:71], v[220:223], v[176:179], v[68:71]
    s_waitcnt lgkmcnt(8)
    v_mfma_f32_16x16x32_bf16 v[12:15], v[224:227], v[204:207], v[12:15]
    ds_read_b64_tr_b16 v[220:221], v255 offset:8960
    v_mfma_f32_16x16x32_bf16 v[16:19], v[224:227], v[208:211], v[16:19]
    ds_read_b64_tr_b16 v[222:223], v255 offset:9088
    v_mfma_f32_16x16x32_bf16 v[20:23], v[224:227], v[212:215], v[20:23]
    s_waitcnt lgkmcnt(8)
    v_mfma_f32_16x16x32_bf16 v[12:15], v[228:231], v[240:243], v[12:15]
    ds_read_b64_tr_b16 v[224:225], v255 offset:8480
    v_mfma_f32_16x16x32_bf16 v[16:19], v[228:231], v[244:247], v[16:19]
    ds_read_b64_tr_b16 v[226:227], v255 offset:8608
    v_mfma_f32_16x16x32_bf16 v[20:23], v[228:231], v[248:251], v[20:23]
    s_waitcnt lgkmcnt(8)
    v_mfma_f32_16x16x32_bf16 v[60:63], v[232:235], v[204:207], v[60:63]
    ds_read_b64_tr_b16 v[228:229], v255 offset:8992
    v_mfma_f32_16x16x32_bf16 v[64:67], v[232:235], v[208:211], v[64:67]
    ds_read_b64_tr_b16 v[230:231], v255 offset:9120
    v_mfma_f32_16x16x32_bf16 v[68:71], v[232:235], v[212:215], v[68:71]
    s_waitcnt lgkmcnt(8)
    v_mfma_f32_16x16x32_bf16 v[60:63], v[236:239], v[240:243], v[60:63]
    v_mfma_f32_16x16x32_bf16 v[64:67], v[236:239], v[244:247], v[64:67]
    v_mfma_f32_16x16x32_bf16 v[68:71], v[236:239], v[248:251], v[68:71]
    s_waitcnt lgkmcnt(0)
    s_barrier
    v_mfma_f32_16x16x32_bf16 v[12:15], v[216:219], v[108:111], v[12:15]
    ds_read_b64_tr_b16 v[232:233], v254 offset:33792
    ds_read_b64_tr_b16 v[234:235], v254 offset:33920
    v_mfma_f32_16x16x32_bf16 v[16:19], v[216:219], v[112:115], v[16:19]
    ds_read_b64_tr_b16 v[236:237], v254 offset:34304
    v_mfma_f32_16x16x32_bf16 v[20:23], v[216:219], v[116:119], v[20:23]
    ds_read_b64_tr_b16 v[238:239], v254 offset:34432
    v_mfma_f32_16x16x32_bf16 v[12:15], v[220:223], v[156:159], v[12:15]
    ds_read_b64_tr_b16 v[216:217], v254 offset:33824
    v_mfma_f32_16x16x32_bf16 v[16:19], v[220:223], v[160:163], v[16:19]
    ds_read_b64_tr_b16 v[218:219], v254 offset:33952
    v_mfma_f32_16x16x32_bf16 v[20:23], v[220:223], v[164:167], v[20:23]
    v_mfma_f32_16x16x32_bf16 v[60:63], v[224:227], v[108:111], v[60:63]
    ds_read_b64_tr_b16 v[220:221], v254 offset:34336
    s_nop 1
    v_cvt_pk_bf16_f32 v180, v12, v13
    v_mfma_f32_16x16x32_bf16 v[64:67], v[224:227], v[112:115], v[64:67]
    ds_read_b64_tr_b16 v[222:223], v254 offset:34464
    v_cvt_pk_bf16_f32 v181, v14, v15
    v_mfma_f32_16x16x32_bf16 v[68:71], v[224:227], v[116:119], v[68:71]
    v_cvt_pk_bf16_f32 v184, v16, v17
    v_cvt_pk_bf16_f32 v185, v18, v19
    v_mfma_f32_16x16x32_bf16 v[60:63], v[228:231], v[156:159], v[60:63]
    ds_read_b64_tr_b16 v[224:225], v254 offset:42240
    v_cvt_pk_bf16_f32 v188, v20, v21
    v_mfma_f32_16x16x32_bf16 v[64:67], v[228:231], v[160:163], v[64:67]
    ds_read_b64_tr_b16 v[226:227], v254 offset:42368
    v_cvt_pk_bf16_f32 v189, v22, v23
    v_mfma_f32_16x16x32_bf16 v[68:71], v[228:231], v[164:167], v[68:71]
    s_waitcnt lgkmcnt(8)
    v_mfma_f32_16x16x32_bf16 v[12:15], v[232:235], v[0:3], 0
    ds_read_b64_tr_b16 v[228:229], v254 offset:42752
    v_cvt_pk_bf16_f32 v182, v60, v61
    v_mfma_f32_16x16x32_bf16 v[16:19], v[232:235], v[4:7], 0
    ds_read_b64_tr_b16 v[230:231], v254 offset:42880
    v_cvt_pk_bf16_f32 v183, v62, v63
    v_mfma_f32_16x16x32_bf16 v[20:23], v[232:235], v[8:11], 0
    v_cvt_pk_bf16_f32 v186, v64, v65
    v_cvt_pk_bf16_f32 v187, v66, v67
    s_waitcnt lgkmcnt(8)
    v_mfma_f32_16x16x32_bf16 v[12:15], v[236:239], v[24:27], v[12:15]
    ds_read_b64_tr_b16 v[232:233], v254 offset:42272
    v_cvt_pk_bf16_f32 v190, v68, v69
    v_mfma_f32_16x16x32_bf16 v[16:19], v[236:239], v[28:31], v[16:19]
    ds_read_b64_tr_b16 v[234:235], v254 offset:42400
    v_cvt_pk_bf16_f32 v191, v70, v71
    v_mfma_f32_16x16x32_bf16 v[20:23], v[236:239], v[32:35], v[20:23]
    s_waitcnt vmcnt(0)
    s_mov_b64 exec, 0x01010101
    buffer_store_dword v252, v253, s[60:63], s17 offen sc1
    s_mov_b64 exec, -1
    s_waitcnt lgkmcnt(8)
    v_mfma_f32_16x16x32_bf16 v[60:63], v[216:219], v[0:3], 0
    ds_read_b64_tr_b16 v[236:237], v254 offset:42784
    v_mfma_f32_16x16x32_bf16 v[64:67], v[216:219], v[4:7], 0
    ds_read_b64_tr_b16 v[238:239], v254 offset:42912
    v_mfma_f32_16x16x32_bf16 v[68:71], v[216:219], v[8:11], 0
    buffer_store_dwordx4 v[180:183], v253, s[60:63], s89 offen offset:0 sc1
    s_waitcnt lgkmcnt(8)
    v_mfma_f32_16x16x32_bf16 v[60:63], v[220:223], v[24:27], v[60:63]
    ds_read_b64_tr_b16 v[216:217], v255 offset:33792
    v_mfma_f32_16x16x32_bf16 v[64:67], v[220:223], v[28:31], v[64:67]
    ds_read_b64_tr_b16 v[218:219], v255 offset:33920
    v_mfma_f32_16x16x32_bf16 v[68:71], v[220:223], v[32:35], v[68:71]
    s_waitcnt lgkmcnt(8)
    v_mfma_f32_16x16x32_bf16 v[12:15], v[224:227], v[48:51], v[12:15]
    ds_read_b64_tr_b16 v[220:221], v255 offset:34304
    v_mfma_f32_16x16x32_bf16 v[16:19], v[224:227], v[52:55], v[16:19]
    ds_read_b64_tr_b16 v[222:223], v255 offset:34432
    v_mfma_f32_16x16x32_bf16 v[20:23], v[224:227], v[56:59], v[20:23]
    buffer_store_dwordx4 v[184:187], v253, s[60:63], s89 offen offset:1024 sc1
    s_waitcnt lgkmcnt(8)
    v_mfma_f32_16x16x32_bf16 v[12:15], v[228:231], v[72:75], v[12:15]
    ds_read_b64_tr_b16 v[224:225], v255 offset:33824
    v_mfma_f32_16x16x32_bf16 v[16:19], v[228:231], v[76:79], v[16:19]
    ds_read_b64_tr_b16 v[226:227], v255 offset:33952
    v_mfma_f32_16x16x32_bf16 v[20:23], v[228:231], v[80:83], v[20:23]
    s_waitcnt lgkmcnt(8)
    v_mfma_f32_16x16x32_bf16 v[60:63], v[232:235], v[48:51], v[60:63]
    ds_read_b64_tr_b16 v[228:229], v255 offset:34336
    v_mfma_f32_16x16x32_bf16 v[64:67], v[232:235], v[52:55], v[64:67]
    ds_read_b64_tr_b16 v[230:231], v255 offset:34464
    v_mfma_f32_16x16x32_bf16 v[68:71], v[232:235], v[56:59], v[68:71]
    buffer_store_dwordx4 v[188:191], v253, s[60:63], s89 offen offset:2048 sc1
    s_waitcnt lgkmcnt(8)
    v_mfma_f32_16x16x32_bf16 v[60:63], v[236:239], v[72:75], v[60:63]
    ds_read_b64_tr_b16 v[232:233], v255 offset:42240
    s_add_u32 s89, s13, 3
    v_mfma_f32_16x16x32_bf16 v[64:67], v[236:239], v[76:79], v[64:67]
    ds_read_b64_tr_b16 v[234:235], v255 offset:42368
    s_sub_u32 s74, s89, 7
    s_cselect_b32 s89, s89, s74
    v_mfma_f32_16x16x32_bf16 v[68:71], v[236:239], v[80:83], v[68:71]
    s_cmp_eq_u32 s12, 7
    s_cselect_b32 s74, 3, 2
    s_waitcnt lgkmcnt(8)
    v_mfma_f32_16x16x32_bf16 v[12:15], v[216:219], v[36:39], v[12:15]
    ds_read_b64_tr_b16 v[236:237], v255 offset:42752
    s_lshl_b32 s17, s89, 7
    v_mfma_f32_16x16x32_bf16 v[16:19], v[216:219], v[40:43], v[16:19]
    ds_read_b64_tr_b16 v[238:239], v255 offset:42880
    s_add_u32 s17, s17, s74
    v_mfma_f32_16x16x32_bf16 v[20:23], v[216:219], v[44:47], v[20:23]
    s_lshl2_add_u32 s17, s17, s16
    s_waitcnt lgkmcnt(8)
    v_mfma_f32_16x16x32_bf16 v[12:15], v[220:223], v[84:87], v[12:15]
    ds_read_b64_tr_b16 v[216:217], v255 offset:42272
    s_mul_i32 s89, s89, 7
    v_mfma_f32_16x16x32_bf16 v[16:19], v[220:223], v[88:91], v[16:19]
    ds_read_b64_tr_b16 v[218:219], v255 offset:42400
    s_add_u32 s89, s89, s74
    v_mfma_f32_16x16x32_bf16 v[20:23], v[220:223], v[92:95], v[20:23]
    s_mul_i32 s89, s89, 12288
    s_waitcnt lgkmcnt(8)
    v_mfma_f32_16x16x32_bf16 v[60:63], v[224:227], v[36:39], v[60:63]
    ds_read_b64_tr_b16 v[220:221], v255 offset:42784
    v_mfma_f32_16x16x32_bf16 v[64:67], v[224:227], v[40:43], v[64:67]
    ds_read_b64_tr_b16 v[222:223], v255 offset:42912
    v_mfma_f32_16x16x32_bf16 v[68:71], v[224:227], v[44:47], v[68:71]
    s_waitcnt lgkmcnt(8)
    v_mfma_f32_16x16x32_bf16 v[60:63], v[228:231], v[84:87], v[60:63]
    v_mfma_f32_16x16x32_bf16 v[64:67], v[228:231], v[88:91], v[64:67]
    v_mfma_f32_16x16x32_bf16 v[68:71], v[228:231], v[92:95], v[68:71]
    s_waitcnt lgkmcnt(0)
    s_barrier
    v_mfma_f32_16x16x32_bf16 v[12:15], v[232:235], v[132:135], v[12:15]
    v_subrev_u32 v254, 67584, v254
    v_subrev_u32 v255, 67584, v255
    v_mfma_f32_16x16x32_bf16 v[16:19], v[232:235], v[136:139], v[16:19]
    ds_read_b64_tr_b16 v[224:225], v254 offset:0
    ds_read_b64_tr_b16 v[226:227], v254 offset:128
    v_mfma_f32_16x16x32_bf16 v[20:23], v[232:235], v[140:143], v[20:23]
    ds_read_b64_tr_b16 v[228:229], v254 offset:512
    v_mfma_f32_16x16x32_bf16 v[12:15], v[236:239], v[192:195], v[12:15]
    ds_read_b64_tr_b16 v[230:231], v254 offset:640
    v_mfma_f32_16x16x32_bf16 v[16:19], v[236:239], v[196:199], v[16:19]
    ds_read_b64_tr_b16 v[232:233], v254 offset:32
    v_mfma_f32_16x16x32_bf16 v[20:23], v[236:239], v[200:203], v[20:23]
    ds_read_b64_tr_b16 v[234:235], v254 offset:160
    v_mfma_f32_16x16x32_bf16 v[60:63], v[216:219], v[132:135], v[60:63]
    ds_read_b64_tr_b16 v[236:237], v254 offset:544
    v_mfma_f32_16x16x32_bf16 v[64:67], v[216:219], v[136:139], v[64:67]
    ds_read_b64_tr_b16 v[238:239], v254 offset:672
    v_mfma_f32_16x16x32_bf16 v[68:71], v[216:219], v[140:143], v[68:71]
    v_mfma_f32_16x16x32_bf16 v[60:63], v[220:223], v[192:195], v[60:63]
    ds_read_b64_tr_b16 v[216:217], v254 offset:8448
    v_mfma_f32_16x16x32_bf16 v[64:67], v[220:223], v[196:199], v[64:67]
    ds_read_b64_tr_b16 v[218:219], v254 offset:8576
    v_mfma_f32_16x16x32_bf16 v[68:71], v[220:223], v[200:203], v[68:71]
    s_waitcnt lgkmcnt(8)
    v_mfma_f32_16x16x32_bf16 v[12:15], v[224:227], v[96:99], v[12:15]
    ds_read_b64_tr_b16 v[220:221], v254 offset:8960
    v_mfma_f32_16x16x32_bf16 v[16:19], v[224:227], v[100:103], v[16:19]
    ds_read_b64_tr_b16 v[222:223], v254 offset:9088
    v_mfma_f32_16x16x32_bf16 v[20:23], v[224:227], v[104:107], v[20:23]
    s_waitcnt lgkmcnt(8)
    v_mfma_f32_16x16x32_bf16 v[12:15], v[228:231], v[120:123], v[12:15]
    ds_read_b64_tr_b16 v[224:225], v254 offset:8480
    v_mfma_f32_16x16x32_bf16 v[16:19], v[228:231], v[124:127], v[16:19]
    ds_read_b64_tr_b16 v[226:227], v254 offset:8608
    v_mfma_f32_16x16x32_bf16 v[20:23], v[228:231], v[128:131], v[20:23]
    s_waitcnt lgkmcnt(8)
    v_mfma_f32_16x16x32_bf16 v[60:63], v[232:235], v[96:99], v[60:63]
    ds_read_b64_tr_b16 v[228:229], v254 offset:8992
    v_mfma_f32_16x16x32_bf16 v[64:67], v[232:235], v[100:103], v[64:67]
    ds_read_b64_tr_b16 v[230:231], v254 offset:9120
    v_mfma_f32_16x16x32_bf16 v[68:71], v[232:235], v[104:107], v[68:71]
    s_waitcnt lgkmcnt(8)
    v_mfma_f32_16x16x32_bf16 v[60:63], v[236:239], v[120:123], v[60:63]
    ds_read_b64_tr_b16 v[232:233], v255 offset:0
    v_mfma_f32_16x16x32_bf16 v[64:67], v[236:239], v[124:127], v[64:67]
    ds_read_b64_tr_b16 v[234:235], v255 offset:128
    v_mfma_f32_16x16x32_bf16 v[68:71], v[236:239], v[128:131], v[68:71]
    s_waitcnt lgkmcnt(8)
    v_mfma_f32_16x16x32_bf16 v[12:15], v[216:219], v[144:147], v[12:15]
    ds_read_b64_tr_b16 v[236:237], v255 offset:512
    v_mfma_f32_16x16x32_bf16 v[16:19], v[216:219], v[148:151], v[16:19]
    ds_read_b64_tr_b16 v[238:239], v255 offset:640
    v_mfma_f32_16x16x32_bf16 v[20:23], v[216:219], v[152:155], v[20:23]
    s_waitcnt lgkmcnt(8)
    v_mfma_f32_16x16x32_bf16 v[12:15], v[220:223], v[168:171], v[12:15]
    ds_read_b64_tr_b16 v[216:217], v255 offset:32
    v_mfma_f32_16x16x32_bf16 v[16:19], v[220:223], v[172:175], v[16:19]
    ds_read_b64_tr_b16 v[218:219], v255 offset:160
    v_mfma_f32_16x16x32_bf16 v[20:23], v[220:223], v[176:179], v[20:23]
    s_waitcnt lgkmcnt(8)
    v_mfma_f32_16x16x32_bf16 v[60:63], v[224:227], v[144:147], v[60:63]
    ds_read_b64_tr_b16 v[220:221], v255 offset:544
    v_mfma_f32_16x16x32_bf16 v[64:67], v[224:227], v[148:151], v[64:67]
    ds_read_b64_tr_b16 v[222:223], v255 offset:672
    v_mfma_f32_16x16x32_bf16 v[68:71], v[224:227], v[152:155], v[68:71]
    s_waitcnt lgkmcnt(8)
    v_mfma_f32_16x16x32_bf16 v[60:63], v[228:231], v[168:171], v[60:63]
    ds_read_b64_tr_b16 v[224:225], v255 offset:8448
    v_mfma_f32_16x16x32_bf16 v[64:67], v[228:231], v[172:175], v[64:67]
    ds_read_b64_tr_b16 v[226:227], v255 offset:8576
    v_mfma_f32_16x16x32_bf16 v[68:71], v[228:231], v[176:179], v[68:71]
    s_waitcnt lgkmcnt(8)
    v_mfma_f32_16x16x32_bf16 v[12:15], v[232:235], v[204:207], v[12:15]
    ds_read_b64_tr_b16 v[228:229], v255 offset:8960
    v_mfma_f32_16x16x32_bf16 v[16:19], v[232:235], v[208:211], v[16:19]
    ds_read_b64_tr_b16 v[230:231], v255 offset:9088
    v_mfma_f32_16x16x32_bf16 v[20:23], v[232:235], v[212:215], v[20:23]
    s_waitcnt lgkmcnt(8)
    v_mfma_f32_16x16x32_bf16 v[12:15], v[236:239], v[240:243], v[12:15]
    ds_read_b64_tr_b16 v[232:233], v255 offset:8480
    v_mfma_f32_16x16x32_bf16 v[16:19], v[236:239], v[244:247], v[16:19]
    ds_read_b64_tr_b16 v[234:235], v255 offset:8608
    v_mfma_f32_16x16x32_bf16 v[20:23], v[236:239], v[248:251], v[20:23]
    s_waitcnt lgkmcnt(8)
    v_mfma_f32_16x16x32_bf16 v[60:63], v[216:219], v[204:207], v[60:63]
    ds_read_b64_tr_b16 v[236:237], v255 offset:8992
    v_mfma_f32_16x16x32_bf16 v[64:67], v[216:219], v[208:211], v[64:67]
    ds_read_b64_tr_b16 v[238:239], v255 offset:9120
    v_mfma_f32_16x16x32_bf16 v[68:71], v[216:219], v[212:215], v[68:71]
    s_waitcnt lgkmcnt(8)
    v_mfma_f32_16x16x32_bf16 v[60:63], v[220:223], v[240:243], v[60:63]
    v_mfma_f32_16x16x32_bf16 v[64:67], v[220:223], v[244:247], v[64:67]
    v_mfma_f32_16x16x32_bf16 v[68:71], v[220:223], v[248:251], v[68:71]
    s_waitcnt lgkmcnt(0)
    s_barrier
    v_mfma_f32_16x16x32_bf16 v[12:15], v[224:227], v[108:111], v[12:15]
    ds_read_b64_tr_b16 v[216:217], v254 offset:33792
    ds_read_b64_tr_b16 v[218:219], v254 offset:33920
    v_mfma_f32_16x16x32_bf16 v[16:19], v[224:227], v[112:115], v[16:19]
    ds_read_b64_tr_b16 v[220:221], v254 offset:34304
    v_mfma_f32_16x16x32_bf16 v[20:23], v[224:227], v[116:119], v[20:23]
    ds_read_b64_tr_b16 v[222:223], v254 offset:34432
    v_mfma_f32_16x16x32_bf16 v[12:15], v[228:231], v[156:159], v[12:15]
    ds_read_b64_tr_b16 v[224:225], v254 offset:33824
    v_mfma_f32_16x16x32_bf16 v[16:19], v[228:231], v[160:163], v[16:19]
    ds_read_b64_tr_b16 v[226:227], v254 offset:33952
    v_mfma_f32_16x16x32_bf16 v[20:23], v[228:231], v[164:167], v[20:23]
    v_mfma_f32_16x16x32_bf16 v[60:63], v[232:235], v[108:111], v[60:63]
    ds_read_b64_tr_b16 v[228:229], v254 offset:34336
    s_nop 1
    v_cvt_pk_bf16_f32 v180, v12, v13
    v_mfma_f32_16x16x32_bf16 v[64:67], v[232:235], v[112:115], v[64:67]
    ds_read_b64_tr_b16 v[230:231], v254 offset:34464
    v_cvt_pk_bf16_f32 v181, v14, v15
    v_mfma_f32_16x16x32_bf16 v[68:71], v[232:235], v[116:119], v[68:71]
    v_cvt_pk_bf16_f32 v184, v16, v17
    v_cvt_pk_bf16_f32 v185, v18, v19
    v_mfma_f32_16x16x32_bf16 v[60:63], v[236:239], v[156:159], v[60:63]
    ds_read_b64_tr_b16 v[232:233], v254 offset:42240
    v_cvt_pk_bf16_f32 v188, v20, v21
    v_mfma_f32_16x16x32_bf16 v[64:67], v[236:239], v[160:163], v[64:67]
    ds_read_b64_tr_b16 v[234:235], v254 offset:42368
    v_cvt_pk_bf16_f32 v189, v22, v23
    v_mfma_f32_16x16x32_bf16 v[68:71], v[236:239], v[164:167], v[68:71]
    s_waitcnt lgkmcnt(8)
    v_mfma_f32_16x16x32_bf16 v[12:15], v[216:219], v[0:3], 0
    ds_read_b64_tr_b16 v[236:237], v254 offset:42752
    v_cvt_pk_bf16_f32 v182, v60, v61
    v_mfma_f32_16x16x32_bf16 v[16:19], v[216:219], v[4:7], 0
    ds_read_b64_tr_b16 v[238:239], v254 offset:42880
    v_cvt_pk_bf16_f32 v183, v62, v63
    v_mfma_f32_16x16x32_bf16 v[20:23], v[216:219], v[8:11], 0
    v_cvt_pk_bf16_f32 v186, v64, v65
    v_cvt_pk_bf16_f32 v187, v66, v67
    s_waitcnt lgkmcnt(8)
    v_mfma_f32_16x16x32_bf16 v[12:15], v[220:223], v[24:27], v[12:15]
    ds_read_b64_tr_b16 v[216:217], v254 offset:42272
    v_cvt_pk_bf16_f32 v190, v68, v69
    v_mfma_f32_16x16x32_bf16 v[16:19], v[220:223], v[28:31], v[16:19]
    ds_read_b64_tr_b16 v[218:219], v254 offset:42400
    v_cvt_pk_bf16_f32 v191, v70, v71
    v_mfma_f32_16x16x32_bf16 v[20:23], v[220:223], v[32:35], v[20:23]
    s_waitcnt vmcnt(0)
    s_mov_b64 exec, 0x01010101
    buffer_store_dword v252, v253, s[60:63], s18 offen sc1
    s_mov_b64 exec, -1
    s_waitcnt lgkmcnt(8)
    v_mfma_f32_16x16x32_bf16 v[60:63], v[224:227], v[0:3], 0
    ds_read_b64_tr_b16 v[220:221], v254 offset:42784
    v_mfma_f32_16x16x32_bf16 v[64:67], v[224:227], v[4:7], 0
    ds_read_b64_tr_b16 v[222:223], v254 offset:42912
    v_mfma_f32_16x16x32_bf16 v[68:71], v[224:227], v[8:11], 0
    buffer_store_dwordx4 v[180:183], v253, s[60:63], s89 offen offset:0 sc1
    s_waitcnt lgkmcnt(8)
    v_mfma_f32_16x16x32_bf16 v[60:63], v[228:231], v[24:27], v[60:63]
    ds_read_b64_tr_b16 v[224:225], v255 offset:33792
    v_mfma_f32_16x16x32_bf16 v[64:67], v[228:231], v[28:31], v[64:67]
    ds_read_b64_tr_b16 v[226:227], v255 offset:33920
    v_mfma_f32_16x16x32_bf16 v[68:71], v[228:231], v[32:35], v[68:71]
    s_waitcnt lgkmcnt(8)
    v_mfma_f32_16x16x32_bf16 v[12:15], v[232:235], v[48:51], v[12:15]
    ds_read_b64_tr_b16 v[228:229], v255 offset:34304
    v_mfma_f32_16x16x32_bf16 v[16:19], v[232:235], v[52:55], v[16:19]
    ds_read_b64_tr_b16 v[230:231], v255 offset:34432
    v_mfma_f32_16x16x32_bf16 v[20:23], v[232:235], v[56:59], v[20:23]
    buffer_store_dwordx4 v[184:187], v253, s[60:63], s89 offen offset:1024 sc1
    s_waitcnt lgkmcnt(8)
    v_mfma_f32_16x16x32_bf16 v[12:15], v[236:239], v[72:75], v[12:15]
    ds_read_b64_tr_b16 v[232:233], v255 offset:33824
    v_mfma_f32_16x16x32_bf16 v[16:19], v[236:239], v[76:79], v[16:19]
    ds_read_b64_tr_b16 v[234:235], v255 offset:33952
    v_mfma_f32_16x16x32_bf16 v[20:23], v[236:239], v[80:83], v[20:23]
    s_waitcnt lgkmcnt(8)
    v_mfma_f32_16x16x32_bf16 v[60:63], v[216:219], v[48:51], v[60:63]
    ds_read_b64_tr_b16 v[236:237], v255 offset:34336
    v_mfma_f32_16x16x32_bf16 v[64:67], v[216:219], v[52:55], v[64:67]
    ds_read_b64_tr_b16 v[238:239], v255 offset:34464
    v_mfma_f32_16x16x32_bf16 v[68:71], v[216:219], v[56:59], v[68:71]
    buffer_store_dwordx4 v[188:191], v253, s[60:63], s89 offen offset:2048 sc1
    s_waitcnt lgkmcnt(8)
    v_mfma_f32_16x16x32_bf16 v[60:63], v[220:223], v[72:75], v[60:63]
    ds_read_b64_tr_b16 v[216:217], v255 offset:42240
    s_add_u32 s89, s13, 4
    v_mfma_f32_16x16x32_bf16 v[64:67], v[220:223], v[76:79], v[64:67]
    ds_read_b64_tr_b16 v[218:219], v255 offset:42368
    s_sub_u32 s74, s89, 7
    s_cselect_b32 s89, s89, s74
    v_mfma_f32_16x16x32_bf16 v[68:71], v[220:223], v[80:83], v[68:71]
    s_cmp_eq_u32 s12, 7
    s_cselect_b32 s74, 3, 4
    s_waitcnt lgkmcnt(8)
    v_mfma_f32_16x16x32_bf16 v[12:15], v[224:227], v[36:39], v[12:15]
    ds_read_b64_tr_b16 v[220:221], v255 offset:42752
    s_lshl_b32 s18, s89, 7
    v_mfma_f32_16x16x32_bf16 v[16:19], v[224:227], v[40:43], v[16:19]
    ds_read_b64_tr_b16 v[222:223], v255 offset:42880
    s_add_u32 s18, s18, s74
    v_mfma_f32_16x16x32_bf16 v[20:23], v[224:227], v[44:47], v[20:23]
    s_lshl2_add_u32 s18, s18, s16
    s_waitcnt lgkmcnt(8)
    v_mfma_f32_16x16x32_bf16 v[12:15], v[228:231], v[84:87], v[12:15]
    ds_read_b64_tr_b16 v[224:225], v255 offset:42272
    s_mul_i32 s89, s89, 7
    v_mfma_f32_16x16x32_bf16 v[16:19], v[228:231], v[88:91], v[16:19]
    ds_read_b64_tr_b16 v[226:227], v255 offset:42400
    s_add_u32 s89, s89, s74
    v_mfma_f32_16x16x32_bf16 v[20:23], v[228:231], v[92:95], v[20:23]
    s_mul_i32 s89, s89, 12288
    s_waitcnt lgkmcnt(8)
    v_mfma_f32_16x16x32_bf16 v[60:63], v[232:235], v[36:39], v[60:63]
    ds_read_b64_tr_b16 v[228:229], v255 offset:42784
    v_mfma_f32_16x16x32_bf16 v[64:67], v[232:235], v[40:43], v[64:67]
    ds_read_b64_tr_b16 v[230:231], v255 offset:42912
    v_mfma_f32_16x16x32_bf16 v[68:71], v[232:235], v[44:47], v[68:71]
    s_waitcnt lgkmcnt(8)
    v_mfma_f32_16x16x32_bf16 v[60:63], v[236:239], v[84:87], v[60:63]
    v_mfma_f32_16x16x32_bf16 v[64:67], v[236:239], v[88:91], v[64:67]
    v_mfma_f32_16x16x32_bf16 v[68:71], v[236:239], v[92:95], v[68:71]
    s_waitcnt lgkmcnt(0)
    s_barrier
    v_mfma_f32_16x16x32_bf16 v[12:15], v[216:219], v[132:135], v[12:15]
    v_add_u32 v254, 67584, v254
    v_add_u32 v255, 67584, v255
    v_mfma_f32_16x16x32_bf16 v[16:19], v[216:219], v[136:139], v[16:19]
    ds_read_b64_tr_b16 v[232:233], v254 offset:0
    ds_read_b64_tr_b16 v[234:235], v254 offset:128
    v_mfma_f32_16x16x32_bf16 v[20:23], v[216:219], v[140:143], v[20:23]
    ds_read_b64_tr_b16 v[236:237], v254 offset:512
    v_mfma_f32_16x16x32_bf16 v[12:15], v[220:223], v[192:195], v[12:15]
    ds_read_b64_tr_b16 v[238:239], v254 offset:640
    v_mfma_f32_16x16x32_bf16 v[16:19], v[220:223], v[196:199], v[16:19]
    ds_read_b64_tr_b16 v[216:217], v254 offset:32
    v_mfma_f32_16x16x32_bf16 v[20:23], v[220:223], v[200:203], v[20:23]
    ds_read_b64_tr_b16 v[218:219], v254 offset:160
    v_mfma_f32_16x16x32_bf16 v[60:63], v[224:227], v[132:135], v[60:63]
    ds_read_b64_tr_b16 v[220:221], v254 offset:544
    v_mfma_f32_16x16x32_bf16 v[64:67], v[224:227], v[136:139], v[64:67]
    ds_read_b64_tr_b16 v[222:223], v254 offset:672
    v_mfma_f32_16x16x32_bf16 v[68:71], v[224:227], v[140:143], v[68:71]
    v_mfma_f32_16x16x32_bf16 v[60:63], v[228:231], v[192:195], v[60:63]
    ds_read_b64_tr_b16 v[224:225], v254 offset:8448
    v_mfma_f32_16x16x32_bf16 v[64:67], v[228:231], v[196:199], v[64:67]
    ds_read_b64_tr_b16 v[226:227], v254 offset:8576
    v_mfma_f32_16x16x32_bf16 v[68:71], v[228:231], v[200:203], v[68:71]
    s_waitcnt lgkmcnt(8)
    v_mfma_f32_16x16x32_bf16 v[12:15], v[232:235], v[96:99], v[12:15]
    ds_read_b64_tr_b16 v[228:229], v254 offset:8960
    v_mfma_f32_16x16x32_bf16 v[16:19], v[232:235], v[100:103], v[16:19]
    ds_read_b64_tr_b16 v[230:231], v254 offset:9088
    v_mfma_f32_16x16x32_bf16 v[20:23], v[232:235], v[104:107], v[20:23]
    s_waitcnt lgkmcnt(8)
    v_mfma_f32_16x16x32_bf16 v[12:15], v[236:239], v[120:123], v[12:15]
    ds_read_b64_tr_b16 v[232:233], v254 offset:8480
    v_mfma_f32_16x16x32_bf16 v[16:19], v[236:239], v[124:127], v[16:19]
    ds_read_b64_tr_b16 v[234:235], v254 offset:8608
    v_mfma_f32_16x16x32_bf16 v[20:23], v[236:239], v[128:131], v[20:23]
    s_waitcnt lgkmcnt(8)
    v_mfma_f32_16x16x32_bf16 v[60:63], v[216:219], v[96:99], v[60:63]
    ds_read_b64_tr_b16 v[236:237], v254 offset:8992
    v_mfma_f32_16x16x32_bf16 v[64:67], v[216:219], v[100:103], v[64:67]
    ds_read_b64_tr_b16 v[238:239], v254 offset:9120
    v_mfma_f32_16x16x32_bf16 v[68:71], v[216:219], v[104:107], v[68:71]
    s_waitcnt lgkmcnt(8)
    v_mfma_f32_16x16x32_bf16 v[60:63], v[220:223], v[120:123], v[60:63]
    ds_read_b64_tr_b16 v[216:217], v255 offset:0
    v_mfma_f32_16x16x32_bf16 v[64:67], v[220:223], v[124:127], v[64:67]
    ds_read_b64_tr_b16 v[218:219], v255 offset:128
    v_mfma_f32_16x16x32_bf16 v[68:71], v[220:223], v[128:131], v[68:71]
    s_waitcnt lgkmcnt(8)
    v_mfma_f32_16x16x32_bf16 v[12:15], v[224:227], v[144:147], v[12:15]
    ds_read_b64_tr_b16 v[220:221], v255 offset:512
    v_mfma_f32_16x16x32_bf16 v[16:19], v[224:227], v[148:151], v[16:19]
    ds_read_b64_tr_b16 v[222:223], v255 offset:640
    v_mfma_f32_16x16x32_bf16 v[20:23], v[224:227], v[152:155], v[20:23]
    s_waitcnt lgkmcnt(8)
    v_mfma_f32_16x16x32_bf16 v[12:15], v[228:231], v[168:171], v[12:15]
    ds_read_b64_tr_b16 v[224:225], v255 offset:32
    v_mfma_f32_16x16x32_bf16 v[16:19], v[228:231], v[172:175], v[16:19]
    ds_read_b64_tr_b16 v[226:227], v255 offset:160
    v_mfma_f32_16x16x32_bf16 v[20:23], v[228:231], v[176:179], v[20:23]
    s_waitcnt lgkmcnt(8)
    v_mfma_f32_16x16x32_bf16 v[60:63], v[232:235], v[144:147], v[60:63]
    ds_read_b64_tr_b16 v[228:229], v255 offset:544
    v_mfma_f32_16x16x32_bf16 v[64:67], v[232:235], v[148:151], v[64:67]
    ds_read_b64_tr_b16 v[230:231], v255 offset:672
    v_mfma_f32_16x16x32_bf16 v[68:71], v[232:235], v[152:155], v[68:71]
    s_waitcnt lgkmcnt(8)
    v_mfma_f32_16x16x32_bf16 v[60:63], v[236:239], v[168:171], v[60:63]
    ds_read_b64_tr_b16 v[232:233], v255 offset:8448
    v_mfma_f32_16x16x32_bf16 v[64:67], v[236:239], v[172:175], v[64:67]
    ds_read_b64_tr_b16 v[234:235], v255 offset:8576
    v_mfma_f32_16x16x32_bf16 v[68:71], v[236:239], v[176:179], v[68:71]
    s_waitcnt lgkmcnt(8)
    v_mfma_f32_16x16x32_bf16 v[12:15], v[216:219], v[204:207], v[12:15]
    ds_read_b64_tr_b16 v[236:237], v255 offset:8960
    v_mfma_f32_16x16x32_bf16 v[16:19], v[216:219], v[208:211], v[16:19]
    ds_read_b64_tr_b16 v[238:239], v255 offset:9088
    v_mfma_f32_16x16x32_bf16 v[20:23], v[216:219], v[212:215], v[20:23]
    s_waitcnt lgkmcnt(8)
    v_mfma_f32_16x16x32_bf16 v[12:15], v[220:223], v[240:243], v[12:15]
    ds_read_b64_tr_b16 v[216:217], v255 offset:8480
    v_mfma_f32_16x16x32_bf16 v[16:19], v[220:223], v[244:247], v[16:19]
    ds_read_b64_tr_b16 v[218:219], v255 offset:8608
    v_mfma_f32_16x16x32_bf16 v[20:23], v[220:223], v[248:251], v[20:23]
    s_waitcnt lgkmcnt(8)
    v_mfma_f32_16x16x32_bf16 v[60:63], v[224:227], v[204:207], v[60:63]
    ds_read_b64_tr_b16 v[220:221], v255 offset:8992
    v_mfma_f32_16x16x32_bf16 v[64:67], v[224:227], v[208:211], v[64:67]
    ds_read_b64_tr_b16 v[222:223], v255 offset:9120
    v_mfma_f32_16x16x32_bf16 v[68:71], v[224:227], v[212:215], v[68:71]
    s_waitcnt lgkmcnt(8)
    v_mfma_f32_16x16x32_bf16 v[60:63], v[228:231], v[240:243], v[60:63]
    v_mfma_f32_16x16x32_bf16 v[64:67], v[228:231], v[244:247], v[64:67]
    v_mfma_f32_16x16x32_bf16 v[68:71], v[228:231], v[248:251], v[68:71]
    s_waitcnt lgkmcnt(0)
    s_barrier
    v_mfma_f32_16x16x32_bf16 v[12:15], v[232:235], v[108:111], v[12:15]
    ds_read_b64_tr_b16 v[224:225], v254 offset:33792
    ds_read_b64_tr_b16 v[226:227], v254 offset:33920
    v_mfma_f32_16x16x32_bf16 v[16:19], v[232:235], v[112:115], v[16:19]
    ds_read_b64_tr_b16 v[228:229], v254 offset:34304
    v_mfma_f32_16x16x32_bf16 v[20:23], v[232:235], v[116:119], v[20:23]
    ds_read_b64_tr_b16 v[230:231], v254 offset:34432
    v_mfma_f32_16x16x32_bf16 v[12:15], v[236:239], v[156:159], v[12:15]
    ds_read_b64_tr_b16 v[232:233], v254 offset:33824
    v_mfma_f32_16x16x32_bf16 v[16:19], v[236:239], v[160:163], v[16:19]
    ds_read_b64_tr_b16 v[234:235], v254 offset:33952
    v_mfma_f32_16x16x32_bf16 v[20:23], v[236:239], v[164:167], v[20:23]
    v_mfma_f32_16x16x32_bf16 v[60:63], v[216:219], v[108:111], v[60:63]
    ds_read_b64_tr_b16 v[236:237], v254 offset:34336
    s_nop 1
    v_cvt_pk_bf16_f32 v180, v12, v13
    v_mfma_f32_16x16x32_bf16 v[64:67], v[216:219], v[112:115], v[64:67]
    ds_read_b64_tr_b16 v[238:239], v254 offset:34464
    v_cvt_pk_bf16_f32 v181, v14, v15
    v_mfma_f32_16x16x32_bf16 v[68:71], v[216:219], v[116:119], v[68:71]
    v_cvt_pk_bf16_f32 v184, v16, v17
    v_cvt_pk_bf16_f32 v185, v18, v19
    v_mfma_f32_16x16x32_bf16 v[60:63], v[220:223], v[156:159], v[60:63]
    ds_read_b64_tr_b16 v[216:217], v254 offset:42240
    v_cvt_pk_bf16_f32 v188, v20, v21
    v_mfma_f32_16x16x32_bf16 v[64:67], v[220:223], v[160:163], v[64:67]
    ds_read_b64_tr_b16 v[218:219], v254 offset:42368
    v_cvt_pk_bf16_f32 v189, v22, v23
    v_mfma_f32_16x16x32_bf16 v[68:71], v[220:223], v[164:167], v[68:71]
    s_waitcnt lgkmcnt(8)
    v_mfma_f32_16x16x32_bf16 v[12:15], v[224:227], v[0:3], 0
    ds_read_b64_tr_b16 v[220:221], v254 offset:42752
    v_cvt_pk_bf16_f32 v182, v60, v61
    v_mfma_f32_16x16x32_bf16 v[16:19], v[224:227], v[4:7], 0
    ds_read_b64_tr_b16 v[222:223], v254 offset:42880
    v_cvt_pk_bf16_f32 v183, v62, v63
    v_mfma_f32_16x16x32_bf16 v[20:23], v[224:227], v[8:11], 0
    v_cvt_pk_bf16_f32 v186, v64, v65
    v_cvt_pk_bf16_f32 v187, v66, v67
    s_waitcnt lgkmcnt(8)
    v_mfma_f32_16x16x32_bf16 v[12:15], v[228:231], v[24:27], v[12:15]
    ds_read_b64_tr_b16 v[224:225], v254 offset:42272
    v_cvt_pk_bf16_f32 v190, v68, v69
    v_mfma_f32_16x16x32_bf16 v[16:19], v[228:231], v[28:31], v[16:19]
    ds_read_b64_tr_b16 v[226:227], v254 offset:42400
    v_cvt_pk_bf16_f32 v191, v70, v71
    v_mfma_f32_16x16x32_bf16 v[20:23], v[228:231], v[32:35], v[20:23]
    s_waitcnt vmcnt(0)
    s_mov_b64 exec, 0x01010101
    buffer_store_dword v252, v253, s[60:63], s17 offen sc1
    s_mov_b64 exec, -1
    s_waitcnt lgkmcnt(8)
    v_mfma_f32_16x16x32_bf16 v[60:63], v[232:235], v[0:3], 0
    ds_read_b64_tr_b16 v[228:229], v254 offset:42784
    v_mfma_f32_16x16x32_bf16 v[64:67], v[232:235], v[4:7], 0
    ds_read_b64_tr_b16 v[230:231], v254 offset:42912
    v_mfma_f32_16x16x32_bf16 v[68:71], v[232:235], v[8:11], 0
    buffer_store_dwordx4 v[180:183], v253, s[60:63], s89 offen offset:0 sc1
    s_waitcnt lgkmcnt(8)
    v_mfma_f32_16x16x32_bf16 v[60:63], v[236:239], v[24:27], v[60:63]
    ds_read_b64_tr_b16 v[232:233], v255 offset:33792
    v_mfma_f32_16x16x32_bf16 v[64:67], v[236:239], v[28:31], v[64:67]
    ds_read_b64_tr_b16 v[234:235], v255 offset:33920
    v_mfma_f32_16x16x32_bf16 v[68:71], v[236:239], v[32:35], v[68:71]
    s_waitcnt lgkmcnt(8)
    v_mfma_f32_16x16x32_bf16 v[12:15], v[216:219], v[48:51], v[12:15]
    ds_read_b64_tr_b16 v[236:237], v255 offset:34304
    v_mfma_f32_16x16x32_bf16 v[16:19], v[216:219], v[52:55], v[16:19]
    ds_read_b64_tr_b16 v[238:239], v255 offset:34432
    v_mfma_f32_16x16x32_bf16 v[20:23], v[216:219], v[56:59], v[20:23]
    buffer_store_dwordx4 v[184:187], v253, s[60:63], s89 offen offset:1024 sc1
    s_waitcnt lgkmcnt(8)
    v_mfma_f32_16x16x32_bf16 v[12:15], v[220:223], v[72:75], v[12:15]
    ds_read_b64_tr_b16 v[216:217], v255 offset:33824
    v_mfma_f32_16x16x32_bf16 v[16:19], v[220:223], v[76:79], v[16:19]
    ds_read_b64_tr_b16 v[218:219], v255 offset:33952
    v_mfma_f32_16x16x32_bf16 v[20:23], v[220:223], v[80:83], v[20:23]
    s_waitcnt lgkmcnt(8)
    v_mfma_f32_16x16x32_bf16 v[60:63], v[224:227], v[48:51], v[60:63]
    ds_read_b64_tr_b16 v[220:221], v255 offset:34336
    v_mfma_f32_16x16x32_bf16 v[64:67], v[224:227], v[52:55], v[64:67]
    ds_read_b64_tr_b16 v[222:223], v255 offset:34464
    v_mfma_f32_16x16x32_bf16 v[68:71], v[224:227], v[56:59], v[68:71]
    buffer_store_dwordx4 v[188:191], v253, s[60:63], s89 offen offset:2048 sc1
    s_waitcnt lgkmcnt(8)
    v_mfma_f32_16x16x32_bf16 v[60:63], v[228:231], v[72:75], v[60:63]
    ds_read_b64_tr_b16 v[224:225], v255 offset:42240
    s_add_u32 s89, s13, 5
    v_mfma_f32_16x16x32_bf16 v[64:67], v[228:231], v[76:79], v[64:67]
    ds_read_b64_tr_b16 v[226:227], v255 offset:42368
    s_sub_u32 s74, s89, 7
    s_cselect_b32 s89, s89, s74
    v_mfma_f32_16x16x32_bf16 v[68:71], v[228:231], v[80:83], v[68:71]
    s_cmp_eq_u32 s12, 7
    s_cselect_b32 s74, 3, 5
    s_waitcnt lgkmcnt(8)
    v_mfma_f32_16x16x32_bf16 v[12:15], v[232:235], v[36:39], v[12:15]
    ds_read_b64_tr_b16 v[228:229], v255 offset:42752
    s_lshl_b32 s17, s89, 7
    v_mfma_f32_16x16x32_bf16 v[16:19], v[232:235], v[40:43], v[16:19]
    ds_read_b64_tr_b16 v[230:231], v255 offset:42880
    s_add_u32 s17, s17, s74
    v_mfma_f32_16x16x32_bf16 v[20:23], v[232:235], v[44:47], v[20:23]
    s_lshl2_add_u32 s17, s17, s16
    s_waitcnt lgkmcnt(8)
    v_mfma_f32_16x16x32_bf16 v[12:15], v[236:239], v[84:87], v[12:15]
    ds_read_b64_tr_b16 v[232:233], v255 offset:42272
    s_mul_i32 s89, s89, 7
    v_mfma_f32_16x16x32_bf16 v[16:19], v[236:239], v[88:91], v[16:19]
    ds_read_b64_tr_b16 v[234:235], v255 offset:42400
    s_add_u32 s89, s89, s74
    v_mfma_f32_16x16x32_bf16 v[20:23], v[236:239], v[92:95], v[20:23]
    s_mul_i32 s89, s89, 12288
    s_waitcnt lgkmcnt(8)
    v_mfma_f32_16x16x32_bf16 v[60:63], v[216:219], v[36:39], v[60:63]
    ds_read_b64_tr_b16 v[236:237], v255 offset:42784
    v_mfma_f32_16x16x32_bf16 v[64:67], v[216:219], v[40:43], v[64:67]
    ds_read_b64_tr_b16 v[238:239], v255 offset:42912
    v_mfma_f32_16x16x32_bf16 v[68:71], v[216:219], v[44:47], v[68:71]
    s_waitcnt lgkmcnt(8)
    v_mfma_f32_16x16x32_bf16 v[60:63], v[220:223], v[84:87], v[60:63]
    v_mfma_f32_16x16x32_bf16 v[64:67], v[220:223], v[88:91], v[64:67]
    v_mfma_f32_16x16x32_bf16 v[68:71], v[220:223], v[92:95], v[68:71]
    s_waitcnt lgkmcnt(0)
    s_barrier
    v_mfma_f32_16x16x32_bf16 v[12:15], v[224:227], v[132:135], v[12:15]
    v_subrev_u32 v254, 67584, v254
    v_subrev_u32 v255, 67584, v255
    v_mfma_f32_16x16x32_bf16 v[16:19], v[224:227], v[136:139], v[16:19]
    ds_read_b64_tr_b16 v[216:217], v254 offset:0
    ds_read_b64_tr_b16 v[218:219], v254 offset:128
    v_mfma_f32_16x16x32_bf16 v[20:23], v[224:227], v[140:143], v[20:23]
    ds_read_b64_tr_b16 v[220:221], v254 offset:512
    v_mfma_f32_16x16x32_bf16 v[12:15], v[228:231], v[192:195], v[12:15]
    ds_read_b64_tr_b16 v[222:223], v254 offset:640
    v_mfma_f32_16x16x32_bf16 v[16:19], v[228:231], v[196:199], v[16:19]
    ds_read_b64_tr_b16 v[224:225], v254 offset:32
    v_mfma_f32_16x16x32_bf16 v[20:23], v[228:231], v[200:203], v[20:23]
    ds_read_b64_tr_b16 v[226:227], v254 offset:160
    v_mfma_f32_16x16x32_bf16 v[60:63], v[232:235], v[132:135], v[60:63]
    ds_read_b64_tr_b16 v[228:229], v254 offset:544
    v_mfma_f32_16x16x32_bf16 v[64:67], v[232:235], v[136:139], v[64:67]
    ds_read_b64_tr_b16 v[230:231], v254 offset:672
    v_mfma_f32_16x16x32_bf16 v[68:71], v[232:235], v[140:143], v[68:71]
    v_mfma_f32_16x16x32_bf16 v[60:63], v[236:239], v[192:195], v[60:63]
    ds_read_b64_tr_b16 v[232:233], v254 offset:8448
    v_mfma_f32_16x16x32_bf16 v[64:67], v[236:239], v[196:199], v[64:67]
    ds_read_b64_tr_b16 v[234:235], v254 offset:8576
    v_mfma_f32_16x16x32_bf16 v[68:71], v[236:239], v[200:203], v[68:71]
    s_waitcnt lgkmcnt(8)
    v_mfma_f32_16x16x32_bf16 v[12:15], v[216:219], v[96:99], v[12:15]
    ds_read_b64_tr_b16 v[236:237], v254 offset:8960
    v_mfma_f32_16x16x32_bf16 v[16:19], v[216:219], v[100:103], v[16:19]
    ds_read_b64_tr_b16 v[238:239], v254 offset:9088
    v_mfma_f32_16x16x32_bf16 v[20:23], v[216:219], v[104:107], v[20:23]
    s_waitcnt lgkmcnt(8)
    v_mfma_f32_16x16x32_bf16 v[12:15], v[220:223], v[120:123], v[12:15]
    ds_read_b64_tr_b16 v[216:217], v254 offset:8480
    v_mfma_f32_16x16x32_bf16 v[16:19], v[220:223], v[124:127], v[16:19]
    ds_read_b64_tr_b16 v[218:219], v254 offset:8608
    v_mfma_f32_16x16x32_bf16 v[20:23], v[220:223], v[128:131], v[20:23]
    s_waitcnt lgkmcnt(8)
    v_mfma_f32_16x16x32_bf16 v[60:63], v[224:227], v[96:99], v[60:63]
    ds_read_b64_tr_b16 v[220:221], v254 offset:8992
    v_mfma_f32_16x16x32_bf16 v[64:67], v[224:227], v[100:103], v[64:67]
    ds_read_b64_tr_b16 v[222:223], v254 offset:9120
    v_mfma_f32_16x16x32_bf16 v[68:71], v[224:227], v[104:107], v[68:71]
    s_waitcnt lgkmcnt(8)
    v_mfma_f32_16x16x32_bf16 v[60:63], v[228:231], v[120:123], v[60:63]
    ds_read_b64_tr_b16 v[224:225], v255 offset:0
    v_mfma_f32_16x16x32_bf16 v[64:67], v[228:231], v[124:127], v[64:67]
    ds_read_b64_tr_b16 v[226:227], v255 offset:128
    v_mfma_f32_16x16x32_bf16 v[68:71], v[228:231], v[128:131], v[68:71]
    s_waitcnt lgkmcnt(8)
    v_mfma_f32_16x16x32_bf16 v[12:15], v[232:235], v[144:147], v[12:15]
    ds_read_b64_tr_b16 v[228:229], v255 offset:512
    v_mfma_f32_16x16x32_bf16 v[16:19], v[232:235], v[148:151], v[16:19]
    ds_read_b64_tr_b16 v[230:231], v255 offset:640
    v_mfma_f32_16x16x32_bf16 v[20:23], v[232:235], v[152:155], v[20:23]
    s_waitcnt lgkmcnt(8)
    v_mfma_f32_16x16x32_bf16 v[12:15], v[236:239], v[168:171], v[12:15]
    ds_read_b64_tr_b16 v[232:233], v255 offset:32
    v_mfma_f32_16x16x32_bf16 v[16:19], v[236:239], v[172:175], v[16:19]
    ds_read_b64_tr_b16 v[234:235], v255 offset:160
    v_mfma_f32_16x16x32_bf16 v[20:23], v[236:239], v[176:179], v[20:23]
    s_waitcnt lgkmcnt(8)
    v_mfma_f32_16x16x32_bf16 v[60:63], v[216:219], v[144:147], v[60:63]
    ds_read_b64_tr_b16 v[236:237], v255 offset:544
    v_mfma_f32_16x16x32_bf16 v[64:67], v[216:219], v[148:151], v[64:67]
    ds_read_b64_tr_b16 v[238:239], v255 offset:672
    v_mfma_f32_16x16x32_bf16 v[68:71], v[216:219], v[152:155], v[68:71]
    s_waitcnt lgkmcnt(8)
    v_mfma_f32_16x16x32_bf16 v[60:63], v[220:223], v[168:171], v[60:63]
    ds_read_b64_tr_b16 v[216:217], v255 offset:8448
    v_mfma_f32_16x16x32_bf16 v[64:67], v[220:223], v[172:175], v[64:67]
    ds_read_b64_tr_b16 v[218:219], v255 offset:8576
    v_mfma_f32_16x16x32_bf16 v[68:71], v[220:223], v[176:179], v[68:71]
    s_waitcnt lgkmcnt(8)
    v_mfma_f32_16x16x32_bf16 v[12:15], v[224:227], v[204:207], v[12:15]
    ds_read_b64_tr_b16 v[220:221], v255 offset:8960
    v_mfma_f32_16x16x32_bf16 v[16:19], v[224:227], v[208:211], v[16:19]
    ds_read_b64_tr_b16 v[222:223], v255 offset:9088
    v_mfma_f32_16x16x32_bf16 v[20:23], v[224:227], v[212:215], v[20:23]
    s_waitcnt lgkmcnt(8)
    v_mfma_f32_16x16x32_bf16 v[12:15], v[228:231], v[240:243], v[12:15]
    ds_read_b64_tr_b16 v[224:225], v255 offset:8480
    v_mfma_f32_16x16x32_bf16 v[16:19], v[228:231], v[244:247], v[16:19]
    ds_read_b64_tr_b16 v[226:227], v255 offset:8608
    v_mfma_f32_16x16x32_bf16 v[20:23], v[228:231], v[248:251], v[20:23]
    s_waitcnt lgkmcnt(8)
    v_mfma_f32_16x16x32_bf16 v[60:63], v[232:235], v[204:207], v[60:63]
    ds_read_b64_tr_b16 v[228:229], v255 offset:8992
    v_mfma_f32_16x16x32_bf16 v[64:67], v[232:235], v[208:211], v[64:67]
    ds_read_b64_tr_b16 v[230:231], v255 offset:9120
    v_mfma_f32_16x16x32_bf16 v[68:71], v[232:235], v[212:215], v[68:71]
    s_waitcnt lgkmcnt(8)
    v_mfma_f32_16x16x32_bf16 v[60:63], v[236:239], v[240:243], v[60:63]
    v_mfma_f32_16x16x32_bf16 v[64:67], v[236:239], v[244:247], v[64:67]
    v_mfma_f32_16x16x32_bf16 v[68:71], v[236:239], v[248:251], v[68:71]
    s_waitcnt lgkmcnt(0)
    s_barrier
    v_mfma_f32_16x16x32_bf16 v[12:15], v[216:219], v[108:111], v[12:15]
    ds_read_b64_tr_b16 v[232:233], v254 offset:33792
    ds_read_b64_tr_b16 v[234:235], v254 offset:33920
    v_mfma_f32_16x16x32_bf16 v[16:19], v[216:219], v[112:115], v[16:19]
    ds_read_b64_tr_b16 v[236:237], v254 offset:34304
    v_mfma_f32_16x16x32_bf16 v[20:23], v[216:219], v[116:119], v[20:23]
    ds_read_b64_tr_b16 v[238:239], v254 offset:34432
    v_mfma_f32_16x16x32_bf16 v[12:15], v[220:223], v[156:159], v[12:15]
    ds_read_b64_tr_b16 v[216:217], v254 offset:33824
    v_mfma_f32_16x16x32_bf16 v[16:19], v[220:223], v[160:163], v[16:19]
    ds_read_b64_tr_b16 v[218:219], v254 offset:33952
    v_mfma_f32_16x16x32_bf16 v[20:23], v[220:223], v[164:167], v[20:23]
    v_mfma_f32_16x16x32_bf16 v[60:63], v[224:227], v[108:111], v[60:63]
    ds_read_b64_tr_b16 v[220:221], v254 offset:34336
    s_nop 1
    v_cvt_pk_bf16_f32 v180, v12, v13
    v_mfma_f32_16x16x32_bf16 v[64:67], v[224:227], v[112:115], v[64:67]
    ds_read_b64_tr_b16 v[222:223], v254 offset:34464
    v_cvt_pk_bf16_f32 v181, v14, v15
    v_mfma_f32_16x16x32_bf16 v[68:71], v[224:227], v[116:119], v[68:71]
    v_cvt_pk_bf16_f32 v184, v16, v17
    v_cvt_pk_bf16_f32 v185, v18, v19
    v_mfma_f32_16x16x32_bf16 v[60:63], v[228:231], v[156:159], v[60:63]
    ds_read_b64_tr_b16 v[224:225], v254 offset:42240
    v_cvt_pk_bf16_f32 v188, v20, v21
    v_mfma_f32_16x16x32_bf16 v[64:67], v[228:231], v[160:163], v[64:67]
    ds_read_b64_tr_b16 v[226:227], v254 offset:42368
    v_cvt_pk_bf16_f32 v189, v22, v23
    v_mfma_f32_16x16x32_bf16 v[68:71], v[228:231], v[164:167], v[68:71]
    v_min_u32 v180, -2, v180
    v_min_u32 v181, -2, v181
    s_waitcnt lgkmcnt(8)
    v_mfma_f32_16x16x32_bf16 v[12:15], v[232:235], v[0:3], 0
    ds_read_b64_tr_b16 v[228:229], v254 offset:42752
    v_min_u32 v184, -2, v184
    v_mfma_f32_16x16x32_bf16 v[16:19], v[232:235], v[4:7], 0
    ds_read_b64_tr_b16 v[230:231], v254 offset:42880
    v_min_u32 v185, -2, v185
    v_mfma_f32_16x16x32_bf16 v[20:23], v[232:235], v[8:11], 0
    v_min_u32 v188, -2, v188
    v_min_u32 v189, -2, v189
    s_waitcnt lgkmcnt(8)
    v_mfma_f32_16x16x32_bf16 v[12:15], v[236:239], v[24:27], v[12:15]
    ds_read_b64_tr_b16 v[232:233], v254 offset:42272
    v_cvt_pk_bf16_f32 v182, v60, v61
    v_mfma_f32_16x16x32_bf16 v[16:19], v[236:239], v[28:31], v[16:19]
    ds_read_b64_tr_b16 v[234:235], v254 offset:42400
    v_cvt_pk_bf16_f32 v183, v62, v63
    v_mfma_f32_16x16x32_bf16 v[20:23], v[236:239], v[32:35], v[20:23]
    v_cvt_pk_bf16_f32 v186, v64, v65
    v_cvt_pk_bf16_f32 v187, v66, v67
    v_cvt_pk_bf16_f32 v190, v68, v69
    v_cvt_pk_bf16_f32 v191, v70, v71
    s_waitcnt lgkmcnt(8)
    v_mfma_f32_16x16x32_bf16 v[60:63], v[216:219], v[0:3], 0
    ds_read_b64_tr_b16 v[236:237], v254 offset:42784
    v_min_u32 v182, -2, v182
    v_mfma_f32_16x16x32_bf16 v[64:67], v[216:219], v[4:7], 0
    ds_read_b64_tr_b16 v[238:239], v254 offset:42912
    v_min_u32 v183, -2, v183
    v_mfma_f32_16x16x32_bf16 v[68:71], v[216:219], v[8:11], 0
    v_min_u32 v186, -2, v186
    v_min_u32 v187, -2, v187
    s_waitcnt lgkmcnt(8)
    v_mfma_f32_16x16x32_bf16 v[60:63], v[220:223], v[24:27], v[60:63]
    ds_read_b64_tr_b16 v[216:217], v255 offset:33792
    v_min_u32 v190, -2, v190
    v_mfma_f32_16x16x32_bf16 v[64:67], v[220:223], v[28:31], v[64:67]
    ds_read_b64_tr_b16 v[218:219], v255 offset:33920
    v_min_u32 v191, -2, v191
    v_mfma_f32_16x16x32_bf16 v[68:71], v[220:223], v[32:35], v[68:71]
    s_waitcnt vmcnt(0)
    s_mov_b64 exec, 0x01010101
    buffer_store_dword v252, v253, s[60:63], s18 offen sc1
    s_mov_b64 exec, -1
    s_waitcnt lgkmcnt(8)
    v_mfma_f32_16x16x32_bf16 v[12:15], v[224:227], v[48:51], v[12:15]
    ds_read_b64_tr_b16 v[220:221], v255 offset:34304
    v_mfma_f32_16x16x32_bf16 v[16:19], v[224:227], v[52:55], v[16:19]
    ds_read_b64_tr_b16 v[222:223], v255 offset:34432
    v_mfma_f32_16x16x32_bf16 v[20:23], v[224:227], v[56:59], v[20:23]
    s_mov_b64 exec, 0x01010101
    buffer_store_dword v252, v253, s[60:63], s17 offen sc1
    s_mov_b64 exec, -1
    s_waitcnt lgkmcnt(8)
    v_mfma_f32_16x16x32_bf16 v[12:15], v[228:231], v[72:75], v[12:15]
    ds_read_b64_tr_b16 v[224:225], v255 offset:33824
    v_mfma_f32_16x16x32_bf16 v[16:19], v[228:231], v[76:79], v[16:19]
    ds_read_b64_tr_b16 v[226:227], v255 offset:33952
    v_mfma_f32_16x16x32_bf16 v[20:23], v[228:231], v[80:83], v[20:23]
    buffer_store_dwordx4 v[180:183], v253, s[60:63], s89 offen offset:0 sc1
    s_waitcnt lgkmcnt(8)
    v_mfma_f32_16x16x32_bf16 v[60:63], v[232:235], v[48:51], v[60:63]
    ds_read_b64_tr_b16 v[228:229], v255 offset:34336
    v_mfma_f32_16x16x32_bf16 v[64:67], v[232:235], v[52:55], v[64:67]
    ds_read_b64_tr_b16 v[230:231], v255 offset:34464
    v_mfma_f32_16x16x32_bf16 v[68:71], v[232:235], v[56:59], v[68:71]
    buffer_store_dwordx4 v[184:187], v253, s[60:63], s89 offen offset:1024 sc1
    s_waitcnt lgkmcnt(8)
    v_mfma_f32_16x16x32_bf16 v[60:63], v[236:239], v[72:75], v[60:63]
    ds_read_b64_tr_b16 v[232:233], v255 offset:42240
    v_mfma_f32_16x16x32_bf16 v[64:67], v[236:239], v[76:79], v[64:67]
    ds_read_b64_tr_b16 v[234:235], v255 offset:42368
    v_mfma_f32_16x16x32_bf16 v[68:71], v[236:239], v[80:83], v[68:71]
    buffer_store_dwordx4 v[188:191], v253, s[60:63], s89 offen offset:2048 sc1
    s_waitcnt lgkmcnt(8)
    v_mfma_f32_16x16x32_bf16 v[12:15], v[216:219], v[36:39], v[12:15]
    ds_read_b64_tr_b16 v[236:237], v255 offset:42752
    s_add_u32 s89, s13, 6
    v_mfma_f32_16x16x32_bf16 v[16:19], v[216:219], v[40:43], v[16:19]
    ds_read_b64_tr_b16 v[238:239], v255 offset:42880
    s_sub_u32 s74, s89, 7
    s_cselect_b32 s89, s89, s74
    v_mfma_f32_16x16x32_bf16 v[20:23], v[216:219], v[44:47], v[20:23]
    s_cmp_eq_u32 s12, 7
    s_cselect_b32 s74, 3, 6
    s_waitcnt lgkmcnt(8)
    v_mfma_f32_16x16x32_bf16 v[12:15], v[220:223], v[84:87], v[12:15]
    ds_read_b64_tr_b16 v[216:217], v255 offset:42272
    s_lshl_b32 s18, s89, 7
    v_mfma_f32_16x16x32_bf16 v[16:19], v[220:223], v[88:91], v[16:19]
    ds_read_b64_tr_b16 v[218:219], v255 offset:42400
    s_add_u32 s18, s18, s74
    v_mfma_f32_16x16x32_bf16 v[20:23], v[220:223], v[92:95], v[20:23]
    s_lshl2_add_u32 s18, s18, s16
    s_waitcnt lgkmcnt(8)
    v_mfma_f32_16x16x32_bf16 v[60:63], v[224:227], v[36:39], v[60:63]
    ds_read_b64_tr_b16 v[220:221], v255 offset:42784
    s_mul_i32 s89, s89, 7
    v_mfma_f32_16x16x32_bf16 v[64:67], v[224:227], v[40:43], v[64:67]
    ds_read_b64_tr_b16 v[222:223], v255 offset:42912
    s_add_u32 s89, s89, s74
    v_mfma_f32_16x16x32_bf16 v[68:71], v[224:227], v[44:47], v[68:71]
    s_mul_i32 s89, s89, 12288
    s_waitcnt lgkmcnt(8)
    v_mfma_f32_16x16x32_bf16 v[60:63], v[228:231], v[84:87], v[60:63]
    v_mfma_f32_16x16x32_bf16 v[64:67], v[228:231], v[88:91], v[64:67]
    v_mfma_f32_16x16x32_bf16 v[68:71], v[228:231], v[92:95], v[68:71]
    s_waitcnt lgkmcnt(0)
    s_barrier
    v_mfma_f32_16x16x32_bf16 v[12:15], v[232:235], v[132:135], v[12:15]
    v_add_u32 v254, 67584, v254
    v_add_u32 v255, 67584, v255
    v_mfma_f32_16x16x32_bf16 v[16:19], v[232:235], v[136:139], v[16:19]
    ds_read_b64_tr_b16 v[224:225], v254 offset:0
    ds_read_b64_tr_b16 v[226:227], v254 offset:128
    v_mfma_f32_16x16x32_bf16 v[20:23], v[232:235], v[140:143], v[20:23]
    ds_read_b64_tr_b16 v[228:229], v254 offset:512
    v_mfma_f32_16x16x32_bf16 v[12:15], v[236:239], v[192:195], v[12:15]
    ds_read_b64_tr_b16 v[230:231], v254 offset:640
    v_mfma_f32_16x16x32_bf16 v[16:19], v[236:239], v[196:199], v[16:19]
    ds_read_b64_tr_b16 v[232:233], v254 offset:32
    v_mfma_f32_16x16x32_bf16 v[20:23], v[236:239], v[200:203], v[20:23]
    ds_read_b64_tr_b16 v[234:235], v254 offset:160
    v_mfma_f32_16x16x32_bf16 v[60:63], v[216:219], v[132:135], v[60:63]
    ds_read_b64_tr_b16 v[236:237], v254 offset:544
    v_mfma_f32_16x16x32_bf16 v[64:67], v[216:219], v[136:139], v[64:67]
    ds_read_b64_tr_b16 v[238:239], v254 offset:672
    v_mfma_f32_16x16x32_bf16 v[68:71], v[216:219], v[140:143], v[68:71]
    v_mfma_f32_16x16x32_bf16 v[60:63], v[220:223], v[192:195], v[60:63]
    ds_read_b64_tr_b16 v[216:217], v254 offset:8448
    v_mfma_f32_16x16x32_bf16 v[64:67], v[220:223], v[196:199], v[64:67]
    ds_read_b64_tr_b16 v[218:219], v254 offset:8576
    v_mfma_f32_16x16x32_bf16 v[68:71], v[220:223], v[200:203], v[68:71]
    s_waitcnt lgkmcnt(8)
    v_mfma_f32_16x16x32_bf16 v[12:15], v[224:227], v[96:99], v[12:15]
    ds_read_b64_tr_b16 v[220:221], v254 offset:8960
    v_mfma_f32_16x16x32_bf16 v[16:19], v[224:227], v[100:103], v[16:19]
    ds_read_b64_tr_b16 v[222:223], v254 offset:9088
    v_mfma_f32_16x16x32_bf16 v[20:23], v[224:227], v[104:107], v[20:23]
    s_waitcnt lgkmcnt(8)
    v_mfma_f32_16x16x32_bf16 v[12:15], v[228:231], v[120:123], v[12:15]
    ds_read_b64_tr_b16 v[224:225], v254 offset:8480
    v_mfma_f32_16x16x32_bf16 v[16:19], v[228:231], v[124:127], v[16:19]
    ds_read_b64_tr_b16 v[226:227], v254 offset:8608
    v_mfma_f32_16x16x32_bf16 v[20:23], v[228:231], v[128:131], v[20:23]
    s_waitcnt lgkmcnt(8)
    v_mfma_f32_16x16x32_bf16 v[60:63], v[232:235], v[96:99], v[60:63]
    ds_read_b64_tr_b16 v[228:229], v254 offset:8992
    v_mfma_f32_16x16x32_bf16 v[64:67], v[232:235], v[100:103], v[64:67]
    ds_read_b64_tr_b16 v[230:231], v254 offset:9120
    v_mfma_f32_16x16x32_bf16 v[68:71], v[232:235], v[104:107], v[68:71]
    s_waitcnt lgkmcnt(8)
    v_mfma_f32_16x16x32_bf16 v[60:63], v[236:239], v[120:123], v[60:63]
    ds_read_b64_tr_b16 v[232:233], v255 offset:0
    v_mfma_f32_16x16x32_bf16 v[64:67], v[236:239], v[124:127], v[64:67]
    ds_read_b64_tr_b16 v[234:235], v255 offset:128
    v_mfma_f32_16x16x32_bf16 v[68:71], v[236:239], v[128:131], v[68:71]
    s_waitcnt lgkmcnt(8)
    v_mfma_f32_16x16x32_bf16 v[12:15], v[216:219], v[144:147], v[12:15]
    ds_read_b64_tr_b16 v[236:237], v255 offset:512
    v_mfma_f32_16x16x32_bf16 v[16:19], v[216:219], v[148:151], v[16:19]
    ds_read_b64_tr_b16 v[238:239], v255 offset:640
    v_mfma_f32_16x16x32_bf16 v[20:23], v[216:219], v[152:155], v[20:23]
    s_waitcnt lgkmcnt(8)
    v_mfma_f32_16x16x32_bf16 v[12:15], v[220:223], v[168:171], v[12:15]
    ds_read_b64_tr_b16 v[216:217], v255 offset:32
    v_mfma_f32_16x16x32_bf16 v[16:19], v[220:223], v[172:175], v[16:19]
    ds_read_b64_tr_b16 v[218:219], v255 offset:160
    v_mfma_f32_16x16x32_bf16 v[20:23], v[220:223], v[176:179], v[20:23]
    s_waitcnt lgkmcnt(8)
    v_mfma_f32_16x16x32_bf16 v[60:63], v[224:227], v[144:147], v[60:63]
    ds_read_b64_tr_b16 v[220:221], v255 offset:544
    v_mfma_f32_16x16x32_bf16 v[64:67], v[224:227], v[148:151], v[64:67]
    ds_read_b64_tr_b16 v[222:223], v255 offset:672
    v_mfma_f32_16x16x32_bf16 v[68:71], v[224:227], v[152:155], v[68:71]
    s_waitcnt lgkmcnt(8)
    v_mfma_f32_16x16x32_bf16 v[60:63], v[228:231], v[168:171], v[60:63]
    ds_read_b64_tr_b16 v[224:225], v255 offset:8448
    v_mfma_f32_16x16x32_bf16 v[64:67], v[228:231], v[172:175], v[64:67]
    ds_read_b64_tr_b16 v[226:227], v255 offset:8576
    v_mfma_f32_16x16x32_bf16 v[68:71], v[228:231], v[176:179], v[68:71]
    s_waitcnt lgkmcnt(8)
    v_mfma_f32_16x16x32_bf16 v[12:15], v[232:235], v[204:207], v[12:15]
    ds_read_b64_tr_b16 v[228:229], v255 offset:8960
    v_mfma_f32_16x16x32_bf16 v[16:19], v[232:235], v[208:211], v[16:19]
    ds_read_b64_tr_b16 v[230:231], v255 offset:9088
    v_mfma_f32_16x16x32_bf16 v[20:23], v[232:235], v[212:215], v[20:23]
    s_waitcnt lgkmcnt(8)
    v_mfma_f32_16x16x32_bf16 v[12:15], v[236:239], v[240:243], v[12:15]
    ds_read_b64_tr_b16 v[232:233], v255 offset:8480
    v_mfma_f32_16x16x32_bf16 v[16:19], v[236:239], v[244:247], v[16:19]
    ds_read_b64_tr_b16 v[234:235], v255 offset:8608
    v_mfma_f32_16x16x32_bf16 v[20:23], v[236:239], v[248:251], v[20:23]
    s_waitcnt lgkmcnt(8)
    v_mfma_f32_16x16x32_bf16 v[60:63], v[216:219], v[204:207], v[60:63]
    ds_read_b64_tr_b16 v[236:237], v255 offset:8992
    v_mfma_f32_16x16x32_bf16 v[64:67], v[216:219], v[208:211], v[64:67]
    ds_read_b64_tr_b16 v[238:239], v255 offset:9120
    v_mfma_f32_16x16x32_bf16 v[68:71], v[216:219], v[212:215], v[68:71]
    s_waitcnt lgkmcnt(8)
    v_mfma_f32_16x16x32_bf16 v[60:63], v[220:223], v[240:243], v[60:63]
    v_mfma_f32_16x16x32_bf16 v[64:67], v[220:223], v[244:247], v[64:67]
    v_mfma_f32_16x16x32_bf16 v[68:71], v[220:223], v[248:251], v[68:71]
    s_waitcnt lgkmcnt(0)
    s_barrier
    v_mfma_f32_16x16x32_bf16 v[12:15], v[224:227], v[108:111], v[12:15]
    ds_read_b64_tr_b16 v[216:217], v254 offset:33792
    ds_read_b64_tr_b16 v[218:219], v254 offset:33920
    v_mfma_f32_16x16x32_bf16 v[16:19], v[224:227], v[112:115], v[16:19]
    ds_read_b64_tr_b16 v[220:221], v254 offset:34304
    v_mfma_f32_16x16x32_bf16 v[20:23], v[224:227], v[116:119], v[20:23]
    ds_read_b64_tr_b16 v[222:223], v254 offset:34432
    v_mfma_f32_16x16x32_bf16 v[12:15], v[228:231], v[156:159], v[12:15]
    ds_read_b64_tr_b16 v[224:225], v254 offset:33824
    v_mfma_f32_16x16x32_bf16 v[16:19], v[228:231], v[160:163], v[16:19]
    ds_read_b64_tr_b16 v[226:227], v254 offset:33952
    v_mfma_f32_16x16x32_bf16 v[20:23], v[228:231], v[164:167], v[20:23]
    v_mfma_f32_16x16x32_bf16 v[60:63], v[232:235], v[108:111], v[60:63]
    ds_read_b64_tr_b16 v[228:229], v254 offset:34336
    s_nop 1
    v_cvt_pk_bf16_f32 v180, v12, v13
    v_mfma_f32_16x16x32_bf16 v[64:67], v[232:235], v[112:115], v[64:67]
    ds_read_b64_tr_b16 v[230:231], v254 offset:34464
    v_cvt_pk_bf16_f32 v181, v14, v15
    v_mfma_f32_16x16x32_bf16 v[68:71], v[232:235], v[116:119], v[68:71]
    v_cvt_pk_bf16_f32 v184, v16, v17
    v_cvt_pk_bf16_f32 v185, v18, v19
    v_mfma_f32_16x16x32_bf16 v[60:63], v[236:239], v[156:159], v[60:63]
    ds_read_b64_tr_b16 v[232:233], v254 offset:42240
    v_cvt_pk_bf16_f32 v188, v20, v21
    v_mfma_f32_16x16x32_bf16 v[64:67], v[236:239], v[160:163], v[64:67]
    ds_read_b64_tr_b16 v[234:235], v254 offset:42368
    v_cvt_pk_bf16_f32 v189, v22, v23
    v_mfma_f32_16x16x32_bf16 v[68:71], v[236:239], v[164:167], v[68:71]
    v_min_u32 v180, -2, v180
    v_min_u32 v181, -2, v181
    s_waitcnt lgkmcnt(8)
    v_mfma_f32_16x16x32_bf16 v[12:15], v[216:219], v[0:3], 0
    ds_read_b64_tr_b16 v[236:237], v254 offset:42752
    v_min_u32 v184, -2, v184
    v_mfma_f32_16x16x32_bf16 v[16:19], v[216:219], v[4:7], 0
    ds_read_b64_tr_b16 v[238:239], v254 offset:42880
    v_min_u32 v185, -2, v185
    v_mfma_f32_16x16x32_bf16 v[20:23], v[216:219], v[8:11], 0
    v_min_u32 v188, -2, v188
    v_min_u32 v189, -2, v189
    s_waitcnt lgkmcnt(8)
    v_mfma_f32_16x16x32_bf16 v[12:15], v[220:223], v[24:27], v[12:15]
    ds_read_b64_tr_b16 v[216:217], v254 offset:42272
    v_cvt_pk_bf16_f32 v182, v60, v61
    v_mfma_f32_16x16x32_bf16 v[16:19], v[220:223], v[28:31], v[16:19]
    ds_read_b64_tr_b16 v[218:219], v254 offset:42400
    v_cvt_pk_bf16_f32 v183, v62, v63
    v_mfma_f32_16x16x32_bf16 v[20:23], v[220:223], v[32:35], v[20:23]
    v_cvt_pk_bf16_f32 v186, v64, v65
    v_cvt_pk_bf16_f32 v187, v66, v67
    v_cvt_pk_bf16_f32 v190, v68, v69
    v_cvt_pk_bf16_f32 v191, v70, v71
    s_waitcnt lgkmcnt(8)
    v_mfma_f32_16x16x32_bf16 v[60:63], v[224:227], v[0:3], 0
    ds_read_b64_tr_b16 v[220:221], v254 offset:42784
    v_min_u32 v182, -2, v182
    v_mfma_f32_16x16x32_bf16 v[64:67], v[224:227], v[4:7], 0
    ds_read_b64_tr_b16 v[222:223], v254 offset:42912
    v_min_u32 v183, -2, v183
    v_mfma_f32_16x16x32_bf16 v[68:71], v[224:227], v[8:11], 0
    v_min_u32 v186, -2, v186
    v_min_u32 v187, -2, v187
    s_waitcnt lgkmcnt(8)
    v_mfma_f32_16x16x32_bf16 v[60:63], v[228:231], v[24:27], v[60:63]
    ds_read_b64_tr_b16 v[224:225], v255 offset:33792
    v_min_u32 v190, -2, v190
    v_mfma_f32_16x16x32_bf16 v[64:67], v[228:231], v[28:31], v[64:67]
    ds_read_b64_tr_b16 v[226:227], v255 offset:33920
    v_min_u32 v191, -2, v191
    v_mfma_f32_16x16x32_bf16 v[68:71], v[228:231], v[32:35], v[68:71]
    buffer_store_dwordx4 v[180:183], v253, s[60:63], s89 offen offset:0 sc1
    s_waitcnt lgkmcnt(8)
    v_mfma_f32_16x16x32_bf16 v[12:15], v[232:235], v[48:51], v[12:15]
    ds_read_b64_tr_b16 v[228:229], v255 offset:34304
    v_mfma_f32_16x16x32_bf16 v[16:19], v[232:235], v[52:55], v[16:19]
    ds_read_b64_tr_b16 v[230:231], v255 offset:34432
    v_mfma_f32_16x16x32_bf16 v[20:23], v[232:235], v[56:59], v[20:23]
    buffer_store_dwordx4 v[184:187], v253, s[60:63], s89 offen offset:1024 sc1
    s_waitcnt lgkmcnt(8)
    v_mfma_f32_16x16x32_bf16 v[12:15], v[236:239], v[72:75], v[12:15]
    ds_read_b64_tr_b16 v[232:233], v255 offset:33824
    v_mfma_f32_16x16x32_bf16 v[16:19], v[236:239], v[76:79], v[16:19]
    ds_read_b64_tr_b16 v[234:235], v255 offset:33952
    v_mfma_f32_16x16x32_bf16 v[20:23], v[236:239], v[80:83], v[20:23]
    s_waitcnt lgkmcnt(8)
    v_mfma_f32_16x16x32_bf16 v[60:63], v[216:219], v[48:51], v[60:63]
    ds_read_b64_tr_b16 v[236:237], v255 offset:34336
    v_mfma_f32_16x16x32_bf16 v[64:67], v[216:219], v[52:55], v[64:67]
    ds_read_b64_tr_b16 v[238:239], v255 offset:34464
    v_mfma_f32_16x16x32_bf16 v[68:71], v[216:219], v[56:59], v[68:71]
    buffer_store_dwordx4 v[188:191], v253, s[60:63], s89 offen offset:2048 sc1
    s_waitcnt lgkmcnt(8)
    v_mfma_f32_16x16x32_bf16 v[60:63], v[220:223], v[72:75], v[60:63]
    ds_read_b64_tr_b16 v[216:217], v255 offset:42240
    v_mfma_f32_16x16x32_bf16 v[64:67], v[220:223], v[76:79], v[64:67]
    ds_read_b64_tr_b16 v[218:219], v255 offset:42368
    v_mfma_f32_16x16x32_bf16 v[68:71], v[220:223], v[80:83], v[68:71]
    s_waitcnt lgkmcnt(8)
    v_mfma_f32_16x16x32_bf16 v[12:15], v[224:227], v[36:39], v[12:15]
    ds_read_b64_tr_b16 v[220:221], v255 offset:42752
    v_mfma_f32_16x16x32_bf16 v[16:19], v[224:227], v[40:43], v[16:19]
    ds_read_b64_tr_b16 v[222:223], v255 offset:42880
    v_mfma_f32_16x16x32_bf16 v[20:23], v[224:227], v[44:47], v[20:23]
    s_waitcnt lgkmcnt(8)
    v_mfma_f32_16x16x32_bf16 v[12:15], v[228:231], v[84:87], v[12:15]
    ds_read_b64_tr_b16 v[224:225], v255 offset:42272
    v_mfma_f32_16x16x32_bf16 v[16:19], v[228:231], v[88:91], v[16:19]
    ds_read_b64_tr_b16 v[226:227], v255 offset:42400
    v_mfma_f32_16x16x32_bf16 v[20:23], v[228:231], v[92:95], v[20:23]
    s_waitcnt lgkmcnt(8)
    v_mfma_f32_16x16x32_bf16 v[60:63], v[232:235], v[36:39], v[60:63]
    ds_read_b64_tr_b16 v[228:229], v255 offset:42784
    v_mfma_f32_16x16x32_bf16 v[64:67], v[232:235], v[40:43], v[64:67]
    ds_read_b64_tr_b16 v[230:231], v255 offset:42912
    v_mfma_f32_16x16x32_bf16 v[68:71], v[232:235], v[44:47], v[68:71]
    s_waitcnt lgkmcnt(8)
    v_mfma_f32_16x16x32_bf16 v[60:63], v[236:239], v[84:87], v[60:63]
    v_subrev_u32 v254, 67584, v254
    v_subrev_u32 v255, 67584, v255
    v_mfma_f32_16x16x32_bf16 v[64:67], v[236:239], v[88:91], v[64:67]
    ds_read_b64_tr_b16 v[232:233], v254 offset:0
    v_mfma_f32_16x16x32_bf16 v[68:71], v[236:239], v[92:95], v[68:71]
    ds_read_b64_tr_b16 v[234:235], v254 offset:128
    s_waitcnt lgkmcnt(8)
    v_mfma_f32_16x16x32_bf16 v[12:15], v[216:219], v[132:135], v[12:15]
    ds_read_b64_tr_b16 v[236:237], v254 offset:512
    v_mfma_f32_16x16x32_bf16 v[16:19], v[216:219], v[136:139], v[16:19]
    ds_read_b64_tr_b16 v[238:239], v254 offset:640
    v_mfma_f32_16x16x32_bf16 v[20:23], v[216:219], v[140:143], v[20:23]
    s_waitcnt lgkmcnt(8)
    v_mfma_f32_16x16x32_bf16 v[12:15], v[220:223], v[192:195], v[12:15]
    ds_read_b64_tr_b16 v[216:217], v254 offset:32
    v_mfma_f32_16x16x32_bf16 v[16:19], v[220:223], v[196:199], v[16:19]
    ds_read_b64_tr_b16 v[218:219], v254 offset:160
    v_mfma_f32_16x16x32_bf16 v[20:23], v[220:223], v[200:203], v[20:23]
    s_waitcnt lgkmcnt(8)
    v_mfma_f32_16x16x32_bf16 v[60:63], v[224:227], v[132:135], v[60:63]
    ds_read_b64_tr_b16 v[220:221], v254 offset:544
    v_mfma_f32_16x16x32_bf16 v[64:67], v[224:227], v[136:139], v[64:67]
    ds_read_b64_tr_b16 v[222:223], v254 offset:672
    v_mfma_f32_16x16x32_bf16 v[68:71], v[224:227], v[140:143], v[68:71]
    s_mov_b64 exec, s[20:21]
    buffer_store_dword v252, v253, s[60:63], s19 offen sc1
    s_mov_b64 exec, -1
    s_waitcnt lgkmcnt(8)
    v_mfma_f32_16x16x32_bf16 v[60:63], v[228:231], v[192:195], v[60:63]
    ds_read_b64_tr_b16 v[224:225], v254 offset:8448
    v_subrev_u32 v252, s78, v253
    v_mfma_f32_16x16x32_bf16 v[64:67], v[228:231], v[196:199], v[64:67]
    ds_read_b64_tr_b16 v[226:227], v254 offset:8576
    v_lshrrev_b32 v252, 1, v252
    v_mfma_f32_16x16x32_bf16 v[68:71], v[228:231], v[200:203], v[68:71]
    s_waitcnt lgkmcnt(8)
    v_mfma_f32_16x16x32_bf16 v[12:15], v[232:235], v[96:99], v[12:15]
    ds_read_b64_tr_b16 v[228:229], v254 offset:8960
    v_mfma_f32_16x16x32_bf16 v[16:19], v[232:235], v[100:103], v[16:19]
    ds_read_b64_tr_b16 v[230:231], v254 offset:9088
    v_mfma_f32_16x16x32_bf16 v[20:23], v[232:235], v[104:107], v[20:23]
    s_waitcnt lgkmcnt(8)
    v_mfma_f32_16x16x32_bf16 v[12:15], v[236:239], v[120:123], v[12:15]
    ds_read_b64_tr_b16 v[232:233], v254 offset:8480
    v_mfma_f32_16x16x32_bf16 v[16:19], v[236:239], v[124:127], v[16:19]
    ds_read_b64_tr_b16 v[234:235], v254 offset:8608
    v_mfma_f32_16x16x32_bf16 v[20:23], v[236:239], v[128:131], v[20:23]
    s_waitcnt lgkmcnt(8)
    v_mfma_f32_16x16x32_bf16 v[60:63], v[216:219], v[96:99], v[60:63]
    ds_read_b64_tr_b16 v[236:237], v254 offset:8992
    v_mfma_f32_16x16x32_bf16 v[64:67], v[216:219], v[100:103], v[64:67]
    ds_read_b64_tr_b16 v[238:239], v254 offset:9120
    v_mfma_f32_16x16x32_bf16 v[68:71], v[216:219], v[104:107], v[68:71]
    s_waitcnt lgkmcnt(8)
    v_mfma_f32_16x16x32_bf16 v[60:63], v[220:223], v[120:123], v[60:63]
    ds_read_b64_tr_b16 v[216:217], v255 offset:0
    v_mfma_f32_16x16x32_bf16 v[64:67], v[220:223], v[124:127], v[64:67]
    ds_read_b64_tr_b16 v[218:219], v255 offset:128
    v_mfma_f32_16x16x32_bf16 v[68:71], v[220:223], v[128:131], v[68:71]
    s_waitcnt lgkmcnt(8)
    v_mfma_f32_16x16x32_bf16 v[12:15], v[224:227], v[144:147], v[12:15]
    ds_read_b64_tr_b16 v[220:221], v255 offset:512
    v_mfma_f32_16x16x32_bf16 v[16:19], v[224:227], v[148:151], v[16:19]
    ds_read_b64_tr_b16 v[222:223], v255 offset:640
    v_mfma_f32_16x16x32_bf16 v[20:23], v[224:227], v[152:155], v[20:23]
    s_waitcnt lgkmcnt(8)
    v_mfma_f32_16x16x32_bf16 v[12:15], v[228:231], v[168:171], v[12:15]
    ds_read_b64_tr_b16 v[224:225], v255 offset:32
    v_mfma_f32_16x16x32_bf16 v[16:19], v[228:231], v[172:175], v[16:19]
    ds_read_b64_tr_b16 v[226:227], v255 offset:160
    v_mfma_f32_16x16x32_bf16 v[20:23], v[228:231], v[176:179], v[20:23]
    s_waitcnt lgkmcnt(8)
    v_mfma_f32_16x16x32_bf16 v[60:63], v[232:235], v[144:147], v[60:63]
    ds_read_b64_tr_b16 v[228:229], v255 offset:544
    v_mfma_f32_16x16x32_bf16 v[64:67], v[232:235], v[148:151], v[64:67]
    ds_read_b64_tr_b16 v[230:231], v255 offset:672
    v_mfma_f32_16x16x32_bf16 v[68:71], v[232:235], v[152:155], v[68:71]
    s_waitcnt lgkmcnt(8)
    v_mfma_f32_16x16x32_bf16 v[60:63], v[236:239], v[168:171], v[60:63]
    ds_read_b64_tr_b16 v[232:233], v255 offset:8448
    v_mfma_f32_16x16x32_bf16 v[64:67], v[236:239], v[172:175], v[64:67]
    ds_read_b64_tr_b16 v[234:235], v255 offset:8576
    v_mfma_f32_16x16x32_bf16 v[68:71], v[236:239], v[176:179], v[68:71]
    s_waitcnt lgkmcnt(8)
    v_mfma_f32_16x16x32_bf16 v[12:15], v[216:219], v[204:207], v[12:15]
    ds_read_b64_tr_b16 v[236:237], v255 offset:8960
    v_mfma_f32_16x16x32_bf16 v[16:19], v[216:219], v[208:211], v[16:19]
    ds_read_b64_tr_b16 v[238:239], v255 offset:9088
    v_mfma_f32_16x16x32_bf16 v[20:23], v[216:219], v[212:215], v[20:23]
    s_waitcnt lgkmcnt(8)
    v_mfma_f32_16x16x32_bf16 v[12:15], v[220:223], v[240:243], v[12:15]
    ds_read_b64_tr_b16 v[216:217], v255 offset:8480
    v_mfma_f32_16x16x32_bf16 v[16:19], v[220:223], v[244:247], v[16:19]
    ds_read_b64_tr_b16 v[218:219], v255 offset:8608
    v_mfma_f32_16x16x32_bf16 v[20:23], v[220:223], v[248:251], v[20:23]
    s_waitcnt lgkmcnt(8)
    v_mfma_f32_16x16x32_bf16 v[60:63], v[224:227], v[204:207], v[60:63]
    ds_read_b64_tr_b16 v[220:221], v255 offset:8992
    v_mfma_f32_16x16x32_bf16 v[64:67], v[224:227], v[208:211], v[64:67]
    ds_read_b64_tr_b16 v[222:223], v255 offset:9120
    v_mfma_f32_16x16x32_bf16 v[68:71], v[224:227], v[212:215], v[68:71]
    s_waitcnt lgkmcnt(8)
    v_mfma_f32_16x16x32_bf16 v[60:63], v[228:231], v[240:243], v[60:63]
    v_mfma_f32_16x16x32_bf16 v[64:67], v[228:231], v[244:247], v[64:67]
    v_mfma_f32_16x16x32_bf16 v[68:71], v[228:231], v[248:251], v[68:71]
    s_waitcnt lgkmcnt(6)
    v_mfma_f32_16x16x32_bf16 v[12:15], v[232:235], v[108:111], v[12:15]
    v_mfma_f32_16x16x32_bf16 v[16:19], v[232:235], v[112:115], v[16:19]
    v_mfma_f32_16x16x32_bf16 v[20:23], v[232:235], v[116:119], v[20:23]
    s_waitcnt lgkmcnt(4)
    v_mfma_f32_16x16x32_bf16 v[12:15], v[236:239], v[156:159], v[12:15]
    v_mfma_f32_16x16x32_bf16 v[16:19], v[236:239], v[160:163], v[16:19]
    v_mfma_f32_16x16x32_bf16 v[20:23], v[236:239], v[164:167], v[20:23]
    s_waitcnt lgkmcnt(2)
    v_mfma_f32_16x16x32_bf16 v[60:63], v[216:219], v[108:111], v[60:63]
    s_nop 3
    v_cvt_pk_bf16_f32 v180, v12, v13
    v_cvt_pk_bf16_f32 v181, v14, v15
    v_mfma_f32_16x16x32_bf16 v[64:67], v[216:219], v[112:115], v[64:67]
    v_cvt_pk_bf16_f32 v184, v16, v17
    v_cvt_pk_bf16_f32 v185, v18, v19
    v_mfma_f32_16x16x32_bf16 v[68:71], v[216:219], v[116:119], v[68:71]
    v_cvt_pk_bf16_f32 v188, v20, v21
    v_cvt_pk_bf16_f32 v189, v22, v23
    s_waitcnt lgkmcnt(0)
    v_mfma_f32_16x16x32_bf16 v[60:63], v[220:223], v[156:159], v[60:63]
    v_min_u32 v180, -2, v180
    v_min_u32 v181, -2, v181
    v_mfma_f32_16x16x32_bf16 v[64:67], v[220:223], v[160:163], v[64:67]
    v_min_u32 v184, -2, v184
    v_min_u32 v185, -2, v185
    v_mfma_f32_16x16x32_bf16 v[68:71], v[220:223], v[164:167], v[68:71]
    v_min_u32 v188, -2, v188
    v_min_u32 v189, -2, v189
    ds_write_b64 v252, v[180:181] offset:12288
    ds_write_b64 v252, v[184:185] offset:13312
    ds_write_b64 v252, v[188:189] offset:14336
    v_cvt_pk_bf16_f32 v182, v60, v61
    v_cvt_pk_bf16_f32 v183, v62, v63
    v_cvt_pk_bf16_f32 v186, v64, v65
    v_cvt_pk_bf16_f32 v187, v66, v67
    v_cvt_pk_bf16_f32 v190, v68, v69
    v_cvt_pk_bf16_f32 v191, v70, v71
    v_min_u32 v182, -2, v182
    v_min_u32 v183, -2, v183
    v_min_u32 v186, -2, v186
    v_min_u32 v187, -2, v187
    v_min_u32 v190, -2, v190
    v_min_u32 v191, -2, v191
    ds_write_b64 v252, v[182:183] offset:12800
    ds_write_b64 v252, v[186:187] offset:13824
    ds_write_b64 v252, v[190:191] offset:14848
    s_cmp_lg_u32 s12, 7
    s_cbranch_scc1 L_nost6
    buffer_store_dwordx4 v[180:183], v253, s[60:63], s81 offen offset:0 sc1
    buffer_store_dwordx4 v[184:187], v253, s[60:63], s81 offen offset:1024 sc1
    buffer_store_dwordx4 v[188:191], v253, s[60:63], s81 offen offset:2048 sc1
L_nost6:
    s_waitcnt lgkmcnt(0)
    s_barrier
    s_endpgm
L_codeend:
    .fill (concat_heads__mha_block_cached__gqa_block_cached__near_ridge_kernel+45952-L_codeend)/4, 4, 0xbf810000
.section .rodata,"a"
.p2align 6
.amdhsa_kernel concat_heads__mha_block_cached__gqa_block_cached__near_ridge_kernel
  .amdhsa_next_free_vgpr 256
  .amdhsa_next_free_sgpr 102
  .amdhsa_accum_offset 256
  .amdhsa_group_segment_fixed_size 0
  .amdhsa_kernarg_size 104
  .amdhsa_user_sgpr_count 2
  .amdhsa_user_sgpr_kernarg_segment_ptr 1
  .amdhsa_system_sgpr_workgroup_id_x 1
.end_amdhsa_kernel
```
